```python
import torch

def _softmax(x, axis=-1):
    return torch.softmax(x, dim=axis)

def _gelu(x):
    return torch.nn.functional.gelu(x, approximate='tanh')

def _silu(x):
    return torch.nn.functional.silu(x)

def _sigmoid(x):
    return torch.sigmoid(x)

def _layernorm(x, axis=-1, eps=1e-05):
    m = x.mean(dim=axis, keepdim=True)
    v = x.var(dim=axis, keepdim=True, unbiased=False)
    return (x - m) / torch.sqrt(v + eps)

def _scatter_add(tgt, idx, src, axis=0):
    return tgt.clone().index_add_(axis, idx, src)

def _segment_sum(src, seg, n):
    out = torch.zeros((n,) + src.shape[1:], dtype=src.dtype)
    return out.index_add_(0, seg, src)

def _pad(x, pw):
    flat = tuple((v for pair in reversed(pw) for v in pair))
    return torch.nn.functional.pad(x, flat)
kernel_name = 'standalone__conformer_conv_module__speech'

def setup_inputs():

    _w = lambda a: (lambda t: t.to(torch.bfloat16) if t.is_floating_point() else t)(torch.as_tensor(a))
    B, T, D, K = (2, 16000, 512, 5)
    return {'x': _w((lambda *s: torch.randn(*s, dtype=torch.bfloat16) * 0.2)(B, T, D)), 'w_pw1': _w((lambda *s: torch.randn(*s, dtype=torch.bfloat16) * 0.2)(D, 2 * D)), 'dw': _w((lambda *s: torch.randn(*s, dtype=torch.bfloat16) * 0.2)(K, D)), 'w_pw2': _w((lambda *s: torch.randn(*s, dtype=torch.bfloat16) * 0.05)(D, D))}

def reference(x, w_pw1, dw, w_pw2):
    B, T, D = x.shape
    K = dw.shape[0]
    h = x @ w_pw1
    a, b = (h[..., :D].clone(), h[..., D:].clone())
    h = a * _sigmoid(b)
    pad = K // 2
    hp = _pad(h, ((0, 0), (pad, pad), (0, 0)))
    out = torch.zeros_like(h)
    for i in range(K):
        out = out + hp[:, i:i + T, :] * dw[i][None, None, :]
    return _silu(out) @ w_pw2
```

```asm
; @launch grid=(256,1,1) block=(512,1,1) lds=163840
.amdgcn_target "amdgcn-amd-amdhsa--gfx950"
.text
.globl standalone__conformer_conv_module__speech_kernel
.p2align 8
.type standalone__conformer_conv_module__speech_kernel,@function
standalone__conformer_conv_module__speech_kernel:
    s_cmp_ge_u32 s2, 256
    s_cbranch_scc1 L_end
    s_load_dwordx8 s[76:83], s[0:1], 0
    s_load_dwordx4 s[84:87], s[0:1], 32
    s_load_dwordx2 s[88:89], s[0:1], 48
    v_readfirstlane_b32 s52, v0
    s_mov_b32 s56, s2
    s_and_b32 s3, s2, 7
    s_lshr_b32 s46, s2, 3
    s_lshl_b32 s47, s3, 5
    s_add_u32 s54, s46, s47
    s_and_b32 s47, s2, 1
    s_lshl_b32 s48, s47, 11
    s_sub_u32 s50, 0x20000, s48
    s_mul_i32 s55, s46, s50
    s_lshl_b32 s47, s47, 22
    s_add_u32 s55, s55, s47
    s_bitcmp1_b32 s2, 1
    s_cselect_b32 s47, 8194048, 0
    s_add_u32 s55, s55, s47
    s_bitcmp1_b32 s2, 2
    s_cselect_b32 s47, 16384000, 0
    s_add_u32 s2, s55, s47
    s_lshr_b32 s52, s52, 6
    s_xor_b32 s52, s52, 4
    s_and_b32 s53, s52, 3
    v_and_b32 v0, 63, v0
    s_and_b32 s46, s54, 63
    s_cmp_eq_u32 s46, 63
    s_cbranch_scc1 L_notile
    s_cmp_lt_u32 s52, 4
    s_cbranch_scc0 L_startB
    s_getpc_b64 s[16:17]
    s_movk_i32 s18, 1024
    s_mov_b32 s19, 0x20000
    s_mul_i32 s46, s53, 1024
    s_add_u32 s16, s16, s46
    s_addc_u32 s17, s17, 0
    v_lshlrev_b32 v9, 7, v0
    buffer_load_dword v8, v9, s[16:19], 0 offen
    v_lshrrev_b32 v1, 5, v0
    v_lshlrev_b32 v1, 1, v1
    v_and_b32 v2, 3, v0
    v_xor_b32 v1, v1, v2
    s_lshl_b32 s36, s53, 6
    v_lshl_add_u32 v1, v1, 4, s36
    v_lshrrev_b32 v3, 2, v0
    v_lshl_add_u32 v244, v3, 11, v1
    s_lshl_b32 s44, s53, 13
    s_add_u32 s44, s44, 131072
    s_add_u32 s45, s44, 4096
    s_mov_b32 s66, 0
    s_mov_b32 s67, 31744
    s_mov_b32 s68, 63488
    s_mov_b32 s69, 95232
    s_mov_b32 s70, 1024
    s_mov_b32 s71, 32768
    s_mov_b32 s72, 64512
    s_mov_b32 s73, 96256
    s_waitcnt lgkmcnt(0)
    s_mov_b32 s8, s78
    s_mov_b32 s9, s79
    s_mov_b32 s10, 1048576
    s_mov_b32 s11, 0x20000
    s_lshr_b32 s47, s56, 3
    s_lshl2_add_u32 s96, s47, s53
    v_add_u32 v240, 0, v244
    s_mov_b32 m0, s44
    s_nop 0
    buffer_load_dwordx4 v240, s[8:11], s66 offen offset:0  lds
    buffer_load_dwordx4 v240, s[8:11], s67 offen offset:1024  lds
    buffer_load_dwordx4 v240, s[8:11], s68 offen offset:2048  lds
    buffer_load_dwordx4 v240, s[8:11], s69 offen offset:3072  lds
    s_mov_b32 m0, s45
    s_nop 0
    buffer_load_dwordx4 v240, s[8:11], s70 offen offset:0  lds
    buffer_load_dwordx4 v240, s[8:11], s71 offen offset:1024  lds
    buffer_load_dwordx4 v240, s[8:11], s72 offen offset:2048  lds
    buffer_load_dwordx4 v240, s[8:11], s73 offen offset:3072  lds
    s_branch L_A2
L_startB:
    v_lshrrev_b32 v12, 3, v0
    v_and_b32 v13, 7, v0
    v_lshrrev_b32 v14, 4, v0
    v_xor_b32 v14, v14, v13
    s_lshl_b32 s49, s53, 11
    v_lshl_add_u32 v14, v14, 4, s49
    v_lshl_add_u32 v16, v12, 13, v14
    v_xor_b32 v17, 0x10040, v16
    v_add_u32 v19, 1024, v17
    s_cmp_eq_u32 s55, 0
    s_cselect_b32 s49, 1024, 0
    v_cmp_gt_u32 vcc, s49, v16
    v_mov_b32 v15, 2130706432
    s_sub_u32 s6, 16386048, s55
    v_cndmask_b32 v16, v16, v15, vcc
    s_mov_b32 s7, 0x20000
    s_min_u32 s6, s6, s7
    v_add_u32 v18, 1024, v16
    s_lshl_b32 s49, s53, 12
    s_waitcnt lgkmcnt(0)
    s_add_u32 s4, s76, s2
    s_addc_u32 s5, s77, 0
    s_sub_u32 s4, s4, 2048
    s_subb_u32 s5, s5, 0
    s_movk_i32 s46, 0
    s_add_u32 m0, s49, 0
    s_nop 0
    buffer_load_dwordx4 v16, s[4:7], s46 offen nt lds
    s_add_u32 m0, s49, 1024
    s_nop 0
    buffer_load_dwordx4 v17, s[4:7], s46 offen nt lds
    s_add_u32 m0, s49, 2048
    s_nop 0
    buffer_load_dwordx4 v18, s[4:7], s46 offen nt lds
    s_add_u32 m0, s49, 3072
    s_nop 0
    buffer_load_dwordx4 v19, s[4:7], s46 offen nt lds
L_B2:
    s_mov_b32 s8, s78
    s_mov_b32 s9, s79
    s_mov_b32 s10, 1048576
    s_mov_b32 s11, 0x20000
    s_getpc_b64 s[16:17]
L_pc:
    s_mov_b32 s18, L_code_end-L_pc
    s_mov_b32 s19, 0x20000
    s_lshr_b32 s47, s56, 3
    s_lshl2_add_u32 s96, s47, s53
    v_lshrrev_b32 v6, 1, v0
    v_lshlrev_b32 v6, 10, v6
    v_and_b32 v7, 1, v0
    v_lshl_add_u32 v6, v7, 7, v6
    v_lshrrev_b32 v7, 4, v0
    v_lshl_add_u32 v6, v7, 28, v6
    s_and_b32 s48, s56, 1
    s_lshl_b32 s48, s48, 30
    v_add_u32 v6, s48, v6
    s_lshl_b32 s48, s96, 13
    buffer_load_dword v8, v6, s[8:11], s48 offen
    s_lshl_b32 s48, s96, 7
    v_lshlrev_b32 v7, 14, v0
    buffer_load_dword v9, v7, s[16:19], s48 offen
    v_and_b32 v2, 3, v0
    s_mov_b32 s12, s82
    s_mov_b32 s13, s83
    s_mov_b32 s14, 524288
    s_mov_b32 s15, 0x20000
    s_mov_b32 s28, s86
    s_mov_b32 s29, s87
    s_mov_b32 s30, 256
    s_mov_b32 s31, 0x20000
    s_add_u32 s16, s84, s2
    s_addc_u32 s17, s85, 0
    s_sub_u32 s18, 16384000, s55
    s_min_u32 s18, s18, s50
    s_mov_b32 s19, 0x20000
    s_lshl_b32 s46, s54, 12
    s_add_u32 s24, s88, s46
    s_addc_u32 s25, s89, 0
    s_and_b32 s46, s54, 63
    s_cselect_b32 s46, 1, 2
    s_sub_u32 s47, s54, s46
    s_lshl_b32 s46, s46, 12
    s_sub_u32 s32, s24, s46
    s_subb_u32 s33, s25, 0
    s_movk_i32 s46, 4096
    s_bitcmp1_b32 s47, 5
    s_cselect_b32 s34, 2048, s46
    s_cmp_eq_u32 s55, 0
    s_cselect_b32 s34, 0, s34
    s_bitcmp1_b32 s54, 5
    s_cselect_b32 s26, 2048, s46
    s_cmp_lt_u32 s18, s50
    s_cselect_b32 s26, 0, s26
    s_mov_b32 s27, 0x20000
    s_mov_b32 s35, 0x20000
    s_mov_b32 s50, 0xbfb8aa3b
    s_mov_b32 s51, 0xbf317218
    s_lshl_b32 s38, s53, 7
    v_lshrrev_b32 v3, 4, v0
    v_lshlrev_b32 v251, 4, v3
    v_bfe_u32 v5, v0, 2, 2
    v_xor_b32 v24, v5, v3
    v_lshlrev_b32 v24, 24, v24
    v_lshl_add_u32 v24, v5, 8, v24
    v_lshl_add_u32 v252, v2, 4, v24
    v_and_b32 v25, 15, v0
    s_sub_u32 s46, s34, 2048
    v_lshlrev_b32 v24, 11, v25
    v_sub_u32 v24, s46, v24
    v_min_u32 v24, 2130706432, v24
    v_add_u32 v254, v24, v251
    v_add_u32 v25, 1, v25
    v_lshrrev_b32 v25, 4, v25
    v_xor_b32 v25, 1, v25
    v_lshl_add_u32 v251, v25, 11, v251
    v_mov_b32 v253, -2
    s_lshr_b32 s46, s53, 1
    s_lshl_b32 s46, s46, 14
    s_and_b32 s47, s53, 1
    s_lshl_b32 s47, s47, 10
    s_add_u32 s39, s46, s47
    s_add_u32 s39, s39, 98304
    v_lshl_add_u32 v250, v0, 4, s39
    s_add_u32 s58, s88, 1048576
    s_addc_u32 s59, s89, 0
    s_lshl_b32 s46, s53, 16
    s_add_u32 s60, s58, s46
    s_addc_u32 s61, s59, 0
    s_sub_u32 s60, s60, s39
    s_subb_u32 s61, s61, 0
    s_mov_b32 s62, 0x200000
    s_mov_b32 s63, 0x20000
    v_and_b32 v4, 15, v0
    v_lshrrev_b32 v5, 1, v4
    v_xor_b32 v5, v5, v3
    v_lshlrev_b32 v5, 4, v5
    v_lshl_add_u32 v248, v4, 7, v5
    v_xor_b32 v249, 64, v248
    s_bitcmp1_b32 s56, 0
    s_cbranch_scc1 L_oddB
    s_lshr_b32 s46, s56, 3
    s_bfe_u32 s47, s56, 0x10001
    s_lshl1_add_u32 s64, s46, s47
    s_bfe_u32 s47, s56, 0x10002
    s_lshl_b32 s47, s47, 6
    s_add_u32 s64, s64, s47
    s_and_b32 s3, s56, 1
    s_lshl_b32 s3, s3, 30
    s_and_b32 s46, s64, 15
    s_lshr_b32 s47, s46, 1
    s_lshl_b32 s42, s47, 13
    s_and_b32 s47, s46, 1
    s_lshl_b32 s47, s47, 10
    s_add_u32 s42, s42, s47
    s_lshl_b32 s43, s46, 15
    s_lshl_b32 s48, s53, 13
    s_add_u32 s43, s43, s48
    s_lshl_b32 s48, s53, 11
    s_add_u32 s97, s42, s48
    s_lshr_b32 s47, s64, 4
    s_lshl_b32 s48, s47, 16
    s_add_u32 s97, s97, s48
    s_add_u32 s97, s97, 786432
    s_lshl_b32 s48, s47, 7
    s_add_u32 s43, s43, s48
    s_lshl_b32 s65, s46, 16
    s_and_b32 s47, s53, 1
    s_lshl_b32 s48, s47, 15
    s_add_u32 s65, s65, s48
    s_lshl_b32 s48, s47, 11
    s_add_u32 s42, s42, s48
    s_lshr_b32 s47, s53, 1
    s_lshl_b32 s48, s47, 13
    s_add_u32 s65, s65, s48
    s_lshl_b32 s48, s47, 16
    s_add_u32 s42, s42, s48
    s_bfe_u32 s47, s64, 0x10004
    s_lshl_b32 s48, s47, 10
    s_add_u32 s65, s65, s48
    s_lshl_b32 s48, s47, 12
    s_add_u32 s42, s42, s48
    s_lshr_b32 s47, s64, 5
    s_lshl_b32 s48, s47, 7
    s_add_u32 s65, s65, s48
    s_add_u32 s65, s65, 256
    s_lshl_b32 s48, s47, 17
    s_add_u32 s42, s42, s48
    s_cmp_lt_u32 s64, 64
    s_cselect_b32 s47, s3, 1073741824
    s_xor_b32 s48, s3, 0
    s_add_u32 s46, s3, 256
    v_lshlrev_b32 v27, 4, v13
    v_lshl_add_u32 v44, v12, 10, v27
    v_add_u32 v44, s48, v44
    v_and_b32 v28, 3, v12
    v_lshrrev_b32 v26, 2, v12
    v_lshl_add_u32 v26, v26, 3, v28
    v_lshl_add_u32 v26, v26, 11, v27
    v_add_u32 v42, s46, v26
    v_add_u32 v43, s47, v26
    s_add_u32 s46, s3, 262144
    v_lshl_add_u32 v45, v0, 4, s46
    v_lshl_add_u32 v46, v0, 4, s47
    v_lshl_add_u32 v47, v0, 4, s48
    v_lshrrev_b32 v26, 2, v0
    v_lshlrev_b32 v26, 7, v26
    s_lshl_b32 s47, s53, 3
    s_add_u32 s47, s47, 114688
    v_lshl_add_u32 v27, v2, 5, v26
    v_add_u32 v27, s47, v27
    s_lshl_b32 s47, s53, 5
    s_add_u32 s47, s47, 114688
    v_lshl_add_u32 v26, v2, 3, v26
    v_add_u32 v26, s47, v26
    s_mov_b32 s20, s80
    s_mov_b32 s21, s81
    s_mov_b32 s22, 5120
    s_mov_b32 s23, 0x20000
    s_lshl_b32 s47, s53, 28
    s_add_u32 s47, s47, s3
    s_lshl3_add_u32 s48, s64, s47
    v_bfe_u32 v37, v0, 2, 2
    v_lshlrev_b32 v38, 1, v2
    v_sub_u32 v37, v38, v37
    v_lshl_add_u32 v37, v37, 10, s48
    v_lshl_add_u32 v37, v3, 1, v37
    v_add_u32 v38, 1024, v37
    s_lshl_b32 s48, s64, 8
    s_add_u32 s47, s47, s48
    s_add_u32 s47, s47, 1310720
    v_lshl_add_u32 v41, v0, 2, s47
    s_lshl_b32 s47, s53, 10
    s_add_u32 m0, s47, 114688
    buffer_load_ushort v48, v37, s[20:23], 0 offen
    buffer_load_dwordx4 v42, s[8:11], s65 offen nt lds
    s_add_u32 m0, m0, 4096
    buffer_load_ushort v49, v38, s[20:23], 0 offen
    buffer_load_dwordx4 v43, s[8:11], s65 offen nt lds
    s_add_u32 m0, m0, 4096
    s_lshl_b32 s46, s53, 11
    s_add_u32 s46, s46, 1310720
    s_add_u32 s20, s58, s46
    s_addc_u32 s21, s59, 0
    s_mov_b32 s22, 32768
    s_mov_b32 s23, 0x20000
    buffer_load_dwordx4 v44, s[12:15], s43 offen nt lds
    s_mov_b32 s12, s58
    s_mov_b32 s13, s59
    s_mov_b32 s14, 1343488
    s_mov_b32 s15, 0x20000
    s_barrier
    s_movk_i32 s46, 128
    s_add_u32 m0, s49, 16384
    s_nop 0
    buffer_load_dwordx4 v16, s[4:7], s46 offen nt lds
    s_add_u32 m0, s49, 17408
    s_nop 0
    buffer_load_dwordx4 v17, s[4:7], s46 offen nt lds
    s_add_u32 m0, s49, 18432
    s_nop 0
    buffer_load_dwordx4 v18, s[4:7], s46 offen nt lds
    s_add_u32 m0, s49, 19456
    s_nop 0
    buffer_load_dwordx4 v19, s[4:7], s46 offen nt lds
    s_waitcnt vmcnt(11)
    s_barrier
    s_branch L_roleB
L_oddB:
    s_lshl_b32 s46, s53, 11
    s_add_u32 s46, s46, 1310720
    s_add_u32 s20, s58, s46
    s_addc_u32 s21, s59, 0
    s_mov_b32 s22, 32768
    s_mov_b32 s23, 0x20000
    s_barrier
    s_movk_i32 s46, 128
    s_add_u32 m0, s49, 16384
    s_nop 0
    buffer_load_dwordx4 v16, s[4:7], s46 offen nt lds
    s_add_u32 m0, s49, 17408
    s_nop 0
    buffer_load_dwordx4 v17, s[4:7], s46 offen nt lds
    s_add_u32 m0, s49, 18432
    s_nop 0
    buffer_load_dwordx4 v18, s[4:7], s46 offen nt lds
    s_add_u32 m0, s49, 19456
    s_nop 0
    buffer_load_dwordx4 v19, s[4:7], s46 offen nt lds
    s_waitcnt vmcnt(6)
    s_barrier
    s_barrier
    s_movk_i32 s46, 256
    s_add_u32 m0, s49, 32768
    s_nop 0
    buffer_load_dwordx4 v16, s[4:7], s46 offen nt lds
    s_add_u32 m0, s49, 33792
    s_nop 0
    buffer_load_dwordx4 v17, s[4:7], s46 offen nt lds
    s_add_u32 m0, s49, 34816
    s_nop 0
    buffer_load_dwordx4 v18, s[4:7], s46 offen nt lds
    s_add_u32 m0, s49, 35840
    s_nop 0
    buffer_load_dwordx4 v19, s[4:7], s46 offen nt lds
    s_and_b32 s57, s54, 0xfc
    s_lshl_b32 s47, s53, 10
    v_lshlrev_b32 v21, 4, v0
    v_mov_b32 v52, -1
    v_mov_b32 v53, -1
    v_mov_b32 v54, -1
    v_mov_b32 v55, -1
    buffer_store_dwordx4 v[52:55], v21, s[24:27], s47 offen sc0 sc1
    s_waitcnt vmcnt(5)
    s_barrier
    s_barrier
    s_movk_i32 s46, 384
    s_add_u32 m0, s49, 49152
    s_nop 0
    buffer_load_dwordx4 v16, s[4:7], s46 offen nt lds
    s_add_u32 m0, s49, 50176
    s_nop 0
    buffer_load_dwordx4 v17, s[4:7], s46 offen nt lds
    s_add_u32 m0, s49, 51200
    s_nop 0
    buffer_load_dwordx4 v18, s[4:7], s46 offen nt lds
    s_add_u32 m0, s49, 52224
    s_nop 0
    buffer_load_dwordx4 v19, s[4:7], s46 offen nt lds
    s_waitcnt vmcnt(4)
    s_barrier
    s_branch L_ann
L_notile:
    s_cmp_lt_u32 s52, 4
    s_cbranch_scc1 L_end
    s_waitcnt lgkmcnt(0)
    s_mov_b32 s8, s78
    s_mov_b32 s9, s79
    s_mov_b32 s10, 1048576
    s_mov_b32 s11, 0x20000
    s_getpc_b64 s[16:17]
L_pcn:
    s_mov_b32 s18, L_code_end-L_pc
    s_sub_u32 s16, s16, L_pcn-L_pc
    s_subb_u32 s17, s17, 0
    s_mov_b32 s19, 0x20000
    s_lshr_b32 s47, s56, 3
    s_lshl2_add_u32 s96, s47, s53
    v_lshrrev_b32 v6, 1, v0
    v_lshlrev_b32 v6, 10, v6
    v_and_b32 v7, 1, v0
    v_lshl_add_u32 v6, v7, 7, v6
    v_lshrrev_b32 v7, 4, v0
    s_lshl_b32 s48, s53, 15
    s_add_u32 s48, s48, 131072
    buffer_load_dword v11, v6, s[8:11], s48 offen
    s_lshl_b32 s48, s96, 7
    v_lshlrev_b32 v7, 14, v0
    buffer_load_dword v9, v7, s[16:19], s48 offen
    s_lshl_b32 s48, s53, 15
    s_add_u32 s48, s48, 262144
    buffer_load_dword v12, v6, s[8:11], s48 offen
    s_lshl_b32 s48, s53, 15
    s_add_u32 s48, s48, 393216
    buffer_load_dword v13, v6, s[8:11], s48 offen
    s_lshl_b32 s48, s53, 15
    s_add_u32 s48, s48, 524288
    buffer_load_dword v14, v6, s[8:11], s48 offen
    s_lshl_b32 s48, s53, 15
    s_add_u32 s48, s48, 655360
    buffer_load_dword v15, v6, s[8:11], s48 offen
    s_lshl_b32 s48, s53, 15
    s_add_u32 s48, s48, 786432
    buffer_load_dword v16, v6, s[8:11], s48 offen
    s_lshl_b32 s48, s53, 15
    s_add_u32 s48, s48, 917504
    buffer_load_dword v17, v6, s[8:11], s48 offen
    s_endpgm
L_A2:
    s_add_u32 s16, s84, s2
    s_addc_u32 s17, s85, 0
    s_sub_u32 s18, 16384000, s55
    s_min_u32 s18, s18, s50
    s_mov_b32 s19, 0x20000
    s_lshl_b32 s46, s54, 12
    s_add_u32 s24, s88, s46
    s_addc_u32 s25, s89, 0
    s_and_b32 s46, s54, 63
    s_cselect_b32 s46, 1, 2
    s_sub_u32 s47, s54, s46
    s_lshl_b32 s46, s46, 12
    s_sub_u32 s32, s24, s46
    s_subb_u32 s33, s25, 0
    s_movk_i32 s46, 4096
    s_bitcmp1_b32 s47, 5
    s_cselect_b32 s34, 2048, s46
    s_cmp_eq_u32 s55, 0
    s_cselect_b32 s34, 0, s34
    s_bitcmp1_b32 s54, 5
    s_cselect_b32 s26, 2048, s46
    s_cmp_lt_u32 s18, s50
    s_cselect_b32 s26, 0, s26
    s_mov_b32 s27, 0x20000
    s_mov_b32 s35, 0x20000
    s_mov_b32 s50, 0xbfb8aa3b
    s_mov_b32 s51, 0xbf317218
    s_lshl_b32 s38, s53, 7
    v_lshrrev_b32 v3, 4, v0
    v_lshlrev_b32 v251, 4, v3
    v_bfe_u32 v5, v0, 2, 2
    v_xor_b32 v24, v5, v3
    v_lshlrev_b32 v24, 24, v24
    v_lshl_add_u32 v24, v5, 8, v24
    v_lshl_add_u32 v252, v2, 4, v24
    v_and_b32 v25, 15, v0
    s_sub_u32 s46, s34, 2048
    v_lshlrev_b32 v24, 11, v25
    v_sub_u32 v24, s46, v24
    v_min_u32 v24, 2130706432, v24
    v_add_u32 v254, v24, v251
    v_add_u32 v25, 1, v25
    v_lshrrev_b32 v25, 4, v25
    v_xor_b32 v25, 1, v25
    v_lshl_add_u32 v251, v25, 11, v251
    v_mov_b32 v253, -2
    s_lshr_b32 s46, s53, 1
    s_lshl_b32 s46, s46, 14
    s_and_b32 s47, s53, 1
    s_lshl_b32 s47, s47, 10
    s_add_u32 s39, s46, s47
    s_add_u32 s39, s39, 32768
    v_lshl_add_u32 v250, v0, 4, s39
    s_add_u32 s58, s88, 1048576
    s_addc_u32 s59, s89, 0
    s_lshl_b32 s46, s53, 16
    s_add_u32 s60, s58, s46
    s_addc_u32 s61, s59, 0
    s_sub_u32 s60, s60, s39
    s_subb_u32 s61, s61, 0
    s_mov_b32 s62, 0x200000
    s_mov_b32 s63, 0x20000
    v_bfe_u32 v4, v0, 4, 1
    v_bfe_u32 v5, v0, 2, 2
    v_lshl_add_u32 v242, v3, 9, s44
    v_lshl_add_u32 v242, v5, 6, v242
    v_lshl_add_u32 v242, v4, 5, v242
    v_lshl_add_u32 v242, v2, 3, v242
    v_xor_b32 v243, 32, v242
    v_and_b32 v4, 15, v0
    v_lshrrev_b32 v5, 1, v4
    v_xor_b32 v5, v5, v3
    v_lshlrev_b32 v5, 4, v5
    v_lshl_add_u32 v248, v4, 7, v5
    v_xor_b32 v249, 64, v248
    s_lshl_b32 s46, s53, 11
    s_add_u32 s46, s46, 1310720
    s_add_u32 s20, s58, s46
    s_addc_u32 s21, s59, 0
    s_mov_b32 s22, 32768
    s_mov_b32 s23, 0x20000
    s_barrier
    s_waitcnt vmcnt(0)
    s_waitcnt lgkmcnt(0)
    s_barrier
    ds_read_b64_tr_b16 v[160:161], v242 offset:0
    ds_read_b64_tr_b16 v[162:163], v242 offset:256
    ds_read_b64_tr_b16 v[164:165], v242 offset:2048
    ds_read_b64_tr_b16 v[166:167], v242 offset:2304
    ds_read_b64_tr_b16 v[168:169], v243 offset:0
    ds_read_b64_tr_b16 v[170:171], v243 offset:256
    ds_read_b64_tr_b16 v[172:173], v243 offset:2048
    ds_read_b64_tr_b16 v[174:175], v243 offset:2304
    ds_read_b128 v[208:211], v248 offset:0
    ds_read_b128 v[212:215], v249 offset:0
    ds_read_b128 v[216:219], v248 offset:2048
    ds_read_b128 v[220:223], v249 offset:2048
    ds_read_b64_tr_b16 v[200:201], v243 offset:4096
    ds_read_b64_tr_b16 v[202:203], v243 offset:4352
    ds_read_b64_tr_b16 v[204:205], v243 offset:6144
    s_waitcnt lgkmcnt(11)
    ds_read_b64_tr_b16 v[206:207], v243 offset:6400
    ds_read_b64_tr_b16 v[192:193], v242 offset:4096
    ds_read_b64_tr_b16 v[194:195], v242 offset:4352
    ds_read_b64_tr_b16 v[196:197], v242 offset:6144
    s_waitcnt lgkmcnt(11)
    ds_read_b64_tr_b16 v[198:199], v242 offset:6400
    v_add_u32 v240, 131072, v244
    s_mov_b32 m0, s44
    s_nop 0
    buffer_load_dwordx4 v240, s[8:11], s66 offen offset:0  lds
    buffer_load_dwordx4 v240, s[8:11], s67 offen offset:1024  lds
    buffer_load_dwordx4 v240, s[8:11], s68 offen offset:2048  lds
    buffer_load_dwordx4 v240, s[8:11], s69 offen offset:3072  lds
    s_mov_b32 m0, s45
    s_waitcnt lgkmcnt(11)
    v_mfma_f32_16x16x32_bf16 v[0:3], v[160:163], v[208:211], 0
    ds_read_b128 v[224:227], v248 offset:4096
    s_waitcnt lgkmcnt(11)
    v_mfma_f32_16x16x32_bf16 v[0:3], v[164:167], v[212:215], v[0:3]
    ds_read_b128 v[228:231], v249 offset:4096
    v_mfma_f32_16x16x32_bf16 v[32:35], v[168:171], v[208:211], 0
    s_waitcnt lgkmcnt(2)
    v_mfma_f32_16x16x32_bf16 v[32:35], v[172:175], v[212:215], v[32:35]
    buffer_load_dwordx4 v240, s[8:11], s70 offen offset:0  lds
    v_mfma_f32_16x16x32_bf16 v[36:39], v[168:171], v[216:219], 0
    ds_read_b128 v[232:235], v248 offset:6144
    v_mfma_f32_16x16x32_bf16 v[36:39], v[172:175], v[220:223], v[36:39]
    ds_read_b128 v[236:239], v249 offset:6144
    v_mfma_f32_16x16x32_bf16 v[4:7], v[160:163], v[216:219], 0
    v_mfma_f32_16x16x32_bf16 v[4:7], v[164:167], v[220:223], v[4:7]
    buffer_load_dwordx4 v240, s[8:11], s71 offen offset:1024  lds
    v_mfma_f32_16x16x32_bf16 v[68:71], v[192:195], v[216:219], 0
    v_mfma_f32_16x16x32_bf16 v[68:71], v[196:199], v[220:223], v[68:71]
    v_mfma_f32_16x16x32_bf16 v[100:103], v[200:203], v[216:219], 0
    v_mfma_f32_16x16x32_bf16 v[100:103], v[204:207], v[220:223], v[100:103]
    buffer_load_dwordx4 v240, s[8:11], s72 offen offset:2048  lds
    v_mfma_f32_16x16x32_bf16 v[96:99], v[200:203], v[208:211], 0
    v_mfma_f32_16x16x32_bf16 v[96:99], v[204:207], v[212:215], v[96:99]
    s_setprio 2
    v_mfma_f32_16x16x32_bf16 v[64:67], v[192:195], v[208:211], 0
    buffer_load_dwordx4 v240, s[8:11], s73 offen offset:3072  lds
    v_mfma_f32_16x16x32_bf16 v[64:67], v[196:199], v[212:215], v[64:67]
    s_waitcnt lgkmcnt(0)
    s_barrier
    v_mfma_f32_16x16x32_bf16 v[72:75], v[192:195], v[224:227], 0
    ds_read_b128 v[208:211], v248 offset:8192
    v_mfma_f32_16x16x32_bf16 v[72:75], v[196:199], v[228:231], v[72:75]
    ds_read_b128 v[212:215], v249 offset:8192
    v_mfma_f32_16x16x32_bf16 v[104:107], v[200:203], v[224:227], 0
    ds_read_b128 v[216:219], v248 offset:10240
    v_mfma_f32_16x16x32_bf16 v[104:107], v[204:207], v[228:231], v[104:107]
    ds_read_b128 v[220:223], v249 offset:10240
    v_mfma_f32_16x16x32_bf16 v[108:111], v[200:203], v[232:235], 0
    v_mfma_f32_16x16x32_bf16 v[108:111], v[204:207], v[236:239], v[108:111]
    v_mfma_f32_16x16x32_bf16 v[76:79], v[192:195], v[232:235], 0
    v_mfma_f32_16x16x32_bf16 v[76:79], v[196:199], v[236:239], v[76:79]
    v_mfma_f32_16x16x32_bf16 v[12:15], v[160:163], v[232:235], 0
    v_mfma_f32_16x16x32_bf16 v[12:15], v[164:167], v[236:239], v[12:15]
    v_mfma_f32_16x16x32_bf16 v[44:47], v[168:171], v[232:235], 0
    v_mfma_f32_16x16x32_bf16 v[44:47], v[172:175], v[236:239], v[44:47]
    v_mfma_f32_16x16x32_bf16 v[40:43], v[168:171], v[224:227], 0
    v_mfma_f32_16x16x32_bf16 v[40:43], v[172:175], v[228:231], v[40:43]
    v_mfma_f32_16x16x32_bf16 v[8:11], v[160:163], v[224:227], 0
    v_mfma_f32_16x16x32_bf16 v[8:11], v[164:167], v[228:231], v[8:11]
    s_waitcnt lgkmcnt(0)
    v_mfma_f32_16x16x32_bf16 v[16:19], v[160:163], v[208:211], 0
    ds_read_b128 v[224:227], v248 offset:12288
    v_mfma_f32_16x16x32_bf16 v[16:19], v[164:167], v[212:215], v[16:19]
    ds_read_b128 v[228:231], v249 offset:12288
    v_mfma_f32_16x16x32_bf16 v[48:51], v[168:171], v[208:211], 0
    ds_read_b128 v[232:235], v248 offset:14336
    v_mfma_f32_16x16x32_bf16 v[48:51], v[172:175], v[212:215], v[48:51]
    ds_read_b128 v[236:239], v249 offset:14336
    v_mfma_f32_16x16x32_bf16 v[52:55], v[168:171], v[216:219], 0
    s_waitcnt vmcnt(4)
    v_mfma_f32_16x16x32_bf16 v[52:55], v[172:175], v[220:223], v[52:55]
    ds_read_b64_tr_b16 v[176:177], v242 offset:0
    v_mfma_f32_16x16x32_bf16 v[20:23], v[160:163], v[216:219], 0
    ds_read_b64_tr_b16 v[178:179], v242 offset:256
    v_mfma_f32_16x16x32_bf16 v[20:23], v[164:167], v[220:223], v[20:23]
    ds_read_b64_tr_b16 v[180:181], v242 offset:2048
    v_mfma_f32_16x16x32_bf16 v[84:87], v[192:195], v[216:219], 0
    ds_read_b64_tr_b16 v[182:183], v242 offset:2304
    v_mfma_f32_16x16x32_bf16 v[84:87], v[196:199], v[220:223], v[84:87]
    ds_read_b64_tr_b16 v[184:185], v243 offset:0
    v_mfma_f32_16x16x32_bf16 v[116:119], v[200:203], v[216:219], 0
    ds_read_b64_tr_b16 v[186:187], v243 offset:256
    v_mfma_f32_16x16x32_bf16 v[116:119], v[204:207], v[220:223], v[116:119]
    ds_read_b64_tr_b16 v[188:189], v243 offset:2048
    v_mfma_f32_16x16x32_bf16 v[112:115], v[200:203], v[208:211], 0
    ds_read_b64_tr_b16 v[190:191], v243 offset:2304
    v_mfma_f32_16x16x32_bf16 v[112:115], v[204:207], v[212:215], v[112:115]
    v_add_u32 v240, 262144, v244
    v_mfma_f32_16x16x32_bf16 v[80:83], v[192:195], v[208:211], 0
    s_mov_b32 m0, s44
    v_mfma_f32_16x16x32_bf16 v[80:83], v[196:199], v[212:215], v[80:83]
    s_waitcnt lgkmcnt(8)
    v_mfma_f32_16x16x32_bf16 v[88:91], v[192:195], v[224:227], 0
    s_barrier
    ds_read_b128 v[208:211], v248 offset:16384
    v_mfma_f32_16x16x32_bf16 v[88:91], v[196:199], v[228:231], v[88:91]
    ds_read_b128 v[212:215], v249 offset:16384
    s_waitcnt lgkmcnt(2)
    v_mfma_f32_16x16x32_bf16 v[120:123], v[200:203], v[224:227], 0
    ds_read_b128 v[216:219], v248 offset:18432
    buffer_load_dwordx4 v240, s[8:11], s66 offen offset:0  lds
    v_mfma_f32_16x16x32_bf16 v[120:123], v[204:207], v[228:231], v[120:123]
    ds_read_b128 v[220:223], v249 offset:18432
    v_mfma_f32_16x16x32_bf16 v[124:127], v[200:203], v[232:235], 0
    s_waitcnt vmcnt(1)
    v_mfma_f32_16x16x32_bf16 v[124:127], v[204:207], v[236:239], v[124:127]
    ds_read_b64_tr_b16 v[200:201], v243 offset:4096
    v_mfma_f32_16x16x32_bf16 v[92:95], v[192:195], v[232:235], 0
    ds_read_b64_tr_b16 v[202:203], v243 offset:4352
    buffer_load_dwordx4 v240, s[8:11], s67 offen offset:1024  lds
    v_mfma_f32_16x16x32_bf16 v[92:95], v[196:199], v[236:239], v[92:95]
    ds_read_b64_tr_b16 v[204:205], v243 offset:6144
    v_mfma_f32_16x16x32_bf16 v[28:31], v[160:163], v[232:235], 0
    ds_read_b64_tr_b16 v[206:207], v243 offset:6400
    v_mfma_f32_16x16x32_bf16 v[28:31], v[164:167], v[236:239], v[28:31]
    ds_read_b64_tr_b16 v[192:193], v242 offset:4096
    v_mfma_f32_16x16x32_bf16 v[60:63], v[168:171], v[232:235], 0
    ds_read_b64_tr_b16 v[194:195], v242 offset:4352
    buffer_load_dwordx4 v240, s[8:11], s68 offen offset:2048  lds
    v_mfma_f32_16x16x32_bf16 v[60:63], v[172:175], v[236:239], v[60:63]
    ds_read_b64_tr_b16 v[196:197], v242 offset:6144
    v_mfma_f32_16x16x32_bf16 v[56:59], v[168:171], v[224:227], 0
    ds_read_b64_tr_b16 v[198:199], v242 offset:6400
    v_mfma_f32_16x16x32_bf16 v[56:59], v[172:175], v[228:231], v[56:59]
    buffer_load_dwordx4 v240, s[8:11], s69 offen offset:3072  lds
    v_mfma_f32_16x16x32_bf16 v[24:27], v[160:163], v[224:227], 0
    s_mov_b32 m0, s45
    v_mfma_f32_16x16x32_bf16 v[24:27], v[164:167], v[228:231], v[24:27]
    s_waitcnt lgkmcnt(8)
    v_mfma_f32_16x16x32_bf16 v[0:3], v[176:179], v[208:211], v[0:3]
    ds_read_b128 v[224:227], v248 offset:20480
    v_mfma_f32_16x16x32_bf16 v[0:3], v[180:183], v[212:215], v[0:3]
    ds_read_b128 v[228:231], v249 offset:20480
    v_mfma_f32_16x16x32_bf16 v[32:35], v[184:187], v[208:211], v[32:35]
    s_waitcnt lgkmcnt(2)
    v_mfma_f32_16x16x32_bf16 v[32:35], v[188:191], v[212:215], v[32:35]
    buffer_load_dwordx4 v240, s[8:11], s70 offen offset:0  lds
    v_mfma_f32_16x16x32_bf16 v[36:39], v[184:187], v[216:219], v[36:39]
    ds_read_b128 v[232:235], v248 offset:22528
    v_mfma_f32_16x16x32_bf16 v[36:39], v[188:191], v[220:223], v[36:39]
    ds_read_b128 v[236:239], v249 offset:22528
    v_mfma_f32_16x16x32_bf16 v[4:7], v[176:179], v[216:219], v[4:7]
    v_mfma_f32_16x16x32_bf16 v[4:7], v[180:183], v[220:223], v[4:7]
    buffer_load_dwordx4 v240, s[8:11], s71 offen offset:1024  lds
    v_mfma_f32_16x16x32_bf16 v[68:71], v[192:195], v[216:219], v[68:71]
    v_mfma_f32_16x16x32_bf16 v[68:71], v[196:199], v[220:223], v[68:71]
    v_mfma_f32_16x16x32_bf16 v[100:103], v[200:203], v[216:219], v[100:103]
    v_mfma_f32_16x16x32_bf16 v[100:103], v[204:207], v[220:223], v[100:103]
    buffer_load_dwordx4 v240, s[8:11], s72 offen offset:2048  lds
    v_mfma_f32_16x16x32_bf16 v[96:99], v[200:203], v[208:211], v[96:99]
    v_mfma_f32_16x16x32_bf16 v[96:99], v[204:207], v[212:215], v[96:99]
    v_mfma_f32_16x16x32_bf16 v[64:67], v[192:195], v[208:211], v[64:67]
    buffer_load_dwordx4 v240, s[8:11], s73 offen offset:3072  lds
    v_mfma_f32_16x16x32_bf16 v[64:67], v[196:199], v[212:215], v[64:67]
    s_waitcnt lgkmcnt(0)
    s_barrier
    v_mfma_f32_16x16x32_bf16 v[72:75], v[192:195], v[224:227], v[72:75]
    ds_read_b128 v[208:211], v248 offset:24576
    v_mfma_f32_16x16x32_bf16 v[72:75], v[196:199], v[228:231], v[72:75]
    ds_read_b128 v[212:215], v249 offset:24576
    v_mfma_f32_16x16x32_bf16 v[104:107], v[200:203], v[224:227], v[104:107]
    ds_read_b128 v[216:219], v248 offset:26624
    v_mfma_f32_16x16x32_bf16 v[104:107], v[204:207], v[228:231], v[104:107]
    ds_read_b128 v[220:223], v249 offset:26624
    v_mfma_f32_16x16x32_bf16 v[108:111], v[200:203], v[232:235], v[108:111]
    v_mfma_f32_16x16x32_bf16 v[108:111], v[204:207], v[236:239], v[108:111]
    v_mfma_f32_16x16x32_bf16 v[76:79], v[192:195], v[232:235], v[76:79]
    v_mfma_f32_16x16x32_bf16 v[76:79], v[196:199], v[236:239], v[76:79]
    v_mfma_f32_16x16x32_bf16 v[12:15], v[176:179], v[232:235], v[12:15]
    v_mfma_f32_16x16x32_bf16 v[12:15], v[180:183], v[236:239], v[12:15]
    v_mfma_f32_16x16x32_bf16 v[44:47], v[184:187], v[232:235], v[44:47]
    v_mfma_f32_16x16x32_bf16 v[44:47], v[188:191], v[236:239], v[44:47]
    v_mfma_f32_16x16x32_bf16 v[40:43], v[184:187], v[224:227], v[40:43]
    v_mfma_f32_16x16x32_bf16 v[40:43], v[188:191], v[228:231], v[40:43]
    v_mfma_f32_16x16x32_bf16 v[8:11], v[176:179], v[224:227], v[8:11]
    v_mfma_f32_16x16x32_bf16 v[8:11], v[180:183], v[228:231], v[8:11]
    s_waitcnt lgkmcnt(0)
    v_mfma_f32_16x16x32_bf16 v[16:19], v[176:179], v[208:211], v[16:19]
    ds_read_b128 v[224:227], v248 offset:28672
    v_mfma_f32_16x16x32_bf16 v[16:19], v[180:183], v[212:215], v[16:19]
    ds_read_b128 v[228:231], v249 offset:28672
    v_mfma_f32_16x16x32_bf16 v[48:51], v[184:187], v[208:211], v[48:51]
    ds_read_b128 v[232:235], v248 offset:30720
    v_mfma_f32_16x16x32_bf16 v[48:51], v[188:191], v[212:215], v[48:51]
    ds_read_b128 v[236:239], v249 offset:30720
    v_mfma_f32_16x16x32_bf16 v[52:55], v[184:187], v[216:219], v[52:55]
    s_waitcnt vmcnt(4)
    v_mfma_f32_16x16x32_bf16 v[52:55], v[188:191], v[220:223], v[52:55]
    ds_read_b64_tr_b16 v[160:161], v242 offset:0
    v_mfma_f32_16x16x32_bf16 v[20:23], v[176:179], v[216:219], v[20:23]
    ds_read_b64_tr_b16 v[162:163], v242 offset:256
    v_mfma_f32_16x16x32_bf16 v[20:23], v[180:183], v[220:223], v[20:23]
    ds_read_b64_tr_b16 v[164:165], v242 offset:2048
    v_mfma_f32_16x16x32_bf16 v[84:87], v[192:195], v[216:219], v[84:87]
    ds_read_b64_tr_b16 v[166:167], v242 offset:2304
    v_mfma_f32_16x16x32_bf16 v[84:87], v[196:199], v[220:223], v[84:87]
    ds_read_b64_tr_b16 v[168:169], v243 offset:0
    v_mfma_f32_16x16x32_bf16 v[116:119], v[200:203], v[216:219], v[116:119]
    ds_read_b64_tr_b16 v[170:171], v243 offset:256
    v_mfma_f32_16x16x32_bf16 v[116:119], v[204:207], v[220:223], v[116:119]
    ds_read_b64_tr_b16 v[172:173], v243 offset:2048
    v_mfma_f32_16x16x32_bf16 v[112:115], v[200:203], v[208:211], v[112:115]
    ds_read_b64_tr_b16 v[174:175], v243 offset:2304
    v_mfma_f32_16x16x32_bf16 v[112:115], v[204:207], v[212:215], v[112:115]
    v_add_u32 v240, 393216, v244
    v_mfma_f32_16x16x32_bf16 v[80:83], v[192:195], v[208:211], v[80:83]
    s_mov_b32 m0, s44
    v_mfma_f32_16x16x32_bf16 v[80:83], v[196:199], v[212:215], v[80:83]
    s_waitcnt lgkmcnt(8)
    v_mfma_f32_16x16x32_bf16 v[88:91], v[192:195], v[224:227], v[88:91]
    s_barrier
    ds_read_b128 v[208:211], v248 offset:32768
    v_mfma_f32_16x16x32_bf16 v[88:91], v[196:199], v[228:231], v[88:91]
    ds_read_b128 v[212:215], v249 offset:32768
    s_waitcnt lgkmcnt(2)
    v_mfma_f32_16x16x32_bf16 v[120:123], v[200:203], v[224:227], v[120:123]
    ds_read_b128 v[216:219], v248 offset:34816
    buffer_load_dwordx4 v240, s[8:11], s66 offen offset:0  lds
    v_mfma_f32_16x16x32_bf16 v[120:123], v[204:207], v[228:231], v[120:123]
    ds_read_b128 v[220:223], v249 offset:34816
    v_mfma_f32_16x16x32_bf16 v[124:127], v[200:203], v[232:235], v[124:127]
    s_waitcnt vmcnt(1)
    v_mfma_f32_16x16x32_bf16 v[124:127], v[204:207], v[236:239], v[124:127]
    ds_read_b64_tr_b16 v[200:201], v243 offset:4096
    v_mfma_f32_16x16x32_bf16 v[92:95], v[192:195], v[232:235], v[92:95]
    ds_read_b64_tr_b16 v[202:203], v243 offset:4352
    buffer_load_dwordx4 v240, s[8:11], s67 offen offset:1024  lds
    v_mfma_f32_16x16x32_bf16 v[92:95], v[196:199], v[236:239], v[92:95]
    ds_read_b64_tr_b16 v[204:205], v243 offset:6144
    v_mfma_f32_16x16x32_bf16 v[28:31], v[176:179], v[232:235], v[28:31]
    ds_read_b64_tr_b16 v[206:207], v243 offset:6400
    v_mfma_f32_16x16x32_bf16 v[28:31], v[180:183], v[236:239], v[28:31]
    ds_read_b64_tr_b16 v[192:193], v242 offset:4096
    v_mfma_f32_16x16x32_bf16 v[60:63], v[184:187], v[232:235], v[60:63]
    ds_read_b64_tr_b16 v[194:195], v242 offset:4352
    buffer_load_dwordx4 v240, s[8:11], s68 offen offset:2048  lds
    v_mfma_f32_16x16x32_bf16 v[60:63], v[188:191], v[236:239], v[60:63]
    ds_read_b64_tr_b16 v[196:197], v242 offset:6144
    v_mfma_f32_16x16x32_bf16 v[56:59], v[184:187], v[224:227], v[56:59]
    ds_read_b64_tr_b16 v[198:199], v242 offset:6400
    v_mfma_f32_16x16x32_bf16 v[56:59], v[188:191], v[228:231], v[56:59]
    buffer_load_dwordx4 v240, s[8:11], s69 offen offset:3072  lds
    v_mfma_f32_16x16x32_bf16 v[24:27], v[176:179], v[224:227], v[24:27]
    s_mov_b32 m0, s45
    v_mfma_f32_16x16x32_bf16 v[24:27], v[180:183], v[228:231], v[24:27]
    s_waitcnt lgkmcnt(8)
    v_mfma_f32_16x16x32_bf16 v[0:3], v[160:163], v[208:211], v[0:3]
    ds_read_b128 v[224:227], v248 offset:36864
    v_mfma_f32_16x16x32_bf16 v[0:3], v[164:167], v[212:215], v[0:3]
    ds_read_b128 v[228:231], v249 offset:36864
    v_mfma_f32_16x16x32_bf16 v[32:35], v[168:171], v[208:211], v[32:35]
    s_waitcnt lgkmcnt(2)
    v_mfma_f32_16x16x32_bf16 v[32:35], v[172:175], v[212:215], v[32:35]
    buffer_load_dwordx4 v240, s[8:11], s70 offen offset:0  lds
    v_mfma_f32_16x16x32_bf16 v[36:39], v[168:171], v[216:219], v[36:39]
    ds_read_b128 v[232:235], v248 offset:38912
    v_mfma_f32_16x16x32_bf16 v[36:39], v[172:175], v[220:223], v[36:39]
    ds_read_b128 v[236:239], v249 offset:38912
    v_mfma_f32_16x16x32_bf16 v[4:7], v[160:163], v[216:219], v[4:7]
    v_mfma_f32_16x16x32_bf16 v[4:7], v[164:167], v[220:223], v[4:7]
    buffer_load_dwordx4 v240, s[8:11], s71 offen offset:1024  lds
    v_mfma_f32_16x16x32_bf16 v[68:71], v[192:195], v[216:219], v[68:71]
    v_mfma_f32_16x16x32_bf16 v[68:71], v[196:199], v[220:223], v[68:71]
    v_mfma_f32_16x16x32_bf16 v[100:103], v[200:203], v[216:219], v[100:103]
    v_mfma_f32_16x16x32_bf16 v[100:103], v[204:207], v[220:223], v[100:103]
    buffer_load_dwordx4 v240, s[8:11], s72 offen offset:2048  lds
    v_mfma_f32_16x16x32_bf16 v[96:99], v[200:203], v[208:211], v[96:99]
    v_mfma_f32_16x16x32_bf16 v[96:99], v[204:207], v[212:215], v[96:99]
    v_mfma_f32_16x16x32_bf16 v[64:67], v[192:195], v[208:211], v[64:67]
    buffer_load_dwordx4 v240, s[8:11], s73 offen offset:3072  lds
    v_mfma_f32_16x16x32_bf16 v[64:67], v[196:199], v[212:215], v[64:67]
    s_waitcnt lgkmcnt(0)
    s_barrier
    v_mfma_f32_16x16x32_bf16 v[72:75], v[192:195], v[224:227], v[72:75]
    ds_read_b128 v[208:211], v248 offset:40960
    v_mfma_f32_16x16x32_bf16 v[72:75], v[196:199], v[228:231], v[72:75]
    ds_read_b128 v[212:215], v249 offset:40960
    v_mfma_f32_16x16x32_bf16 v[104:107], v[200:203], v[224:227], v[104:107]
    ds_read_b128 v[216:219], v248 offset:43008
    v_mfma_f32_16x16x32_bf16 v[104:107], v[204:207], v[228:231], v[104:107]
    ds_read_b128 v[220:223], v249 offset:43008
    v_mfma_f32_16x16x32_bf16 v[108:111], v[200:203], v[232:235], v[108:111]
    v_mfma_f32_16x16x32_bf16 v[108:111], v[204:207], v[236:239], v[108:111]
    v_mfma_f32_16x16x32_bf16 v[76:79], v[192:195], v[232:235], v[76:79]
    v_mfma_f32_16x16x32_bf16 v[76:79], v[196:199], v[236:239], v[76:79]
    v_mfma_f32_16x16x32_bf16 v[12:15], v[160:163], v[232:235], v[12:15]
    v_mfma_f32_16x16x32_bf16 v[12:15], v[164:167], v[236:239], v[12:15]
    v_mfma_f32_16x16x32_bf16 v[44:47], v[168:171], v[232:235], v[44:47]
    v_mfma_f32_16x16x32_bf16 v[44:47], v[172:175], v[236:239], v[44:47]
    v_mfma_f32_16x16x32_bf16 v[40:43], v[168:171], v[224:227], v[40:43]
    v_mfma_f32_16x16x32_bf16 v[40:43], v[172:175], v[228:231], v[40:43]
    v_mfma_f32_16x16x32_bf16 v[8:11], v[160:163], v[224:227], v[8:11]
    v_mfma_f32_16x16x32_bf16 v[8:11], v[164:167], v[228:231], v[8:11]
    s_waitcnt lgkmcnt(0)
    v_mfma_f32_16x16x32_bf16 v[16:19], v[160:163], v[208:211], v[16:19]
    ds_read_b128 v[224:227], v248 offset:45056
    v_mfma_f32_16x16x32_bf16 v[16:19], v[164:167], v[212:215], v[16:19]
    ds_read_b128 v[228:231], v249 offset:45056
    v_mfma_f32_16x16x32_bf16 v[48:51], v[168:171], v[208:211], v[48:51]
    ds_read_b128 v[232:235], v248 offset:47104
    v_mfma_f32_16x16x32_bf16 v[48:51], v[172:175], v[212:215], v[48:51]
    ds_read_b128 v[236:239], v249 offset:47104
    v_mfma_f32_16x16x32_bf16 v[52:55], v[168:171], v[216:219], v[52:55]
    s_waitcnt vmcnt(4)
    v_mfma_f32_16x16x32_bf16 v[52:55], v[172:175], v[220:223], v[52:55]
    ds_read_b64_tr_b16 v[176:177], v242 offset:0
    v_mfma_f32_16x16x32_bf16 v[20:23], v[160:163], v[216:219], v[20:23]
    ds_read_b64_tr_b16 v[178:179], v242 offset:256
    v_mfma_f32_16x16x32_bf16 v[20:23], v[164:167], v[220:223], v[20:23]
    ds_read_b64_tr_b16 v[180:181], v242 offset:2048
    v_mfma_f32_16x16x32_bf16 v[84:87], v[192:195], v[216:219], v[84:87]
    ds_read_b64_tr_b16 v[182:183], v242 offset:2304
    v_mfma_f32_16x16x32_bf16 v[84:87], v[196:199], v[220:223], v[84:87]
    ds_read_b64_tr_b16 v[184:185], v243 offset:0
    v_mfma_f32_16x16x32_bf16 v[116:119], v[200:203], v[216:219], v[116:119]
    ds_read_b64_tr_b16 v[186:187], v243 offset:256
    v_mfma_f32_16x16x32_bf16 v[116:119], v[204:207], v[220:223], v[116:119]
    ds_read_b64_tr_b16 v[188:189], v243 offset:2048
    v_mfma_f32_16x16x32_bf16 v[112:115], v[200:203], v[208:211], v[112:115]
    ds_read_b64_tr_b16 v[190:191], v243 offset:2304
    v_mfma_f32_16x16x32_bf16 v[112:115], v[204:207], v[212:215], v[112:115]
    v_add_u32 v240, 524288, v244
    v_mfma_f32_16x16x32_bf16 v[80:83], v[192:195], v[208:211], v[80:83]
    s_mov_b32 m0, s44
    v_mfma_f32_16x16x32_bf16 v[80:83], v[196:199], v[212:215], v[80:83]
    s_waitcnt lgkmcnt(8)
    v_mfma_f32_16x16x32_bf16 v[88:91], v[192:195], v[224:227], v[88:91]
    s_barrier
    ds_read_b128 v[208:211], v248 offset:49152
    v_mfma_f32_16x16x32_bf16 v[88:91], v[196:199], v[228:231], v[88:91]
    ds_read_b128 v[212:215], v249 offset:49152
    s_waitcnt lgkmcnt(2)
    v_mfma_f32_16x16x32_bf16 v[120:123], v[200:203], v[224:227], v[120:123]
    ds_read_b128 v[216:219], v248 offset:51200
    buffer_load_dwordx4 v240, s[8:11], s66 offen offset:0  lds
    v_mfma_f32_16x16x32_bf16 v[120:123], v[204:207], v[228:231], v[120:123]
    ds_read_b128 v[220:223], v249 offset:51200
    v_mfma_f32_16x16x32_bf16 v[124:127], v[200:203], v[232:235], v[124:127]
    s_waitcnt vmcnt(1)
    v_mfma_f32_16x16x32_bf16 v[124:127], v[204:207], v[236:239], v[124:127]
    ds_read_b64_tr_b16 v[200:201], v243 offset:4096
    v_mfma_f32_16x16x32_bf16 v[92:95], v[192:195], v[232:235], v[92:95]
    ds_read_b64_tr_b16 v[202:203], v243 offset:4352
    buffer_load_dwordx4 v240, s[8:11], s67 offen offset:1024  lds
    v_mfma_f32_16x16x32_bf16 v[92:95], v[196:199], v[236:239], v[92:95]
    ds_read_b64_tr_b16 v[204:205], v243 offset:6144
    v_mfma_f32_16x16x32_bf16 v[28:31], v[160:163], v[232:235], v[28:31]
    ds_read_b64_tr_b16 v[206:207], v243 offset:6400
    v_mfma_f32_16x16x32_bf16 v[28:31], v[164:167], v[236:239], v[28:31]
    ds_read_b64_tr_b16 v[192:193], v242 offset:4096
    v_mfma_f32_16x16x32_bf16 v[60:63], v[168:171], v[232:235], v[60:63]
    ds_read_b64_tr_b16 v[194:195], v242 offset:4352
    buffer_load_dwordx4 v240, s[8:11], s68 offen offset:2048  lds
    v_mfma_f32_16x16x32_bf16 v[60:63], v[172:175], v[236:239], v[60:63]
    ds_read_b64_tr_b16 v[196:197], v242 offset:6144
    v_mfma_f32_16x16x32_bf16 v[56:59], v[168:171], v[224:227], v[56:59]
    ds_read_b64_tr_b16 v[198:199], v242 offset:6400
    v_mfma_f32_16x16x32_bf16 v[56:59], v[172:175], v[228:231], v[56:59]
    buffer_load_dwordx4 v240, s[8:11], s69 offen offset:3072  lds
    v_mfma_f32_16x16x32_bf16 v[24:27], v[160:163], v[224:227], v[24:27]
    s_mov_b32 m0, s45
    v_mfma_f32_16x16x32_bf16 v[24:27], v[164:167], v[228:231], v[24:27]
    s_waitcnt lgkmcnt(8)
    v_mfma_f32_16x16x32_bf16 v[0:3], v[176:179], v[208:211], v[0:3]
    ds_read_b128 v[224:227], v248 offset:53248
    v_mfma_f32_16x16x32_bf16 v[0:3], v[180:183], v[212:215], v[0:3]
    ds_read_b128 v[228:231], v249 offset:53248
    v_mfma_f32_16x16x32_bf16 v[32:35], v[184:187], v[208:211], v[32:35]
    s_waitcnt lgkmcnt(2)
    v_mfma_f32_16x16x32_bf16 v[32:35], v[188:191], v[212:215], v[32:35]
    buffer_load_dwordx4 v240, s[8:11], s70 offen offset:0  lds
    v_mfma_f32_16x16x32_bf16 v[36:39], v[184:187], v[216:219], v[36:39]
    ds_read_b128 v[232:235], v248 offset:55296
    v_mfma_f32_16x16x32_bf16 v[36:39], v[188:191], v[220:223], v[36:39]
    ds_read_b128 v[236:239], v249 offset:55296
    v_mfma_f32_16x16x32_bf16 v[4:7], v[176:179], v[216:219], v[4:7]
    v_mfma_f32_16x16x32_bf16 v[4:7], v[180:183], v[220:223], v[4:7]
    buffer_load_dwordx4 v240, s[8:11], s71 offen offset:1024  lds
    v_mfma_f32_16x16x32_bf16 v[68:71], v[192:195], v[216:219], v[68:71]
    v_mfma_f32_16x16x32_bf16 v[68:71], v[196:199], v[220:223], v[68:71]
    v_mfma_f32_16x16x32_bf16 v[100:103], v[200:203], v[216:219], v[100:103]
    v_mfma_f32_16x16x32_bf16 v[100:103], v[204:207], v[220:223], v[100:103]
    buffer_load_dwordx4 v240, s[8:11], s72 offen offset:2048  lds
    v_mfma_f32_16x16x32_bf16 v[96:99], v[200:203], v[208:211], v[96:99]
    v_mfma_f32_16x16x32_bf16 v[96:99], v[204:207], v[212:215], v[96:99]
    v_mfma_f32_16x16x32_bf16 v[64:67], v[192:195], v[208:211], v[64:67]
    buffer_load_dwordx4 v240, s[8:11], s73 offen offset:3072  lds
    v_mfma_f32_16x16x32_bf16 v[64:67], v[196:199], v[212:215], v[64:67]
    s_waitcnt lgkmcnt(0)
    s_barrier
    v_mfma_f32_16x16x32_bf16 v[72:75], v[192:195], v[224:227], v[72:75]
    ds_read_b128 v[208:211], v248 offset:57344
    v_mfma_f32_16x16x32_bf16 v[72:75], v[196:199], v[228:231], v[72:75]
    ds_read_b128 v[212:215], v249 offset:57344
    v_mfma_f32_16x16x32_bf16 v[104:107], v[200:203], v[224:227], v[104:107]
    ds_read_b128 v[216:219], v248 offset:59392
    v_mfma_f32_16x16x32_bf16 v[104:107], v[204:207], v[228:231], v[104:107]
    ds_read_b128 v[220:223], v249 offset:59392
    v_mfma_f32_16x16x32_bf16 v[108:111], v[200:203], v[232:235], v[108:111]
    v_mfma_f32_16x16x32_bf16 v[108:111], v[204:207], v[236:239], v[108:111]
    v_mfma_f32_16x16x32_bf16 v[76:79], v[192:195], v[232:235], v[76:79]
    v_mfma_f32_16x16x32_bf16 v[76:79], v[196:199], v[236:239], v[76:79]
    v_mfma_f32_16x16x32_bf16 v[12:15], v[176:179], v[232:235], v[12:15]
    v_mfma_f32_16x16x32_bf16 v[12:15], v[180:183], v[236:239], v[12:15]
    v_mfma_f32_16x16x32_bf16 v[44:47], v[184:187], v[232:235], v[44:47]
    v_mfma_f32_16x16x32_bf16 v[44:47], v[188:191], v[236:239], v[44:47]
    v_mfma_f32_16x16x32_bf16 v[40:43], v[184:187], v[224:227], v[40:43]
    v_mfma_f32_16x16x32_bf16 v[40:43], v[188:191], v[228:231], v[40:43]
    v_mfma_f32_16x16x32_bf16 v[8:11], v[176:179], v[224:227], v[8:11]
    v_mfma_f32_16x16x32_bf16 v[8:11], v[180:183], v[228:231], v[8:11]
    s_waitcnt lgkmcnt(0)
    v_mfma_f32_16x16x32_bf16 v[16:19], v[176:179], v[208:211], v[16:19]
    ds_read_b128 v[224:227], v248 offset:61440
    v_mfma_f32_16x16x32_bf16 v[16:19], v[180:183], v[212:215], v[16:19]
    ds_read_b128 v[228:231], v249 offset:61440
    v_mfma_f32_16x16x32_bf16 v[48:51], v[184:187], v[208:211], v[48:51]
    ds_read_b128 v[232:235], v248 offset:63488
    v_mfma_f32_16x16x32_bf16 v[48:51], v[188:191], v[212:215], v[48:51]
    ds_read_b128 v[236:239], v249 offset:63488
    v_mfma_f32_16x16x32_bf16 v[52:55], v[184:187], v[216:219], v[52:55]
    s_waitcnt vmcnt(4)
    v_mfma_f32_16x16x32_bf16 v[52:55], v[188:191], v[220:223], v[52:55]
    ds_read_b64_tr_b16 v[160:161], v242 offset:0
    v_mfma_f32_16x16x32_bf16 v[20:23], v[176:179], v[216:219], v[20:23]
    ds_read_b64_tr_b16 v[162:163], v242 offset:256
    v_mfma_f32_16x16x32_bf16 v[20:23], v[180:183], v[220:223], v[20:23]
    ds_read_b64_tr_b16 v[164:165], v242 offset:2048
    v_mfma_f32_16x16x32_bf16 v[84:87], v[192:195], v[216:219], v[84:87]
    v_add_u32 v248, 0x10000, v248
    ds_read_b64_tr_b16 v[166:167], v242 offset:2304
    v_mfma_f32_16x16x32_bf16 v[84:87], v[196:199], v[220:223], v[84:87]
    v_add_u32 v249, 0x10000, v249
    ds_read_b64_tr_b16 v[168:169], v243 offset:0
    v_mfma_f32_16x16x32_bf16 v[116:119], v[200:203], v[216:219], v[116:119]
    ds_read_b64_tr_b16 v[170:171], v243 offset:256
    v_mfma_f32_16x16x32_bf16 v[116:119], v[204:207], v[220:223], v[116:119]
    ds_read_b64_tr_b16 v[172:173], v243 offset:2048
    v_mfma_f32_16x16x32_bf16 v[112:115], v[200:203], v[208:211], v[112:115]
    ds_read_b64_tr_b16 v[174:175], v243 offset:2304
    v_mfma_f32_16x16x32_bf16 v[112:115], v[204:207], v[212:215], v[112:115]
    v_add_u32 v240, 655360, v244
    v_mfma_f32_16x16x32_bf16 v[80:83], v[192:195], v[208:211], v[80:83]
    s_mov_b32 m0, s44
    v_mfma_f32_16x16x32_bf16 v[80:83], v[196:199], v[212:215], v[80:83]
    s_waitcnt lgkmcnt(8)
    v_mfma_f32_16x16x32_bf16 v[88:91], v[192:195], v[224:227], v[88:91]
    s_barrier
    ds_read_b128 v[208:211], v248 offset:0
    v_mfma_f32_16x16x32_bf16 v[88:91], v[196:199], v[228:231], v[88:91]
    ds_read_b128 v[212:215], v249 offset:0
    s_waitcnt lgkmcnt(2)
    v_mfma_f32_16x16x32_bf16 v[120:123], v[200:203], v[224:227], v[120:123]
    ds_read_b128 v[216:219], v248 offset:2048
    buffer_load_dwordx4 v240, s[8:11], s66 offen offset:0  lds
    v_mfma_f32_16x16x32_bf16 v[120:123], v[204:207], v[228:231], v[120:123]
    ds_read_b128 v[220:223], v249 offset:2048
    v_mfma_f32_16x16x32_bf16 v[124:127], v[200:203], v[232:235], v[124:127]
    s_waitcnt vmcnt(1)
    v_mfma_f32_16x16x32_bf16 v[124:127], v[204:207], v[236:239], v[124:127]
    ds_read_b64_tr_b16 v[200:201], v243 offset:4096
    v_mfma_f32_16x16x32_bf16 v[92:95], v[192:195], v[232:235], v[92:95]
    ds_read_b64_tr_b16 v[202:203], v243 offset:4352
    buffer_load_dwordx4 v240, s[8:11], s67 offen offset:1024  lds
    v_mfma_f32_16x16x32_bf16 v[92:95], v[196:199], v[236:239], v[92:95]
    ds_read_b64_tr_b16 v[204:205], v243 offset:6144
    v_mfma_f32_16x16x32_bf16 v[28:31], v[176:179], v[232:235], v[28:31]
    ds_read_b64_tr_b16 v[206:207], v243 offset:6400
    v_mfma_f32_16x16x32_bf16 v[28:31], v[180:183], v[236:239], v[28:31]
    ds_read_b64_tr_b16 v[192:193], v242 offset:4096
    v_mfma_f32_16x16x32_bf16 v[60:63], v[184:187], v[232:235], v[60:63]
    ds_read_b64_tr_b16 v[194:195], v242 offset:4352
    buffer_load_dwordx4 v240, s[8:11], s68 offen offset:2048  lds
    v_mfma_f32_16x16x32_bf16 v[60:63], v[188:191], v[236:239], v[60:63]
    ds_read_b64_tr_b16 v[196:197], v242 offset:6144
    v_mfma_f32_16x16x32_bf16 v[56:59], v[184:187], v[224:227], v[56:59]
    ds_read_b64_tr_b16 v[198:199], v242 offset:6400
    v_mfma_f32_16x16x32_bf16 v[56:59], v[188:191], v[228:231], v[56:59]
    buffer_load_dwordx4 v240, s[8:11], s69 offen offset:3072  lds
    v_mfma_f32_16x16x32_bf16 v[24:27], v[176:179], v[224:227], v[24:27]
    s_mov_b32 m0, s45
    v_mfma_f32_16x16x32_bf16 v[24:27], v[180:183], v[228:231], v[24:27]
    s_waitcnt lgkmcnt(8)
    v_mfma_f32_16x16x32_bf16 v[0:3], v[160:163], v[208:211], v[0:3]
    ds_read_b128 v[224:227], v248 offset:4096
    v_mfma_f32_16x16x32_bf16 v[0:3], v[164:167], v[212:215], v[0:3]
    ds_read_b128 v[228:231], v249 offset:4096
    v_mfma_f32_16x16x32_bf16 v[32:35], v[168:171], v[208:211], v[32:35]
    s_waitcnt lgkmcnt(2)
    v_mfma_f32_16x16x32_bf16 v[32:35], v[172:175], v[212:215], v[32:35]
    buffer_load_dwordx4 v240, s[8:11], s70 offen offset:0  lds
    v_mfma_f32_16x16x32_bf16 v[36:39], v[168:171], v[216:219], v[36:39]
    ds_read_b128 v[232:235], v248 offset:6144
    v_mfma_f32_16x16x32_bf16 v[36:39], v[172:175], v[220:223], v[36:39]
    ds_read_b128 v[236:239], v249 offset:6144
    v_mfma_f32_16x16x32_bf16 v[4:7], v[160:163], v[216:219], v[4:7]
    v_mfma_f32_16x16x32_bf16 v[4:7], v[164:167], v[220:223], v[4:7]
    buffer_load_dwordx4 v240, s[8:11], s71 offen offset:1024  lds
    v_mfma_f32_16x16x32_bf16 v[68:71], v[192:195], v[216:219], v[68:71]
    v_mfma_f32_16x16x32_bf16 v[68:71], v[196:199], v[220:223], v[68:71]
    v_mfma_f32_16x16x32_bf16 v[100:103], v[200:203], v[216:219], v[100:103]
    v_mfma_f32_16x16x32_bf16 v[100:103], v[204:207], v[220:223], v[100:103]
    buffer_load_dwordx4 v240, s[8:11], s72 offen offset:2048  lds
    v_mfma_f32_16x16x32_bf16 v[96:99], v[200:203], v[208:211], v[96:99]
    v_mfma_f32_16x16x32_bf16 v[96:99], v[204:207], v[212:215], v[96:99]
    v_mfma_f32_16x16x32_bf16 v[64:67], v[192:195], v[208:211], v[64:67]
    buffer_load_dwordx4 v240, s[8:11], s73 offen offset:3072  lds
    v_mfma_f32_16x16x32_bf16 v[64:67], v[196:199], v[212:215], v[64:67]
    s_waitcnt lgkmcnt(0)
    s_barrier
    v_mfma_f32_16x16x32_bf16 v[72:75], v[192:195], v[224:227], v[72:75]
    ds_read_b128 v[208:211], v248 offset:8192
    v_mfma_f32_16x16x32_bf16 v[72:75], v[196:199], v[228:231], v[72:75]
    ds_read_b128 v[212:215], v249 offset:8192
    v_mfma_f32_16x16x32_bf16 v[104:107], v[200:203], v[224:227], v[104:107]
    ds_read_b128 v[216:219], v248 offset:10240
    v_mfma_f32_16x16x32_bf16 v[104:107], v[204:207], v[228:231], v[104:107]
    ds_read_b128 v[220:223], v249 offset:10240
    v_mfma_f32_16x16x32_bf16 v[108:111], v[200:203], v[232:235], v[108:111]
    v_mfma_f32_16x16x32_bf16 v[108:111], v[204:207], v[236:239], v[108:111]
    v_mfma_f32_16x16x32_bf16 v[76:79], v[192:195], v[232:235], v[76:79]
    v_mfma_f32_16x16x32_bf16 v[76:79], v[196:199], v[236:239], v[76:79]
    v_mfma_f32_16x16x32_bf16 v[12:15], v[160:163], v[232:235], v[12:15]
    v_mfma_f32_16x16x32_bf16 v[12:15], v[164:167], v[236:239], v[12:15]
    v_mfma_f32_16x16x32_bf16 v[44:47], v[168:171], v[232:235], v[44:47]
    v_mfma_f32_16x16x32_bf16 v[44:47], v[172:175], v[236:239], v[44:47]
    v_mfma_f32_16x16x32_bf16 v[40:43], v[168:171], v[224:227], v[40:43]
    v_mfma_f32_16x16x32_bf16 v[40:43], v[172:175], v[228:231], v[40:43]
    v_mfma_f32_16x16x32_bf16 v[8:11], v[160:163], v[224:227], v[8:11]
    v_mfma_f32_16x16x32_bf16 v[8:11], v[164:167], v[228:231], v[8:11]
    s_waitcnt lgkmcnt(0)
    v_mfma_f32_16x16x32_bf16 v[16:19], v[160:163], v[208:211], v[16:19]
    ds_read_b128 v[224:227], v248 offset:12288
    v_mfma_f32_16x16x32_bf16 v[16:19], v[164:167], v[212:215], v[16:19]
    ds_read_b128 v[228:231], v249 offset:12288
    v_mfma_f32_16x16x32_bf16 v[48:51], v[168:171], v[208:211], v[48:51]
    ds_read_b128 v[232:235], v248 offset:14336
    v_mfma_f32_16x16x32_bf16 v[48:51], v[172:175], v[212:215], v[48:51]
    ds_read_b128 v[236:239], v249 offset:14336
    v_mfma_f32_16x16x32_bf16 v[52:55], v[168:171], v[216:219], v[52:55]
    s_waitcnt vmcnt(4)
    v_mfma_f32_16x16x32_bf16 v[52:55], v[172:175], v[220:223], v[52:55]
    ds_read_b64_tr_b16 v[176:177], v242 offset:0
    v_mfma_f32_16x16x32_bf16 v[20:23], v[160:163], v[216:219], v[20:23]
    ds_read_b64_tr_b16 v[178:179], v242 offset:256
    v_mfma_f32_16x16x32_bf16 v[20:23], v[164:167], v[220:223], v[20:23]
    ds_read_b64_tr_b16 v[180:181], v242 offset:2048
    v_mfma_f32_16x16x32_bf16 v[84:87], v[192:195], v[216:219], v[84:87]
    ds_read_b64_tr_b16 v[182:183], v242 offset:2304
    v_mfma_f32_16x16x32_bf16 v[84:87], v[196:199], v[220:223], v[84:87]
    ds_read_b64_tr_b16 v[184:185], v243 offset:0
    v_mfma_f32_16x16x32_bf16 v[116:119], v[200:203], v[216:219], v[116:119]
    ds_read_b64_tr_b16 v[186:187], v243 offset:256
    v_mfma_f32_16x16x32_bf16 v[116:119], v[204:207], v[220:223], v[116:119]
    ds_read_b64_tr_b16 v[188:189], v243 offset:2048
    v_mfma_f32_16x16x32_bf16 v[112:115], v[200:203], v[208:211], v[112:115]
    ds_read_b64_tr_b16 v[190:191], v243 offset:2304
    v_mfma_f32_16x16x32_bf16 v[112:115], v[204:207], v[212:215], v[112:115]
    v_add_u32 v240, 786432, v244
    v_mfma_f32_16x16x32_bf16 v[80:83], v[192:195], v[208:211], v[80:83]
    s_mov_b32 m0, s44
    v_mfma_f32_16x16x32_bf16 v[80:83], v[196:199], v[212:215], v[80:83]
    s_waitcnt lgkmcnt(8)
    v_mfma_f32_16x16x32_bf16 v[88:91], v[192:195], v[224:227], v[88:91]
    s_barrier
    ds_read_b128 v[208:211], v248 offset:16384
    v_mfma_f32_16x16x32_bf16 v[88:91], v[196:199], v[228:231], v[88:91]
    ds_read_b128 v[212:215], v249 offset:16384
    s_waitcnt lgkmcnt(2)
    v_mfma_f32_16x16x32_bf16 v[120:123], v[200:203], v[224:227], v[120:123]
    ds_read_b128 v[216:219], v248 offset:18432
    buffer_load_dwordx4 v240, s[8:11], s66 offen offset:0  lds
    v_mfma_f32_16x16x32_bf16 v[120:123], v[204:207], v[228:231], v[120:123]
    ds_read_b128 v[220:223], v249 offset:18432
    v_mfma_f32_16x16x32_bf16 v[124:127], v[200:203], v[232:235], v[124:127]
    s_waitcnt vmcnt(1)
    v_mfma_f32_16x16x32_bf16 v[124:127], v[204:207], v[236:239], v[124:127]
    ds_read_b64_tr_b16 v[200:201], v243 offset:4096
    v_mfma_f32_16x16x32_bf16 v[92:95], v[192:195], v[232:235], v[92:95]
    ds_read_b64_tr_b16 v[202:203], v243 offset:4352
    buffer_load_dwordx4 v240, s[8:11], s67 offen offset:1024  lds
    v_mfma_f32_16x16x32_bf16 v[92:95], v[196:199], v[236:239], v[92:95]
    ds_read_b64_tr_b16 v[204:205], v243 offset:6144
    v_mfma_f32_16x16x32_bf16 v[28:31], v[160:163], v[232:235], v[28:31]
    ds_read_b64_tr_b16 v[206:207], v243 offset:6400
    v_mfma_f32_16x16x32_bf16 v[28:31], v[164:167], v[236:239], v[28:31]
    ds_read_b64_tr_b16 v[192:193], v242 offset:4096
    v_mfma_f32_16x16x32_bf16 v[60:63], v[168:171], v[232:235], v[60:63]
    ds_read_b64_tr_b16 v[194:195], v242 offset:4352
    buffer_load_dwordx4 v240, s[8:11], s68 offen offset:2048  lds
    v_mfma_f32_16x16x32_bf16 v[60:63], v[172:175], v[236:239], v[60:63]
    ds_read_b64_tr_b16 v[196:197], v242 offset:6144
    v_mfma_f32_16x16x32_bf16 v[56:59], v[168:171], v[224:227], v[56:59]
    ds_read_b64_tr_b16 v[198:199], v242 offset:6400
    v_mfma_f32_16x16x32_bf16 v[56:59], v[172:175], v[228:231], v[56:59]
    buffer_load_dwordx4 v240, s[8:11], s69 offen offset:3072  lds
    v_mfma_f32_16x16x32_bf16 v[24:27], v[160:163], v[224:227], v[24:27]
    s_mov_b32 m0, s45
    v_mfma_f32_16x16x32_bf16 v[24:27], v[164:167], v[228:231], v[24:27]
    s_waitcnt lgkmcnt(8)
    v_mfma_f32_16x16x32_bf16 v[0:3], v[176:179], v[208:211], v[0:3]
    ds_read_b128 v[224:227], v248 offset:20480
    v_mfma_f32_16x16x32_bf16 v[0:3], v[180:183], v[212:215], v[0:3]
    ds_read_b128 v[228:231], v249 offset:20480
    v_mfma_f32_16x16x32_bf16 v[32:35], v[184:187], v[208:211], v[32:35]
    s_waitcnt lgkmcnt(2)
    v_mfma_f32_16x16x32_bf16 v[32:35], v[188:191], v[212:215], v[32:35]
    buffer_load_dwordx4 v240, s[8:11], s70 offen offset:0  lds
    v_mfma_f32_16x16x32_bf16 v[36:39], v[184:187], v[216:219], v[36:39]
    ds_read_b128 v[232:235], v248 offset:22528
    v_mfma_f32_16x16x32_bf16 v[36:39], v[188:191], v[220:223], v[36:39]
    ds_read_b128 v[236:239], v249 offset:22528
    v_mfma_f32_16x16x32_bf16 v[4:7], v[176:179], v[216:219], v[4:7]
    v_mfma_f32_16x16x32_bf16 v[4:7], v[180:183], v[220:223], v[4:7]
    buffer_load_dwordx4 v240, s[8:11], s71 offen offset:1024  lds
    v_mfma_f32_16x16x32_bf16 v[68:71], v[192:195], v[216:219], v[68:71]
    v_mfma_f32_16x16x32_bf16 v[68:71], v[196:199], v[220:223], v[68:71]
    v_mfma_f32_16x16x32_bf16 v[100:103], v[200:203], v[216:219], v[100:103]
    v_mfma_f32_16x16x32_bf16 v[100:103], v[204:207], v[220:223], v[100:103]
    buffer_load_dwordx4 v240, s[8:11], s72 offen offset:2048  lds
    v_mfma_f32_16x16x32_bf16 v[96:99], v[200:203], v[208:211], v[96:99]
    v_mfma_f32_16x16x32_bf16 v[96:99], v[204:207], v[212:215], v[96:99]
    v_mfma_f32_16x16x32_bf16 v[64:67], v[192:195], v[208:211], v[64:67]
    buffer_load_dwordx4 v240, s[8:11], s73 offen offset:3072  lds
    v_mfma_f32_16x16x32_bf16 v[64:67], v[196:199], v[212:215], v[64:67]
    s_waitcnt lgkmcnt(0)
    s_barrier
    v_mfma_f32_16x16x32_bf16 v[72:75], v[192:195], v[224:227], v[72:75]
    ds_read_b128 v[208:211], v248 offset:24576
    v_mfma_f32_16x16x32_bf16 v[72:75], v[196:199], v[228:231], v[72:75]
    ds_read_b128 v[212:215], v249 offset:24576
    v_mfma_f32_16x16x32_bf16 v[104:107], v[200:203], v[224:227], v[104:107]
    ds_read_b128 v[216:219], v248 offset:26624
    v_mfma_f32_16x16x32_bf16 v[104:107], v[204:207], v[228:231], v[104:107]
    ds_read_b128 v[220:223], v249 offset:26624
    v_mfma_f32_16x16x32_bf16 v[108:111], v[200:203], v[232:235], v[108:111]
    v_mfma_f32_16x16x32_bf16 v[108:111], v[204:207], v[236:239], v[108:111]
    v_mfma_f32_16x16x32_bf16 v[76:79], v[192:195], v[232:235], v[76:79]
    v_mfma_f32_16x16x32_bf16 v[76:79], v[196:199], v[236:239], v[76:79]
    v_mfma_f32_16x16x32_bf16 v[12:15], v[176:179], v[232:235], v[12:15]
    v_mfma_f32_16x16x32_bf16 v[12:15], v[180:183], v[236:239], v[12:15]
    v_mfma_f32_16x16x32_bf16 v[44:47], v[184:187], v[232:235], v[44:47]
    v_mfma_f32_16x16x32_bf16 v[44:47], v[188:191], v[236:239], v[44:47]
    v_mfma_f32_16x16x32_bf16 v[40:43], v[184:187], v[224:227], v[40:43]
    v_mfma_f32_16x16x32_bf16 v[40:43], v[188:191], v[228:231], v[40:43]
    v_mfma_f32_16x16x32_bf16 v[8:11], v[176:179], v[224:227], v[8:11]
    v_mfma_f32_16x16x32_bf16 v[8:11], v[180:183], v[228:231], v[8:11]
    s_waitcnt lgkmcnt(0)
    v_mfma_f32_16x16x32_bf16 v[16:19], v[176:179], v[208:211], v[16:19]
    ds_read_b128 v[224:227], v248 offset:28672
    v_mfma_f32_16x16x32_bf16 v[16:19], v[180:183], v[212:215], v[16:19]
    ds_read_b128 v[228:231], v249 offset:28672
    v_mfma_f32_16x16x32_bf16 v[48:51], v[184:187], v[208:211], v[48:51]
    ds_read_b128 v[232:235], v248 offset:30720
    v_mfma_f32_16x16x32_bf16 v[48:51], v[188:191], v[212:215], v[48:51]
    ds_read_b128 v[236:239], v249 offset:30720
    v_mfma_f32_16x16x32_bf16 v[52:55], v[184:187], v[216:219], v[52:55]
    s_waitcnt vmcnt(4)
    v_mfma_f32_16x16x32_bf16 v[52:55], v[188:191], v[220:223], v[52:55]
    ds_read_b64_tr_b16 v[160:161], v242 offset:0
    v_mfma_f32_16x16x32_bf16 v[20:23], v[176:179], v[216:219], v[20:23]
    ds_read_b64_tr_b16 v[162:163], v242 offset:256
    v_mfma_f32_16x16x32_bf16 v[20:23], v[180:183], v[220:223], v[20:23]
    ds_read_b64_tr_b16 v[164:165], v242 offset:2048
    v_mfma_f32_16x16x32_bf16 v[84:87], v[192:195], v[216:219], v[84:87]
    ds_read_b64_tr_b16 v[166:167], v242 offset:2304
    v_mfma_f32_16x16x32_bf16 v[84:87], v[196:199], v[220:223], v[84:87]
    ds_read_b64_tr_b16 v[168:169], v243 offset:0
    v_mfma_f32_16x16x32_bf16 v[116:119], v[200:203], v[216:219], v[116:119]
    ds_read_b64_tr_b16 v[170:171], v243 offset:256
    v_mfma_f32_16x16x32_bf16 v[116:119], v[204:207], v[220:223], v[116:119]
    ds_read_b64_tr_b16 v[172:173], v243 offset:2048
    v_mfma_f32_16x16x32_bf16 v[112:115], v[200:203], v[208:211], v[112:115]
    ds_read_b64_tr_b16 v[174:175], v243 offset:2304
    v_mfma_f32_16x16x32_bf16 v[112:115], v[204:207], v[212:215], v[112:115]
    v_add_u32 v240, 917504, v244
    v_mfma_f32_16x16x32_bf16 v[80:83], v[192:195], v[208:211], v[80:83]
    s_mov_b32 m0, s44
    v_mfma_f32_16x16x32_bf16 v[80:83], v[196:199], v[212:215], v[80:83]
    s_waitcnt lgkmcnt(8)
    v_mfma_f32_16x16x32_bf16 v[88:91], v[192:195], v[224:227], v[88:91]
    s_barrier
    ds_read_b128 v[208:211], v248 offset:32768
    v_mfma_f32_16x16x32_bf16 v[88:91], v[196:199], v[228:231], v[88:91]
    ds_read_b128 v[212:215], v249 offset:32768
    s_waitcnt lgkmcnt(2)
    v_mfma_f32_16x16x32_bf16 v[120:123], v[200:203], v[224:227], v[120:123]
    ds_read_b128 v[216:219], v248 offset:34816
    buffer_load_dwordx4 v240, s[8:11], s66 offen offset:0  lds
    v_mfma_f32_16x16x32_bf16 v[120:123], v[204:207], v[228:231], v[120:123]
    ds_read_b128 v[220:223], v249 offset:34816
    v_mfma_f32_16x16x32_bf16 v[124:127], v[200:203], v[232:235], v[124:127]
    s_waitcnt vmcnt(1)
    v_mfma_f32_16x16x32_bf16 v[124:127], v[204:207], v[236:239], v[124:127]
    ds_read_b64_tr_b16 v[200:201], v243 offset:4096
    v_mfma_f32_16x16x32_bf16 v[92:95], v[192:195], v[232:235], v[92:95]
    ds_read_b64_tr_b16 v[202:203], v243 offset:4352
    buffer_load_dwordx4 v240, s[8:11], s67 offen offset:1024  lds
    v_mfma_f32_16x16x32_bf16 v[92:95], v[196:199], v[236:239], v[92:95]
    ds_read_b64_tr_b16 v[204:205], v243 offset:6144
    v_mfma_f32_16x16x32_bf16 v[28:31], v[176:179], v[232:235], v[28:31]
    ds_read_b64_tr_b16 v[206:207], v243 offset:6400
    v_mfma_f32_16x16x32_bf16 v[28:31], v[180:183], v[236:239], v[28:31]
    ds_read_b64_tr_b16 v[192:193], v242 offset:4096
    v_mfma_f32_16x16x32_bf16 v[60:63], v[184:187], v[232:235], v[60:63]
    ds_read_b64_tr_b16 v[194:195], v242 offset:4352
    buffer_load_dwordx4 v240, s[8:11], s68 offen offset:2048  lds
    v_mfma_f32_16x16x32_bf16 v[60:63], v[188:191], v[236:239], v[60:63]
    ds_read_b64_tr_b16 v[196:197], v242 offset:6144
    v_mfma_f32_16x16x32_bf16 v[56:59], v[184:187], v[224:227], v[56:59]
    ds_read_b64_tr_b16 v[198:199], v242 offset:6400
    v_mfma_f32_16x16x32_bf16 v[56:59], v[188:191], v[228:231], v[56:59]
    buffer_load_dwordx4 v240, s[8:11], s69 offen offset:3072  lds
    v_mfma_f32_16x16x32_bf16 v[24:27], v[176:179], v[224:227], v[24:27]
    s_mov_b32 m0, s45
    v_mfma_f32_16x16x32_bf16 v[24:27], v[180:183], v[228:231], v[24:27]
    s_waitcnt lgkmcnt(8)
    v_mfma_f32_16x16x32_bf16 v[0:3], v[160:163], v[208:211], v[0:3]
    ds_read_b128 v[224:227], v248 offset:36864
    v_mfma_f32_16x16x32_bf16 v[0:3], v[164:167], v[212:215], v[0:3]
    ds_read_b128 v[228:231], v249 offset:36864
    v_mfma_f32_16x16x32_bf16 v[32:35], v[168:171], v[208:211], v[32:35]
    s_waitcnt lgkmcnt(2)
    v_mfma_f32_16x16x32_bf16 v[32:35], v[172:175], v[212:215], v[32:35]
    buffer_load_dwordx4 v240, s[8:11], s70 offen offset:0  lds
    v_mfma_f32_16x16x32_bf16 v[36:39], v[168:171], v[216:219], v[36:39]
    ds_read_b128 v[232:235], v248 offset:38912
    v_mfma_f32_16x16x32_bf16 v[36:39], v[172:175], v[220:223], v[36:39]
    ds_read_b128 v[236:239], v249 offset:38912
    v_mfma_f32_16x16x32_bf16 v[4:7], v[160:163], v[216:219], v[4:7]
    v_mfma_f32_16x16x32_bf16 v[4:7], v[164:167], v[220:223], v[4:7]
    buffer_load_dwordx4 v240, s[8:11], s71 offen offset:1024  lds
    v_mfma_f32_16x16x32_bf16 v[68:71], v[192:195], v[216:219], v[68:71]
    v_mfma_f32_16x16x32_bf16 v[68:71], v[196:199], v[220:223], v[68:71]
    v_mfma_f32_16x16x32_bf16 v[100:103], v[200:203], v[216:219], v[100:103]
    v_mfma_f32_16x16x32_bf16 v[100:103], v[204:207], v[220:223], v[100:103]
    buffer_load_dwordx4 v240, s[8:11], s72 offen offset:2048  lds
    v_mfma_f32_16x16x32_bf16 v[96:99], v[200:203], v[208:211], v[96:99]
    v_mfma_f32_16x16x32_bf16 v[96:99], v[204:207], v[212:215], v[96:99]
    v_mfma_f32_16x16x32_bf16 v[64:67], v[192:195], v[208:211], v[64:67]
    buffer_load_dwordx4 v240, s[8:11], s73 offen offset:3072  lds
    v_mfma_f32_16x16x32_bf16 v[64:67], v[196:199], v[212:215], v[64:67]
    s_waitcnt lgkmcnt(0)
    v_mfma_f32_16x16x32_bf16 v[72:75], v[192:195], v[224:227], v[72:75]
    ds_read_b128 v[208:211], v248 offset:40960
    v_mfma_f32_16x16x32_bf16 v[72:75], v[196:199], v[228:231], v[72:75]
    ds_read_b128 v[212:215], v249 offset:40960
    v_mfma_f32_16x16x32_bf16 v[104:107], v[200:203], v[224:227], v[104:107]
    ds_read_b128 v[216:219], v248 offset:43008
    v_mfma_f32_16x16x32_bf16 v[104:107], v[204:207], v[228:231], v[104:107]
    ds_read_b128 v[220:223], v249 offset:43008
    v_mfma_f32_16x16x32_bf16 v[108:111], v[200:203], v[232:235], v[108:111]
    v_mfma_f32_16x16x32_bf16 v[108:111], v[204:207], v[236:239], v[108:111]
    v_mfma_f32_16x16x32_bf16 v[76:79], v[192:195], v[232:235], v[76:79]
    v_mfma_f32_16x16x32_bf16 v[76:79], v[196:199], v[236:239], v[76:79]
    v_mfma_f32_16x16x32_bf16 v[12:15], v[160:163], v[232:235], v[12:15]
    v_mfma_f32_16x16x32_bf16 v[12:15], v[164:167], v[236:239], v[12:15]
    v_mfma_f32_16x16x32_bf16 v[44:47], v[168:171], v[232:235], v[44:47]
    v_mfma_f32_16x16x32_bf16 v[44:47], v[172:175], v[236:239], v[44:47]
    v_mfma_f32_16x16x32_bf16 v[40:43], v[168:171], v[224:227], v[40:43]
    v_mfma_f32_16x16x32_bf16 v[40:43], v[172:175], v[228:231], v[40:43]
    v_mfma_f32_16x16x32_bf16 v[8:11], v[160:163], v[224:227], v[8:11]
    v_mfma_f32_16x16x32_bf16 v[8:11], v[164:167], v[228:231], v[8:11]
    s_waitcnt lgkmcnt(0)
    v_mfma_f32_16x16x32_bf16 v[16:19], v[160:163], v[208:211], v[16:19]
    ds_read_b128 v[224:227], v248 offset:45056
    v_mfma_f32_16x16x32_bf16 v[16:19], v[164:167], v[212:215], v[16:19]
    ds_read_b128 v[228:231], v249 offset:45056
    v_mfma_f32_16x16x32_bf16 v[48:51], v[168:171], v[208:211], v[48:51]
    ds_read_b128 v[232:235], v248 offset:47104
    v_mfma_f32_16x16x32_bf16 v[48:51], v[172:175], v[212:215], v[48:51]
    ds_read_b128 v[236:239], v249 offset:47104
    v_mfma_f32_16x16x32_bf16 v[52:55], v[168:171], v[216:219], v[52:55]
    s_waitcnt vmcnt(4)
    v_mfma_f32_16x16x32_bf16 v[52:55], v[172:175], v[220:223], v[52:55]
    ds_read_b64_tr_b16 v[176:177], v242 offset:0
    v_mfma_f32_16x16x32_bf16 v[20:23], v[160:163], v[216:219], v[20:23]
    ds_read_b64_tr_b16 v[178:179], v242 offset:256
    v_mfma_f32_16x16x32_bf16 v[20:23], v[164:167], v[220:223], v[20:23]
    ds_read_b64_tr_b16 v[180:181], v242 offset:2048
    v_mfma_f32_16x16x32_bf16 v[84:87], v[192:195], v[216:219], v[84:87]
    ds_read_b64_tr_b16 v[182:183], v242 offset:2304
    v_mfma_f32_16x16x32_bf16 v[84:87], v[196:199], v[220:223], v[84:87]
    ds_read_b64_tr_b16 v[184:185], v243 offset:0
    v_mfma_f32_16x16x32_bf16 v[116:119], v[200:203], v[216:219], v[116:119]
    ds_read_b64_tr_b16 v[186:187], v243 offset:256
    v_mfma_f32_16x16x32_bf16 v[116:119], v[204:207], v[220:223], v[116:119]
    ds_read_b64_tr_b16 v[188:189], v243 offset:2048
    v_mfma_f32_16x16x32_bf16 v[112:115], v[200:203], v[208:211], v[112:115]
    ds_read_b64_tr_b16 v[190:191], v243 offset:2304
    v_mfma_f32_16x16x32_bf16 v[112:115], v[204:207], v[212:215], v[112:115]
    v_mfma_f32_16x16x32_bf16 v[80:83], v[192:195], v[208:211], v[80:83]
    v_mfma_f32_16x16x32_bf16 v[80:83], v[196:199], v[212:215], v[80:83]
    s_waitcnt lgkmcnt(8)
    v_mfma_f32_16x16x32_bf16 v[88:91], v[192:195], v[224:227], v[88:91]
    s_barrier
    ds_read_b128 v[208:211], v248 offset:49152
    v_mfma_f32_16x16x32_bf16 v[88:91], v[196:199], v[228:231], v[88:91]
    ds_read_b128 v[212:215], v249 offset:49152
    v_mfma_f32_16x16x32_bf16 v[120:123], v[200:203], v[224:227], v[120:123]
    ds_read_b128 v[216:219], v248 offset:51200
    v_mfma_f32_16x16x32_bf16 v[120:123], v[204:207], v[228:231], v[120:123]
    ds_read_b128 v[220:223], v249 offset:51200
    v_mfma_f32_16x16x32_bf16 v[124:127], v[200:203], v[232:235], v[124:127]
    s_waitcnt vmcnt(0)
    v_mfma_f32_16x16x32_bf16 v[124:127], v[204:207], v[236:239], v[124:127]
    ds_read_b64_tr_b16 v[200:201], v243 offset:4096
    v_mfma_f32_16x16x32_bf16 v[92:95], v[192:195], v[232:235], v[92:95]
    ds_read_b64_tr_b16 v[202:203], v243 offset:4352
    v_mfma_f32_16x16x32_bf16 v[92:95], v[196:199], v[236:239], v[92:95]
    ds_read_b64_tr_b16 v[204:205], v243 offset:6144
    v_mfma_f32_16x16x32_bf16 v[28:31], v[160:163], v[232:235], v[28:31]
    s_waitcnt lgkmcnt(11)
    ds_read_b64_tr_b16 v[206:207], v243 offset:6400
    v_mfma_f32_16x16x32_bf16 v[28:31], v[164:167], v[236:239], v[28:31]
    ds_read_b64_tr_b16 v[192:193], v242 offset:4096
    v_mfma_f32_16x16x32_bf16 v[60:63], v[168:171], v[232:235], v[60:63]
    ds_read_b64_tr_b16 v[194:195], v242 offset:4352
    v_mfma_f32_16x16x32_bf16 v[60:63], v[172:175], v[236:239], v[60:63]
    ds_read_b64_tr_b16 v[196:197], v242 offset:6144
    v_mfma_f32_16x16x32_bf16 v[56:59], v[168:171], v[224:227], v[56:59]
    s_waitcnt lgkmcnt(11)
    ds_read_b64_tr_b16 v[198:199], v242 offset:6400
    v_mfma_f32_16x16x32_bf16 v[56:59], v[172:175], v[228:231], v[56:59]
    v_mfma_f32_16x16x32_bf16 v[24:27], v[160:163], v[224:227], v[24:27]
    v_mfma_f32_16x16x32_bf16 v[24:27], v[164:167], v[228:231], v[24:27]
    s_waitcnt lgkmcnt(8)
    v_mfma_f32_16x16x32_bf16 v[0:3], v[176:179], v[208:211], v[0:3]
    ds_read_b128 v[224:227], v248 offset:53248
    v_mfma_f32_16x16x32_bf16 v[0:3], v[180:183], v[212:215], v[0:3]
    ds_read_b128 v[228:231], v249 offset:53248
    v_mfma_f32_16x16x32_bf16 v[32:35], v[184:187], v[208:211], v[32:35]
    v_mfma_f32_16x16x32_bf16 v[32:35], v[188:191], v[212:215], v[32:35]
    v_mfma_f32_16x16x32_bf16 v[36:39], v[184:187], v[216:219], v[36:39]
    ds_read_b128 v[232:235], v248 offset:55296
    v_mfma_f32_16x16x32_bf16 v[36:39], v[188:191], v[220:223], v[36:39]
    ds_read_b128 v[236:239], v249 offset:55296
    v_mfma_f32_16x16x32_bf16 v[4:7], v[176:179], v[216:219], v[4:7]
    v_mfma_f32_16x16x32_bf16 v[4:7], v[180:183], v[220:223], v[4:7]
    s_waitcnt lgkmcnt(6)
    v_mfma_f32_16x16x32_bf16 v[68:71], v[192:195], v[216:219], v[68:71]
    s_waitcnt lgkmcnt(4)
    v_mfma_f32_16x16x32_bf16 v[68:71], v[196:199], v[220:223], v[68:71]
    v_mfma_f32_16x16x32_bf16 v[100:103], v[200:203], v[216:219], v[100:103]
    v_mfma_f32_16x16x32_bf16 v[100:103], v[204:207], v[220:223], v[100:103]
    v_mfma_f32_16x16x32_bf16 v[96:99], v[200:203], v[208:211], v[96:99]
    v_mfma_f32_16x16x32_bf16 v[96:99], v[204:207], v[212:215], v[96:99]
    v_mfma_f32_16x16x32_bf16 v[64:67], v[192:195], v[208:211], v[64:67]
    v_mfma_f32_16x16x32_bf16 v[64:67], v[196:199], v[212:215], v[64:67]
    s_waitcnt lgkmcnt(0)
    v_mfma_f32_16x16x32_bf16 v[72:75], v[192:195], v[224:227], v[72:75]
    ds_read_b128 v[208:211], v248 offset:57344
    v_mfma_f32_16x16x32_bf16 v[72:75], v[196:199], v[228:231], v[72:75]
    ds_read_b128 v[212:215], v249 offset:57344
    v_mfma_f32_16x16x32_bf16 v[104:107], v[200:203], v[224:227], v[104:107]
    ds_read_b128 v[216:219], v248 offset:59392
    v_mfma_f32_16x16x32_bf16 v[104:107], v[204:207], v[228:231], v[104:107]
    ds_read_b128 v[220:223], v249 offset:59392
    v_mfma_f32_16x16x32_bf16 v[108:111], v[200:203], v[232:235], v[108:111]
    v_mfma_f32_16x16x32_bf16 v[108:111], v[204:207], v[236:239], v[108:111]
    v_mfma_f32_16x16x32_bf16 v[76:79], v[192:195], v[232:235], v[76:79]
    v_mfma_f32_16x16x32_bf16 v[76:79], v[196:199], v[236:239], v[76:79]
    v_mfma_f32_16x16x32_bf16 v[12:15], v[176:179], v[232:235], v[12:15]
    v_mfma_f32_16x16x32_bf16 v[12:15], v[180:183], v[236:239], v[12:15]
    v_mfma_f32_16x16x32_bf16 v[44:47], v[184:187], v[232:235], v[44:47]
    v_mfma_f32_16x16x32_bf16 v[44:47], v[188:191], v[236:239], v[44:47]
    v_mfma_f32_16x16x32_bf16 v[40:43], v[184:187], v[224:227], v[40:43]
    v_mfma_f32_16x16x32_bf16 v[40:43], v[188:191], v[228:231], v[40:43]
    v_mfma_f32_16x16x32_bf16 v[8:11], v[176:179], v[224:227], v[8:11]
    v_mfma_f32_16x16x32_bf16 v[8:11], v[180:183], v[228:231], v[8:11]
    s_waitcnt lgkmcnt(0)
    v_mfma_f32_16x16x32_bf16 v[16:19], v[176:179], v[208:211], v[16:19]
    ds_read_b128 v[224:227], v248 offset:61440
    v_mfma_f32_16x16x32_bf16 v[16:19], v[180:183], v[212:215], v[16:19]
    ds_read_b128 v[228:231], v249 offset:61440
    v_mfma_f32_16x16x32_bf16 v[48:51], v[184:187], v[208:211], v[48:51]
    ds_read_b128 v[232:235], v248 offset:63488
    v_mfma_f32_16x16x32_bf16 v[48:51], v[188:191], v[212:215], v[48:51]
    ds_read_b128 v[236:239], v249 offset:63488
    v_mfma_f32_16x16x32_bf16 v[52:55], v[184:187], v[216:219], v[52:55]
    v_mfma_f32_16x16x32_bf16 v[52:55], v[188:191], v[220:223], v[52:55]
    v_mfma_f32_16x16x32_bf16 v[20:23], v[176:179], v[216:219], v[20:23]
    v_mfma_f32_16x16x32_bf16 v[20:23], v[180:183], v[220:223], v[20:23]
    v_mfma_f32_16x16x32_bf16 v[84:87], v[192:195], v[216:219], v[84:87]
    v_add_u32 v248, 0xffff0000, v248
    v_mfma_f32_16x16x32_bf16 v[84:87], v[196:199], v[220:223], v[84:87]
    v_add_u32 v249, 0xffff0000, v249
    v_mfma_f32_16x16x32_bf16 v[116:119], v[200:203], v[216:219], v[116:119]
    v_mfma_f32_16x16x32_bf16 v[116:119], v[204:207], v[220:223], v[116:119]
    v_mfma_f32_16x16x32_bf16 v[112:115], v[200:203], v[208:211], v[112:115]
    v_mfma_f32_16x16x32_bf16 v[112:115], v[204:207], v[212:215], v[112:115]
    s_barrier
    v_mfma_f32_16x16x32_bf16 v[80:83], v[192:195], v[208:211], v[80:83]
    v_mfma_f32_16x16x32_bf16 v[80:83], v[196:199], v[212:215], v[80:83]
    s_waitcnt lgkmcnt(0)
    v_mfma_f32_16x16x32_bf16 v[88:91], v[192:195], v[224:227], v[88:91]
    v_mfma_f32_16x16x32_bf16 v[88:91], v[196:199], v[228:231], v[88:91]
    v_mfma_f32_16x16x32_bf16 v[120:123], v[200:203], v[224:227], v[120:123]
    v_mfma_f32_16x16x32_bf16 v[120:123], v[204:207], v[228:231], v[120:123]
    v_mfma_f32_16x16x32_bf16 v[124:127], v[200:203], v[232:235], v[124:127]
    v_mfma_f32_16x16x32_bf16 v[124:127], v[204:207], v[236:239], v[124:127]
    v_mfma_f32_16x16x32_bf16 v[92:95], v[192:195], v[232:235], v[92:95]
    v_mfma_f32_16x16x32_bf16 v[92:95], v[196:199], v[236:239], v[92:95]
    v_mfma_f32_16x16x32_bf16 v[28:31], v[176:179], v[232:235], v[28:31]
    v_mfma_f32_16x16x32_bf16 v[28:31], v[180:183], v[236:239], v[28:31]
    v_mfma_f32_16x16x32_bf16 v[60:63], v[184:187], v[232:235], v[60:63]
    v_mfma_f32_16x16x32_bf16 v[60:63], v[188:191], v[236:239], v[60:63]
    v_mfma_f32_16x16x32_bf16 v[56:59], v[184:187], v[224:227], v[56:59]
    v_mfma_f32_16x16x32_bf16 v[56:59], v[188:191], v[228:231], v[56:59]
    v_mfma_f32_16x16x32_bf16 v[24:27], v[176:179], v[224:227], v[24:27]
    v_mfma_f32_16x16x32_bf16 v[24:27], v[180:183], v[228:231], v[24:27]
    s_setprio 0
    s_movk_i32 s49, 0
    s_nop 5
    v_mul_f32 v72, s50, v72
    v_mul_f32 v73, s50, v73
    v_mul_f32 v74, s50, v74
    v_mul_f32 v75, s50, v75
    v_mul_f32 v104, s50, v104
    v_mul_f32 v105, s50, v105
    v_mul_f32 v106, s50, v106
    v_mul_f32 v107, s50, v107
    v_exp_f32 v72, v72
    v_exp_f32 v73, v73
    v_exp_f32 v74, v74
    v_exp_f32 v75, v75
    v_exp_f32 v104, v104
    v_exp_f32 v105, v105
    v_exp_f32 v106, v106
    v_exp_f32 v107, v107
    v_fma_f32 v72, v72, s51, s51
    v_fma_f32 v73, v73, s51, s51
    v_fma_f32 v74, v74, s51, s51
    v_fma_f32 v75, v75, s51, s51
    v_fma_f32 v104, v104, s51, s51
    v_fma_f32 v105, v105, s51, s51
    v_fma_f32 v106, v106, s51, s51
    v_fma_f32 v107, v107, s51, s51
    buffer_load_dwordx4 v[192:195], v252, s[20:23], s49 offen offset:0 sc1
    v_rcp_f32 v72, v72
    v_rcp_f32 v73, v73
    v_rcp_f32 v74, v74
    v_rcp_f32 v75, v75
    v_rcp_f32 v104, v104
    v_rcp_f32 v105, v105
    v_rcp_f32 v106, v106
    v_rcp_f32 v107, v107
    buffer_load_dwordx4 v[196:199], v252, s[20:23], s49 offen offset:64 sc1
    v_mul_f32 v8, v8, v72
    v_mul_f32 v9, v9, v73
    v_mul_f32 v10, v10, v74
    v_mul_f32 v11, v11, v75
    v_mul_f32 v40, v40, v104
    v_mul_f32 v41, v41, v105
    v_mul_f32 v42, v42, v106
    v_mul_f32 v43, v43, v107
    buffer_load_dwordx4 v[200:203], v252, s[20:23], s49 offen offset:128 sc1
    v_mul_f32 v76, s50, v76
    v_mul_f32 v77, s50, v77
    v_mul_f32 v78, s50, v78
    v_mul_f32 v79, s50, v79
    v_mul_f32 v108, s50, v108
    v_mul_f32 v109, s50, v109
    v_mul_f32 v110, s50, v110
    v_mul_f32 v111, s50, v111
    buffer_load_dwordx4 v[204:207], v252, s[20:23], s49 offen offset:192 sc1
    v_exp_f32 v76, v76
    v_exp_f32 v77, v77
    v_exp_f32 v78, v78
    v_exp_f32 v79, v79
    v_exp_f32 v108, v108
    v_exp_f32 v109, v109
    v_exp_f32 v110, v110
    v_exp_f32 v111, v111
    buffer_load_dwordx4 v[208:211], v252, s[20:23], s49 offen offset:1024 sc1
    v_fma_f32 v76, v76, s51, s51
    v_fma_f32 v77, v77, s51, s51
    v_fma_f32 v78, v78, s51, s51
    v_fma_f32 v79, v79, s51, s51
    v_fma_f32 v108, v108, s51, s51
    v_fma_f32 v109, v109, s51, s51
    v_fma_f32 v110, v110, s51, s51
    v_fma_f32 v111, v111, s51, s51
    buffer_load_dwordx4 v[212:215], v252, s[20:23], s49 offen offset:1088 sc1
    v_rcp_f32 v76, v76
    v_rcp_f32 v77, v77
    v_rcp_f32 v78, v78
    v_rcp_f32 v79, v79
    v_rcp_f32 v108, v108
    v_rcp_f32 v109, v109
    v_rcp_f32 v110, v110
    v_rcp_f32 v111, v111
    buffer_load_dwordx4 v[216:219], v252, s[20:23], s49 offen offset:1152 sc1
    v_mul_f32 v12, v12, v76
    v_mul_f32 v13, v13, v77
    v_mul_f32 v14, v14, v78
    v_mul_f32 v15, v15, v79
    v_mul_f32 v44, v44, v108
    v_mul_f32 v45, v45, v109
    v_mul_f32 v46, v46, v110
    v_mul_f32 v47, v47, v111
    buffer_load_dwordx4 v[220:223], v252, s[20:23], s49 offen offset:1216 sc1
    v_mul_f32 v64, s50, v64
    v_mul_f32 v65, s50, v65
    v_mul_f32 v66, s50, v66
    v_mul_f32 v67, s50, v67
    v_mul_f32 v96, s50, v96
    v_mul_f32 v97, s50, v97
    v_mul_f32 v98, s50, v98
    v_mul_f32 v99, s50, v99
    v_exp_f32 v64, v64
    v_exp_f32 v65, v65
    v_exp_f32 v66, v66
    v_exp_f32 v67, v67
    v_exp_f32 v96, v96
    v_exp_f32 v97, v97
    v_exp_f32 v98, v98
    v_exp_f32 v99, v99
    v_fma_f32 v64, v64, s51, s51
    v_fma_f32 v65, v65, s51, s51
    v_fma_f32 v66, v66, s51, s51
    v_fma_f32 v67, v67, s51, s51
    v_fma_f32 v96, v96, s51, s51
    v_fma_f32 v97, v97, s51, s51
    v_fma_f32 v98, v98, s51, s51
    v_fma_f32 v99, v99, s51, s51
    v_rcp_f32 v64, v64
    v_rcp_f32 v65, v65
    v_rcp_f32 v66, v66
    v_rcp_f32 v67, v67
    v_rcp_f32 v96, v96
    v_rcp_f32 v97, v97
    v_rcp_f32 v98, v98
    v_rcp_f32 v99, v99
    v_mul_f32 v0, v0, v64
    v_mul_f32 v1, v1, v65
    v_mul_f32 v2, v2, v66
    v_mul_f32 v3, v3, v67
    v_mul_f32 v32, v32, v96
    v_mul_f32 v33, v33, v97
    v_mul_f32 v34, v34, v98
    v_mul_f32 v35, v35, v99
    v_mul_f32 v68, s50, v68
    v_mul_f32 v69, s50, v69
    v_mul_f32 v70, s50, v70
    v_mul_f32 v71, s50, v71
    v_mul_f32 v100, s50, v100
    v_mul_f32 v101, s50, v101
    v_mul_f32 v102, s50, v102
    v_mul_f32 v103, s50, v103
    v_exp_f32 v68, v68
    v_exp_f32 v69, v69
    v_exp_f32 v70, v70
    v_exp_f32 v71, v71
    v_exp_f32 v100, v100
    v_exp_f32 v101, v101
    v_exp_f32 v102, v102
    v_exp_f32 v103, v103
    v_fma_f32 v68, v68, s51, s51
    v_fma_f32 v69, v69, s51, s51
    v_fma_f32 v70, v70, s51, s51
    v_fma_f32 v71, v71, s51, s51
    v_fma_f32 v100, v100, s51, s51
    v_fma_f32 v101, v101, s51, s51
    v_fma_f32 v102, v102, s51, s51
    v_fma_f32 v103, v103, s51, s51
    v_rcp_f32 v68, v68
    v_rcp_f32 v69, v69
    v_rcp_f32 v70, v70
    v_rcp_f32 v71, v71
    v_rcp_f32 v100, v100
    v_rcp_f32 v101, v101
    v_rcp_f32 v102, v102
    v_rcp_f32 v103, v103
    v_mul_f32 v4, v4, v68
    v_mul_f32 v5, v5, v69
    v_mul_f32 v6, v6, v70
    v_mul_f32 v7, v7, v71
    v_mul_f32 v36, v36, v100
    v_mul_f32 v37, v37, v101
    v_mul_f32 v38, v38, v102
    v_mul_f32 v39, v39, v103
    v_cvt_pk_bf16_f32 v161, v8, v12
    v_cvt_pk_bf16_f32 v167, v9, v13
    v_cvt_pk_bf16_f32 v173, v10, v14
    v_cvt_pk_bf16_f32 v179, v11, v15
    v_cvt_pk_bf16_f32 v185, v40, v44
    v_cvt_pk_bf16_f32 v225, v41, v45
    v_cvt_pk_bf16_f32 v231, v42, v46
    v_cvt_pk_bf16_f32 v237, v43, v47
    v_cvt_pk_bf16_f32 v160, v0, v4
    v_cvt_pk_bf16_f32 v166, v1, v5
    v_cvt_pk_bf16_f32 v172, v2, v6
    v_cvt_pk_bf16_f32 v178, v3, v7
    v_cvt_pk_bf16_f32 v184, v32, v36
    v_cvt_pk_bf16_f32 v224, v33, v37
    v_cvt_pk_bf16_f32 v230, v34, v38
    v_cvt_pk_bf16_f32 v236, v35, v39
    v_min_u32 v72, -2, v161
    v_min_u32 v73, -2, v167
    v_min_u32 v74, -2, v173
    v_min_u32 v75, -2, v179
    v_min_u32 v104, -2, v185
    v_min_u32 v105, -2, v225
    v_min_u32 v106, -2, v231
    v_min_u32 v107, -2, v237
    s_cmp_lg_u32 s34, 4096
    s_cbranch_scc1 L_exp20
    v_min_u32_dpp v72, v160, v253 row_shr:1 row_mask:0xf bank_mask:0xf
    v_min_u32_dpp v73, v166, v253 row_shr:1 row_mask:0xf bank_mask:0xf
    v_min_u32_dpp v74, v172, v253 row_shr:1 row_mask:0xf bank_mask:0xf
    v_min_u32_dpp v75, v178, v253 row_shr:1 row_mask:0xf bank_mask:0xf
    v_min_u32_dpp v104, v184, v253 row_shr:1 row_mask:0xf bank_mask:0xf
    v_min_u32_dpp v105, v224, v253 row_shr:1 row_mask:0xf bank_mask:0xf
    v_min_u32_dpp v106, v230, v253 row_shr:1 row_mask:0xf bank_mask:0xf
    v_min_u32_dpp v107, v236, v253 row_shr:1 row_mask:0xf bank_mask:0xf
L_exp20:
    v_mul_f32 v80, s50, v80
    v_mul_f32 v81, s50, v81
    v_mul_f32 v82, s50, v82
    v_mul_f32 v83, s50, v83
    v_mul_f32 v112, s50, v112
    v_mul_f32 v113, s50, v113
    v_mul_f32 v114, s50, v114
    v_mul_f32 v115, s50, v115
    v_exp_f32 v80, v80
    v_exp_f32 v81, v81
    v_exp_f32 v82, v82
    v_exp_f32 v83, v83
    v_exp_f32 v112, v112
    v_exp_f32 v113, v113
    v_exp_f32 v114, v114
    v_exp_f32 v115, v115
    v_fma_f32 v80, v80, s51, s51
    v_fma_f32 v81, v81, s51, s51
    v_fma_f32 v82, v82, s51, s51
    v_fma_f32 v83, v83, s51, s51
    v_fma_f32 v112, v112, s51, s51
    v_fma_f32 v113, v113, s51, s51
    v_fma_f32 v114, v114, s51, s51
    v_fma_f32 v115, v115, s51, s51
    v_rcp_f32 v80, v80
    v_rcp_f32 v81, v81
    v_rcp_f32 v82, v82
    v_rcp_f32 v83, v83
    v_rcp_f32 v112, v112
    v_rcp_f32 v113, v113
    v_rcp_f32 v114, v114
    v_rcp_f32 v115, v115
    v_mul_f32 v16, v16, v80
    v_mul_f32 v17, v17, v81
    v_mul_f32 v18, v18, v82
    v_mul_f32 v19, v19, v83
    v_mul_f32 v48, v48, v112
    v_mul_f32 v49, v49, v113
    v_mul_f32 v50, v50, v114
    v_mul_f32 v51, v51, v115
    buffer_store_dwordx4 v[72:75], v254, s[32:35], s38 offen offset:0 sc0 sc1
    buffer_store_dwordx4 v[104:107], v254, s[32:35], s38 offen offset:64 sc0 sc1
    v_mul_f32 v84, s50, v84
    v_mul_f32 v85, s50, v85
    v_mul_f32 v86, s50, v86
    v_mul_f32 v87, s50, v87
    v_mul_f32 v116, s50, v116
    v_mul_f32 v117, s50, v117
    v_mul_f32 v118, s50, v118
    v_mul_f32 v119, s50, v119
    v_exp_f32 v84, v84
    v_exp_f32 v85, v85
    v_exp_f32 v86, v86
    v_exp_f32 v87, v87
    v_exp_f32 v116, v116
    v_exp_f32 v117, v117
    v_exp_f32 v118, v118
    v_exp_f32 v119, v119
    v_fma_f32 v84, v84, s51, s51
    v_fma_f32 v85, v85, s51, s51
    v_fma_f32 v86, v86, s51, s51
    v_fma_f32 v87, v87, s51, s51
    v_fma_f32 v116, v116, s51, s51
    v_fma_f32 v117, v117, s51, s51
    v_fma_f32 v118, v118, s51, s51
    v_fma_f32 v119, v119, s51, s51
    v_rcp_f32 v84, v84
    v_rcp_f32 v85, v85
    v_rcp_f32 v86, v86
    v_rcp_f32 v87, v87
    v_rcp_f32 v116, v116
    v_rcp_f32 v117, v117
    v_rcp_f32 v118, v118
    v_rcp_f32 v119, v119
    v_mul_f32 v20, v20, v84
    v_mul_f32 v21, v21, v85
    v_mul_f32 v22, v22, v86
    v_mul_f32 v23, v23, v87
    v_mul_f32 v52, v52, v116
    v_mul_f32 v53, v53, v117
    v_mul_f32 v54, v54, v118
    v_mul_f32 v55, v55, v119
    v_mul_f32 v88, s50, v88
    v_mul_f32 v89, s50, v89
    v_mul_f32 v90, s50, v90
    v_mul_f32 v91, s50, v91
    v_mul_f32 v120, s50, v120
    v_mul_f32 v121, s50, v121
    v_mul_f32 v122, s50, v122
    v_mul_f32 v123, s50, v123
    v_exp_f32 v88, v88
    v_exp_f32 v89, v89
    v_exp_f32 v90, v90
    v_exp_f32 v91, v91
    v_exp_f32 v120, v120
    v_exp_f32 v121, v121
    v_exp_f32 v122, v122
    v_exp_f32 v123, v123
    v_fma_f32 v88, v88, s51, s51
    v_fma_f32 v89, v89, s51, s51
    v_fma_f32 v90, v90, s51, s51
    v_fma_f32 v91, v91, s51, s51
    v_fma_f32 v120, v120, s51, s51
    v_fma_f32 v121, v121, s51, s51
    v_fma_f32 v122, v122, s51, s51
    v_fma_f32 v123, v123, s51, s51
    v_rcp_f32 v88, v88
    v_rcp_f32 v89, v89
    v_rcp_f32 v90, v90
    v_rcp_f32 v91, v91
    v_rcp_f32 v120, v120
    v_rcp_f32 v121, v121
    v_rcp_f32 v122, v122
    v_rcp_f32 v123, v123
    v_mul_f32 v24, v24, v88
    v_mul_f32 v25, v25, v89
    v_mul_f32 v26, v26, v90
    v_mul_f32 v27, v27, v91
    v_mul_f32 v56, v56, v120
    v_mul_f32 v57, v57, v121
    v_mul_f32 v58, v58, v122
    v_mul_f32 v59, v59, v123
    v_mul_f32 v92, s50, v92
    v_mul_f32 v93, s50, v93
    v_mul_f32 v94, s50, v94
    v_mul_f32 v95, s50, v95
    v_mul_f32 v124, s50, v124
    v_mul_f32 v125, s50, v125
    v_mul_f32 v126, s50, v126
    v_mul_f32 v127, s50, v127
    v_exp_f32 v92, v92
    v_exp_f32 v93, v93
    v_exp_f32 v94, v94
    v_exp_f32 v95, v95
    v_exp_f32 v124, v124
    v_exp_f32 v125, v125
    v_exp_f32 v126, v126
    v_exp_f32 v127, v127
    v_fma_f32 v92, v92, s51, s51
    v_fma_f32 v93, v93, s51, s51
    v_fma_f32 v94, v94, s51, s51
    v_fma_f32 v95, v95, s51, s51
    v_fma_f32 v124, v124, s51, s51
    v_fma_f32 v125, v125, s51, s51
    v_fma_f32 v126, v126, s51, s51
    v_fma_f32 v127, v127, s51, s51
    v_rcp_f32 v92, v92
    v_rcp_f32 v93, v93
    v_rcp_f32 v94, v94
    v_rcp_f32 v95, v95
    v_rcp_f32 v124, v124
    v_rcp_f32 v125, v125
    v_rcp_f32 v126, v126
    v_rcp_f32 v127, v127
    v_mul_f32 v28, v28, v92
    v_mul_f32 v29, v29, v93
    v_mul_f32 v30, v30, v94
    v_mul_f32 v31, v31, v95
    v_mul_f32 v60, v60, v124
    v_mul_f32 v61, v61, v125
    v_mul_f32 v62, v62, v126
    v_mul_f32 v63, v63, v127
    v_cvt_pk_bf16_f32 v162, v16, v20
    v_cvt_pk_bf16_f32 v163, v24, v28
    v_cvt_pk_bf16_f32 v168, v17, v21
    v_cvt_pk_bf16_f32 v169, v25, v29
    s_waitcnt vmcnt(2)
    s_setprio 3
    v_mfma_f32_16x16x32_bf16 v[64:67], v[192:195], v[160:163], 0
    v_cvt_pk_bf16_f32 v174, v18, v22
    v_cvt_pk_bf16_f32 v175, v26, v30
    v_mfma_f32_16x16x32_bf16 v[72:75], v[196:199], v[166:169], 0
    v_cvt_pk_bf16_f32 v180, v19, v23
    v_cvt_pk_bf16_f32 v181, v27, v31
    v_mfma_f32_16x16x32_bf16 v[80:83], v[200:203], v[172:175], 0
    v_cvt_pk_bf16_f32 v186, v48, v52
    v_cvt_pk_bf16_f32 v187, v56, v60
    v_mfma_f32_16x16x32_bf16 v[88:91], v[204:207], v[178:181], 0
    v_cvt_pk_bf16_f32 v226, v49, v53
    v_cvt_pk_bf16_f32 v227, v57, v61
    v_mfma_f32_16x16x32_bf16 v[96:99], v[208:211], v[184:187], 0
    v_cvt_pk_bf16_f32 v232, v50, v54
    v_cvt_pk_bf16_f32 v233, v58, v62
    v_mfma_f32_16x16x32_bf16 v[104:107], v[212:215], v[224:227], 0
    v_cvt_pk_bf16_f32 v238, v51, v55
    v_cvt_pk_bf16_f32 v239, v59, v63
    s_nop 0
    v_mfma_f32_16x16x32_bf16 v[112:115], v[216:219], v[230:233], 0
    v_mfma_f32_16x16x32_bf16 v[120:123], v[220:223], v[236:239], 0
    s_setprio 0
    v_exp_f32 v32, v64
    v_exp_f32 v33, v72
    v_exp_f32 v34, v80
    v_exp_f32 v35, v88
    v_exp_f32 v36, v96
    v_exp_f32 v37, v104
    v_exp_f32 v38, v112
    v_exp_f32 v39, v120
    v_fma_f32 v32, v32, s50, s50
    v_fma_f32 v33, v33, s50, s50
    v_fma_f32 v34, v34, s50, s50
    v_fma_f32 v35, v35, s50, s50
    v_fma_f32 v36, v36, s50, s50
    v_fma_f32 v37, v37, s50, s50
    v_fma_f32 v38, v38, s50, s50
    v_fma_f32 v39, v39, s50, s50
    v_rcp_f32 v32, v32
    v_rcp_f32 v33, v33
    v_rcp_f32 v34, v34
    v_rcp_f32 v35, v35
    v_rcp_f32 v36, v36
    v_rcp_f32 v37, v37
    v_rcp_f32 v38, v38
    v_rcp_f32 v39, v39
    v_mul_f32 v64, v64, v32
    v_mul_f32 v72, v72, v33
    v_mul_f32 v80, v80, v34
    v_mul_f32 v88, v88, v35
    v_mul_f32 v96, v96, v36
    v_mul_f32 v104, v104, v37
    v_mul_f32 v112, v112, v38
    v_mul_f32 v120, v120, v39
    v_cvt_pk_bf16_f32 v128, v64, v72
    v_cvt_pk_bf16_f32 v129, v80, v88
    v_cvt_pk_bf16_f32 v130, v96, v104
    v_cvt_pk_bf16_f32 v131, v112, v120
    buffer_load_dwordx4 v[40:43], v251, s[24:27], s38 offen offset:0 sc0 sc1
    buffer_load_dwordx4 v[44:47], v251, s[24:27], s38 offen offset:64 sc0 sc1
    v_exp_f32 v32, v65
    v_exp_f32 v33, v73
    v_exp_f32 v34, v81
    v_exp_f32 v35, v89
    v_exp_f32 v36, v97
    v_exp_f32 v37, v105
    v_exp_f32 v38, v113
    v_exp_f32 v39, v121
    v_fma_f32 v32, v32, s50, s50
    v_fma_f32 v33, v33, s50, s50
    v_fma_f32 v34, v34, s50, s50
    v_fma_f32 v35, v35, s50, s50
    v_fma_f32 v36, v36, s50, s50
    v_fma_f32 v37, v37, s50, s50
    v_fma_f32 v38, v38, s50, s50
    v_fma_f32 v39, v39, s50, s50
    v_rcp_f32 v32, v32
    v_rcp_f32 v33, v33
    v_rcp_f32 v34, v34
    v_rcp_f32 v35, v35
    v_rcp_f32 v36, v36
    v_rcp_f32 v37, v37
    v_rcp_f32 v38, v38
    v_rcp_f32 v39, v39
    v_mul_f32 v65, v65, v32
    v_mul_f32 v73, v73, v33
    v_mul_f32 v81, v81, v34
    v_mul_f32 v89, v89, v35
    v_mul_f32 v97, v97, v36
    v_mul_f32 v105, v105, v37
    v_mul_f32 v113, v113, v38
    v_mul_f32 v121, v121, v39
    v_cvt_pk_bf16_f32 v132, v65, v73
    v_cvt_pk_bf16_f32 v133, v81, v89
    v_cvt_pk_bf16_f32 v134, v97, v105
    v_cvt_pk_bf16_f32 v135, v113, v121
    v_exp_f32 v32, v66
    v_exp_f32 v33, v74
    v_exp_f32 v34, v82
    v_exp_f32 v35, v90
    v_exp_f32 v36, v98
    v_exp_f32 v37, v106
    v_exp_f32 v38, v114
    v_exp_f32 v39, v122
    v_fma_f32 v32, v32, s50, s50
    v_fma_f32 v33, v33, s50, s50
    v_fma_f32 v34, v34, s50, s50
    v_fma_f32 v35, v35, s50, s50
    v_fma_f32 v36, v36, s50, s50
    v_fma_f32 v37, v37, s50, s50
    v_fma_f32 v38, v38, s50, s50
    v_fma_f32 v39, v39, s50, s50
    v_rcp_f32 v32, v32
    v_rcp_f32 v33, v33
    v_rcp_f32 v34, v34
    v_rcp_f32 v35, v35
    v_rcp_f32 v36, v36
    v_rcp_f32 v37, v37
    v_rcp_f32 v38, v38
    v_rcp_f32 v39, v39
    v_mul_f32 v66, v66, v32
    v_mul_f32 v74, v74, v33
    v_mul_f32 v82, v82, v34
    v_mul_f32 v90, v90, v35
    v_mul_f32 v98, v98, v36
    v_mul_f32 v106, v106, v37
    v_mul_f32 v114, v114, v38
    v_mul_f32 v122, v122, v39
    v_cvt_pk_bf16_f32 v136, v66, v74
    v_cvt_pk_bf16_f32 v137, v82, v90
    v_cvt_pk_bf16_f32 v138, v98, v106
    v_cvt_pk_bf16_f32 v139, v114, v122
    v_mov_b32_dpp v165, v161 row_shl:1 row_mask:0xf bank_mask:0xf bound_ctrl:1
    v_mov_b32_dpp v171, v167 row_shl:1 row_mask:0xf bank_mask:0xf bound_ctrl:1
    v_mov_b32_dpp v177, v173 row_shl:1 row_mask:0xf bank_mask:0xf bound_ctrl:1
    v_mov_b32_dpp v183, v179 row_shl:1 row_mask:0xf bank_mask:0xf bound_ctrl:1
    v_mov_b32_dpp v189, v185 row_shl:1 row_mask:0xf bank_mask:0xf bound_ctrl:1
    v_mov_b32_dpp v229, v225 row_shl:1 row_mask:0xf bank_mask:0xf bound_ctrl:1
    v_mov_b32_dpp v235, v231 row_shl:1 row_mask:0xf bank_mask:0xf bound_ctrl:1
    v_mov_b32_dpp v241, v237 row_shl:1 row_mask:0xf bank_mask:0xf bound_ctrl:1
    s_mov_b32 s48, 4000000
    s_waitcnt vmcnt(0)
L_poll0:
    v_max3_u32 v32, v40, v41, v42
    v_max3_u32 v33, v43, v44, v45
    v_max3_u32 v32, v32, v46, v47
    v_max_u32 v32, v32, v33
    v_cmp_eq_u32 vcc, -1, v32
    s_sub_u32 s48, s48, 1
    s_cbranch_scc1 L_poll0_ok
    s_cbranch_vccz L_poll0_ok
    buffer_load_dwordx4 v[40:43], v251, s[24:27], s38 offen offset:0 sc0 sc1
    buffer_load_dwordx4 v[44:47], v251, s[24:27], s38 offen offset:64 sc0 sc1
    s_waitcnt vmcnt(0)
    s_branch L_poll0
L_poll0_ok:
    s_mov_b32 vcc_lo, 2147516416
    s_mov_b32 vcc_hi, 2147516416
    s_cmp_lg_u32 s26, 4096
    s_cbranch_scc1 L_imp20
    v_mov_b32_dpp v165, v40 row_shr:15 row_mask:0xf bank_mask:0xf
    v_mov_b32_dpp v171, v41 row_shr:15 row_mask:0xf bank_mask:0xf
    v_mov_b32_dpp v177, v42 row_shr:15 row_mask:0xf bank_mask:0xf
    v_mov_b32_dpp v183, v43 row_shr:15 row_mask:0xf bank_mask:0xf
    v_mov_b32_dpp v189, v44 row_shr:15 row_mask:0xf bank_mask:0xf
    v_mov_b32_dpp v229, v45 row_shr:15 row_mask:0xf bank_mask:0xf
    v_mov_b32_dpp v235, v46 row_shr:15 row_mask:0xf bank_mask:0xf
    v_mov_b32_dpp v241, v47 row_shr:15 row_mask:0xf bank_mask:0xf
L_imp20:
    v_cndmask_b32_dpp v164, v160, v40, vcc row_shl:1 row_mask:0xf bank_mask:0xf bound_ctrl:1
    v_cndmask_b32_dpp v170, v166, v41, vcc row_shl:1 row_mask:0xf bank_mask:0xf bound_ctrl:1
    v_cndmask_b32_dpp v176, v172, v42, vcc row_shl:1 row_mask:0xf bank_mask:0xf bound_ctrl:1
    v_cndmask_b32_dpp v182, v178, v43, vcc row_shl:1 row_mask:0xf bank_mask:0xf bound_ctrl:1
    v_cndmask_b32_dpp v188, v184, v44, vcc row_shl:1 row_mask:0xf bank_mask:0xf bound_ctrl:1
    v_cndmask_b32_dpp v228, v224, v45, vcc row_shl:1 row_mask:0xf bank_mask:0xf bound_ctrl:1
    v_cndmask_b32_dpp v234, v230, v46, vcc row_shl:1 row_mask:0xf bank_mask:0xf bound_ctrl:1
    v_cndmask_b32_dpp v240, v236, v47, vcc row_shl:1 row_mask:0xf bank_mask:0xf bound_ctrl:1
    s_setprio 3
    v_mfma_f32_16x16x32_bf16 v[68:71], v[192:195], v[162:165], 0
    v_exp_f32 v32, v67
    v_mfma_f32_16x16x32_bf16 v[76:79], v[196:199], v[168:171], 0
    v_exp_f32 v33, v75
    v_mfma_f32_16x16x32_bf16 v[84:87], v[200:203], v[174:177], 0
    v_exp_f32 v34, v83
    v_mfma_f32_16x16x32_bf16 v[92:95], v[204:207], v[180:183], 0
    v_exp_f32 v35, v91
    v_mfma_f32_16x16x32_bf16 v[100:103], v[208:211], v[186:189], 0
    v_exp_f32 v36, v99
    v_mfma_f32_16x16x32_bf16 v[108:111], v[212:215], v[226:229], 0
    v_exp_f32 v37, v107
    v_mfma_f32_16x16x32_bf16 v[116:119], v[216:219], v[232:235], 0
    v_exp_f32 v38, v115
    v_mfma_f32_16x16x32_bf16 v[124:127], v[220:223], v[238:241], 0
    v_exp_f32 v39, v123
    s_setprio 0
    v_fma_f32 v32, v32, s50, s50
    v_fma_f32 v33, v33, s50, s50
    v_fma_f32 v34, v34, s50, s50
    v_fma_f32 v35, v35, s50, s50
    v_fma_f32 v36, v36, s50, s50
    v_fma_f32 v37, v37, s50, s50
    v_fma_f32 v38, v38, s50, s50
    v_fma_f32 v39, v39, s50, s50
    v_rcp_f32 v32, v32
    v_rcp_f32 v33, v33
    v_rcp_f32 v34, v34
    v_rcp_f32 v35, v35
    v_rcp_f32 v36, v36
    v_rcp_f32 v37, v37
    v_rcp_f32 v38, v38
    v_rcp_f32 v39, v39
    v_mul_f32 v67, v67, v32
    v_mul_f32 v75, v75, v33
    v_mul_f32 v83, v83, v34
    v_mul_f32 v91, v91, v35
    v_mul_f32 v99, v99, v36
    v_mul_f32 v107, v107, v37
    v_mul_f32 v115, v115, v38
    v_mul_f32 v123, v123, v39
    v_cvt_pk_bf16_f32 v140, v67, v75
    v_cvt_pk_bf16_f32 v141, v83, v91
    v_cvt_pk_bf16_f32 v142, v99, v107
    v_cvt_pk_bf16_f32 v143, v115, v123
    v_exp_f32 v32, v68
    v_exp_f32 v33, v76
    v_exp_f32 v34, v84
    v_exp_f32 v35, v92
    v_exp_f32 v36, v100
    v_exp_f32 v37, v108
    v_exp_f32 v38, v116
    v_exp_f32 v39, v124
    v_fma_f32 v32, v32, s50, s50
    v_fma_f32 v33, v33, s50, s50
    v_fma_f32 v34, v34, s50, s50
    v_fma_f32 v35, v35, s50, s50
    v_fma_f32 v36, v36, s50, s50
    v_fma_f32 v37, v37, s50, s50
    v_fma_f32 v38, v38, s50, s50
    v_fma_f32 v39, v39, s50, s50
    v_rcp_f32 v32, v32
    v_rcp_f32 v33, v33
    v_rcp_f32 v34, v34
    v_rcp_f32 v35, v35
    v_rcp_f32 v36, v36
    v_rcp_f32 v37, v37
    v_rcp_f32 v38, v38
    v_rcp_f32 v39, v39
    v_mul_f32 v68, v68, v32
    v_mul_f32 v76, v76, v33
    v_mul_f32 v84, v84, v34
    v_mul_f32 v92, v92, v35
    v_mul_f32 v100, v100, v36
    v_mul_f32 v108, v108, v37
    v_mul_f32 v116, v116, v38
    v_mul_f32 v124, v124, v39
    v_cvt_pk_bf16_f32 v144, v68, v76
    v_cvt_pk_bf16_f32 v145, v84, v92
    v_cvt_pk_bf16_f32 v146, v100, v108
    v_cvt_pk_bf16_f32 v147, v116, v124
    v_exp_f32 v32, v69
    v_exp_f32 v33, v77
    v_exp_f32 v34, v85
    v_exp_f32 v35, v93
    v_exp_f32 v36, v101
    v_exp_f32 v37, v109
    v_exp_f32 v38, v117
    v_exp_f32 v39, v125
    v_fma_f32 v32, v32, s50, s50
    v_fma_f32 v33, v33, s50, s50
    v_fma_f32 v34, v34, s50, s50
    v_fma_f32 v35, v35, s50, s50
    v_fma_f32 v36, v36, s50, s50
    v_fma_f32 v37, v37, s50, s50
    v_fma_f32 v38, v38, s50, s50
    v_fma_f32 v39, v39, s50, s50
    v_rcp_f32 v32, v32
    v_rcp_f32 v33, v33
    v_rcp_f32 v34, v34
    v_rcp_f32 v35, v35
    v_rcp_f32 v36, v36
    v_rcp_f32 v37, v37
    v_rcp_f32 v38, v38
    v_rcp_f32 v39, v39
    v_mul_f32 v69, v69, v32
    v_mul_f32 v77, v77, v33
    v_mul_f32 v85, v85, v34
    v_mul_f32 v93, v93, v35
    v_mul_f32 v101, v101, v36
    v_mul_f32 v109, v109, v37
    v_mul_f32 v117, v117, v38
    v_mul_f32 v125, v125, v39
    v_cvt_pk_bf16_f32 v148, v69, v77
    v_cvt_pk_bf16_f32 v149, v85, v93
    v_cvt_pk_bf16_f32 v150, v101, v109
    v_cvt_pk_bf16_f32 v151, v117, v125
    s_setprio 1
    v_exp_f32 v32, v70
    v_exp_f32 v33, v78
    s_mov_b32 s46, 262144
    v_exp_f32 v34, v86
    v_exp_f32 v35, v94
    s_mov_b32 s47, 266240
    v_exp_f32 v36, v102
    v_exp_f32 v37, v110
    buffer_load_dwordx4 v[160:163], v250, s[60:63], s46 offen offset:0 sc1
    v_exp_f32 v38, v118
    v_exp_f32 v39, v126
    v_fma_f32 v32, v32, s50, s50
    v_fma_f32 v33, v33, s50, s50
    v_fma_f32 v34, v34, s50, s50
    v_fma_f32 v35, v35, s50, s50
    buffer_load_dwordx4 v[164:167], v250, s[60:63], s46 offen offset:1024 sc1
    v_fma_f32 v36, v36, s50, s50
    v_fma_f32 v37, v37, s50, s50
    v_fma_f32 v38, v38, s50, s50
    v_fma_f32 v39, v39, s50, s50
    v_rcp_f32 v32, v32
    v_rcp_f32 v33, v33
    buffer_load_dwordx4 v[168:171], v250, s[60:63], s46 offen offset:2048 sc1
    v_rcp_f32 v34, v34
    v_rcp_f32 v35, v35
    v_rcp_f32 v36, v36
    v_rcp_f32 v37, v37
    v_rcp_f32 v38, v38
    v_rcp_f32 v39, v39
    buffer_load_dwordx4 v[172:175], v250, s[60:63], s46 offen offset:3072 sc1
    v_mul_f32 v70, v70, v32
    v_mul_f32 v78, v78, v33
    v_mul_f32 v86, v86, v34
    v_mul_f32 v94, v94, v35
    v_mul_f32 v102, v102, v36
    v_mul_f32 v110, v110, v37
    buffer_load_dwordx4 v[176:179], v250, s[60:63], s47 offen offset:0 sc1
    v_mul_f32 v118, v118, v38
    v_mul_f32 v126, v126, v39
    v_cvt_pk_bf16_f32 v152, v70, v78
    v_cvt_pk_bf16_f32 v153, v86, v94
    v_cvt_pk_bf16_f32 v154, v102, v110
    v_cvt_pk_bf16_f32 v155, v118, v126
    buffer_load_dwordx4 v[180:183], v250, s[60:63], s47 offen offset:1024 sc1
    v_exp_f32 v32, v71
    v_exp_f32 v33, v79
    v_exp_f32 v34, v87
    v_exp_f32 v35, v95
    v_exp_f32 v36, v103
    v_exp_f32 v37, v111
    buffer_load_dwordx4 v[184:187], v250, s[60:63], s47 offen offset:2048 sc1
    v_exp_f32 v38, v119
    v_exp_f32 v39, v127
    v_fma_f32 v32, v32, s50, s50
    v_fma_f32 v33, v33, s50, s50
    v_fma_f32 v34, v34, s50, s50
    v_fma_f32 v35, v35, s50, s50
    buffer_load_dwordx4 v[188:191], v250, s[60:63], s47 offen offset:3072 sc1
    v_fma_f32 v36, v36, s50, s50
    v_fma_f32 v37, v37, s50, s50
    v_fma_f32 v38, v38, s50, s50
    v_fma_f32 v39, v39, s50, s50
    v_rcp_f32 v32, v32
    v_rcp_f32 v33, v33
    s_mov_b32 s46, 270336
    v_rcp_f32 v34, v34
    v_rcp_f32 v35, v35
    s_mov_b32 s47, 274432
    v_rcp_f32 v36, v36
    v_rcp_f32 v37, v37
    ds_read_b128 v[224:227], v248 offset:0
    v_rcp_f32 v38, v38
    v_rcp_f32 v39, v39
    ds_read_b128 v[228:231], v249 offset:0
    v_mul_f32 v71, v71, v32
    v_mul_f32 v79, v79, v33
    ds_read_b128 v[232:235], v248 offset:2048
    v_mul_f32 v87, v87, v34
    v_mul_f32 v95, v95, v35
    ds_read_b128 v[236:239], v249 offset:2048
    v_mul_f32 v103, v103, v36
    v_mul_f32 v111, v111, v37
    v_mul_f32 v119, v119, v38
    v_mul_f32 v127, v127, v39
    v_cvt_pk_bf16_f32 v156, v71, v79
    v_cvt_pk_bf16_f32 v157, v87, v95
    v_cvt_pk_bf16_f32 v158, v103, v111
    v_cvt_pk_bf16_f32 v159, v119, v127
    s_setprio 1
    s_waitcnt vmcnt(7) lgkmcnt(3)
    v_mfma_f32_16x16x32_bf16 v[0:3], v[160:163], v[224:227], 0
    ds_read_b128 v[240:243], v248 offset:4096
    s_waitcnt vmcnt(6) lgkmcnt(3)
    v_mfma_f32_16x16x32_bf16 v[0:3], v[164:167], v[228:231], v[0:3]
    ds_read_b128 v[244:247], v249 offset:4096
    s_waitcnt vmcnt(5)
    v_mfma_f32_16x16x32_bf16 v[32:35], v[168:171], v[224:227], 0
    buffer_load_dwordx4 v[192:195], v250, s[60:63], s46 offen offset:0 sc1
    s_waitcnt vmcnt(5)
    v_mfma_f32_16x16x32_bf16 v[32:35], v[172:175], v[228:231], v[32:35]
    s_waitcnt vmcnt(1)
    v_mfma_f32_16x16x32_bf16 v[64:67], v[176:179], v[224:227], 0
    v_mfma_f32_16x16x32_bf16 v[64:67], v[180:183], v[228:231], v[64:67]
    buffer_load_dwordx4 v[196:199], v250, s[60:63], s46 offen offset:1024 sc1
    v_mfma_f32_16x16x32_bf16 v[96:99], v[184:187], v[224:227], 0
    v_mfma_f32_16x16x32_bf16 v[96:99], v[188:191], v[228:231], v[96:99]
    s_waitcnt lgkmcnt(2)
    v_mfma_f32_16x16x32_bf16 v[100:103], v[184:187], v[232:235], 0
    ds_read_b128 v[224:227], v248 offset:6144
    v_mfma_f32_16x16x32_bf16 v[100:103], v[188:191], v[236:239], v[100:103]
    ds_read_b128 v[228:231], v249 offset:6144
    v_mfma_f32_16x16x32_bf16 v[68:71], v[176:179], v[232:235], 0
    buffer_load_dwordx4 v[200:203], v250, s[60:63], s46 offen offset:2048 sc1
    v_mfma_f32_16x16x32_bf16 v[68:71], v[180:183], v[236:239], v[68:71]
    v_mfma_f32_16x16x32_bf16 v[36:39], v[168:171], v[232:235], 0
    v_mfma_f32_16x16x32_bf16 v[36:39], v[172:175], v[236:239], v[36:39]
    buffer_load_dwordx4 v[204:207], v250, s[60:63], s46 offen offset:3072 sc1
    v_mfma_f32_16x16x32_bf16 v[4:7], v[160:163], v[232:235], 0
    v_mfma_f32_16x16x32_bf16 v[4:7], v[164:167], v[236:239], v[4:7]
    s_waitcnt lgkmcnt(2)
    v_mfma_f32_16x16x32_bf16 v[8:11], v[160:163], v[240:243], 0
    ds_read_b128 v[232:235], v248 offset:8192
    v_mfma_f32_16x16x32_bf16 v[8:11], v[164:167], v[244:247], v[8:11]
    ds_read_b128 v[236:239], v249 offset:8192
    v_mfma_f32_16x16x32_bf16 v[40:43], v[168:171], v[240:243], 0
    buffer_load_dwordx4 v[208:211], v250, s[60:63], s47 offen offset:0 sc1
    v_mfma_f32_16x16x32_bf16 v[40:43], v[172:175], v[244:247], v[40:43]
    v_mfma_f32_16x16x32_bf16 v[72:75], v[176:179], v[240:243], 0
    v_mfma_f32_16x16x32_bf16 v[72:75], v[180:183], v[244:247], v[72:75]
    buffer_load_dwordx4 v[212:215], v250, s[60:63], s47 offen offset:1024 sc1
    v_mfma_f32_16x16x32_bf16 v[104:107], v[184:187], v[240:243], 0
    v_mfma_f32_16x16x32_bf16 v[104:107], v[188:191], v[244:247], v[104:107]
    s_waitcnt lgkmcnt(2)
    v_mfma_f32_16x16x32_bf16 v[108:111], v[184:187], v[224:227], 0
    ds_read_b128 v[240:243], v248 offset:10240
    v_mfma_f32_16x16x32_bf16 v[108:111], v[188:191], v[228:231], v[108:111]
    ds_read_b128 v[244:247], v249 offset:10240
    v_mfma_f32_16x16x32_bf16 v[76:79], v[176:179], v[224:227], 0
    buffer_load_dwordx4 v[216:219], v250, s[60:63], s47 offen offset:2048 sc1
    v_mfma_f32_16x16x32_bf16 v[76:79], v[180:183], v[228:231], v[76:79]
    v_mfma_f32_16x16x32_bf16 v[44:47], v[168:171], v[224:227], 0
    v_mfma_f32_16x16x32_bf16 v[44:47], v[172:175], v[228:231], v[44:47]
    buffer_load_dwordx4 v[220:223], v250, s[60:63], s47 offen offset:3072 sc1
    v_mfma_f32_16x16x32_bf16 v[12:15], v[160:163], v[224:227], 0
    v_mfma_f32_16x16x32_bf16 v[12:15], v[164:167], v[228:231], v[12:15]
    s_waitcnt lgkmcnt(2)
    v_mfma_f32_16x16x32_bf16 v[16:19], v[160:163], v[232:235], 0
    ds_read_b128 v[224:227], v248 offset:12288
    v_mfma_f32_16x16x32_bf16 v[16:19], v[164:167], v[236:239], v[16:19]
    ds_read_b128 v[228:231], v249 offset:12288
    v_mfma_f32_16x16x32_bf16 v[48:51], v[168:171], v[232:235], 0
    v_mfma_f32_16x16x32_bf16 v[48:51], v[172:175], v[236:239], v[48:51]
    v_mfma_f32_16x16x32_bf16 v[80:83], v[176:179], v[232:235], 0
    v_mfma_f32_16x16x32_bf16 v[80:83], v[180:183], v[236:239], v[80:83]
    v_mfma_f32_16x16x32_bf16 v[112:115], v[184:187], v[232:235], 0
    v_mfma_f32_16x16x32_bf16 v[112:115], v[188:191], v[236:239], v[112:115]
    s_waitcnt lgkmcnt(2)
    v_mfma_f32_16x16x32_bf16 v[116:119], v[184:187], v[240:243], 0
    ds_read_b128 v[232:235], v248 offset:14336
    v_mfma_f32_16x16x32_bf16 v[116:119], v[188:191], v[244:247], v[116:119]
    ds_read_b128 v[236:239], v249 offset:14336
    v_mfma_f32_16x16x32_bf16 v[84:87], v[176:179], v[240:243], 0
    v_mfma_f32_16x16x32_bf16 v[84:87], v[180:183], v[244:247], v[84:87]
    v_mfma_f32_16x16x32_bf16 v[52:55], v[168:171], v[240:243], 0
    v_mfma_f32_16x16x32_bf16 v[52:55], v[172:175], v[244:247], v[52:55]
    v_mfma_f32_16x16x32_bf16 v[20:23], v[160:163], v[240:243], 0
    v_mfma_f32_16x16x32_bf16 v[20:23], v[164:167], v[244:247], v[20:23]
    s_waitcnt lgkmcnt(2)
    v_mfma_f32_16x16x32_bf16 v[24:27], v[160:163], v[224:227], 0
    ds_read_b128 v[240:243], v248 offset:16384
    v_mfma_f32_16x16x32_bf16 v[24:27], v[164:167], v[228:231], v[24:27]
    ds_read_b128 v[244:247], v249 offset:16384
    v_mfma_f32_16x16x32_bf16 v[56:59], v[168:171], v[224:227], 0
    v_mfma_f32_16x16x32_bf16 v[56:59], v[172:175], v[228:231], v[56:59]
    v_mfma_f32_16x16x32_bf16 v[88:91], v[176:179], v[224:227], 0
    v_mfma_f32_16x16x32_bf16 v[88:91], v[180:183], v[228:231], v[88:91]
    v_mfma_f32_16x16x32_bf16 v[120:123], v[184:187], v[224:227], 0
    v_mfma_f32_16x16x32_bf16 v[120:123], v[188:191], v[228:231], v[120:123]
    s_waitcnt lgkmcnt(2)
    v_mfma_f32_16x16x32_bf16 v[124:127], v[184:187], v[232:235], 0
    ds_read_b128 v[224:227], v248 offset:18432
    v_mfma_f32_16x16x32_bf16 v[124:127], v[188:191], v[236:239], v[124:127]
    ds_read_b128 v[228:231], v249 offset:18432
    v_mfma_f32_16x16x32_bf16 v[92:95], v[176:179], v[232:235], 0
    v_mfma_f32_16x16x32_bf16 v[92:95], v[180:183], v[236:239], v[92:95]
    s_mov_b32 s46, 278528
    v_mfma_f32_16x16x32_bf16 v[60:63], v[168:171], v[232:235], 0
    s_mov_b32 s47, 282624
    v_mfma_f32_16x16x32_bf16 v[60:63], v[172:175], v[236:239], v[60:63]
    v_mfma_f32_16x16x32_bf16 v[28:31], v[160:163], v[232:235], 0
    v_mfma_f32_16x16x32_bf16 v[28:31], v[164:167], v[236:239], v[28:31]
    s_waitcnt vmcnt(4) lgkmcnt(2)
    v_mfma_f32_16x16x32_bf16 v[0:3], v[192:195], v[240:243], v[0:3]
    ds_read_b128 v[232:235], v248 offset:20480
    v_mfma_f32_16x16x32_bf16 v[0:3], v[196:199], v[244:247], v[0:3]
    ds_read_b128 v[236:239], v249 offset:20480
    v_mfma_f32_16x16x32_bf16 v[32:35], v[200:203], v[240:243], v[32:35]
    buffer_load_dwordx4 v[160:163], v250, s[60:63], s46 offen offset:0 sc1
    v_mfma_f32_16x16x32_bf16 v[32:35], v[204:207], v[244:247], v[32:35]
    s_waitcnt vmcnt(1)
    v_mfma_f32_16x16x32_bf16 v[64:67], v[208:211], v[240:243], v[64:67]
    v_mfma_f32_16x16x32_bf16 v[64:67], v[212:215], v[244:247], v[64:67]
    buffer_load_dwordx4 v[164:167], v250, s[60:63], s46 offen offset:1024 sc1
    v_mfma_f32_16x16x32_bf16 v[96:99], v[216:219], v[240:243], v[96:99]
    v_mfma_f32_16x16x32_bf16 v[96:99], v[220:223], v[244:247], v[96:99]
    s_waitcnt lgkmcnt(2)
    v_mfma_f32_16x16x32_bf16 v[100:103], v[216:219], v[224:227], v[100:103]
    ds_read_b128 v[240:243], v248 offset:22528
    v_mfma_f32_16x16x32_bf16 v[100:103], v[220:223], v[228:231], v[100:103]
    ds_read_b128 v[244:247], v249 offset:22528
    v_mfma_f32_16x16x32_bf16 v[68:71], v[208:211], v[224:227], v[68:71]
    buffer_load_dwordx4 v[168:171], v250, s[60:63], s46 offen offset:2048 sc1
    v_mfma_f32_16x16x32_bf16 v[68:71], v[212:215], v[228:231], v[68:71]
    v_mfma_f32_16x16x32_bf16 v[36:39], v[200:203], v[224:227], v[36:39]
    v_mfma_f32_16x16x32_bf16 v[36:39], v[204:207], v[228:231], v[36:39]
    buffer_load_dwordx4 v[172:175], v250, s[60:63], s46 offen offset:3072 sc1
    v_mfma_f32_16x16x32_bf16 v[4:7], v[192:195], v[224:227], v[4:7]
    v_mfma_f32_16x16x32_bf16 v[4:7], v[196:199], v[228:231], v[4:7]
    s_waitcnt lgkmcnt(2)
    v_mfma_f32_16x16x32_bf16 v[8:11], v[192:195], v[232:235], v[8:11]
    ds_read_b128 v[224:227], v248 offset:24576
    v_mfma_f32_16x16x32_bf16 v[8:11], v[196:199], v[236:239], v[8:11]
    ds_read_b128 v[228:231], v249 offset:24576
    v_mfma_f32_16x16x32_bf16 v[40:43], v[200:203], v[232:235], v[40:43]
    buffer_load_dwordx4 v[176:179], v250, s[60:63], s47 offen offset:0 sc1
    v_mfma_f32_16x16x32_bf16 v[40:43], v[204:207], v[236:239], v[40:43]
    v_mfma_f32_16x16x32_bf16 v[72:75], v[208:211], v[232:235], v[72:75]
    v_mfma_f32_16x16x32_bf16 v[72:75], v[212:215], v[236:239], v[72:75]
    buffer_load_dwordx4 v[180:183], v250, s[60:63], s47 offen offset:1024 sc1
    v_mfma_f32_16x16x32_bf16 v[104:107], v[216:219], v[232:235], v[104:107]
    v_mfma_f32_16x16x32_bf16 v[104:107], v[220:223], v[236:239], v[104:107]
    s_waitcnt lgkmcnt(2)
    v_mfma_f32_16x16x32_bf16 v[108:111], v[216:219], v[240:243], v[108:111]
    ds_read_b128 v[232:235], v248 offset:26624
    v_mfma_f32_16x16x32_bf16 v[108:111], v[220:223], v[244:247], v[108:111]
    ds_read_b128 v[236:239], v249 offset:26624
    v_mfma_f32_16x16x32_bf16 v[76:79], v[208:211], v[240:243], v[76:79]
    buffer_load_dwordx4 v[184:187], v250, s[60:63], s47 offen offset:2048 sc1
    v_mfma_f32_16x16x32_bf16 v[76:79], v[212:215], v[244:247], v[76:79]
    v_mfma_f32_16x16x32_bf16 v[44:47], v[200:203], v[240:243], v[44:47]
    v_mfma_f32_16x16x32_bf16 v[44:47], v[204:207], v[244:247], v[44:47]
    buffer_load_dwordx4 v[188:191], v250, s[60:63], s47 offen offset:3072 sc1
    v_mfma_f32_16x16x32_bf16 v[12:15], v[192:195], v[240:243], v[12:15]
    v_mfma_f32_16x16x32_bf16 v[12:15], v[196:199], v[244:247], v[12:15]
    s_waitcnt lgkmcnt(2)
    v_mfma_f32_16x16x32_bf16 v[16:19], v[192:195], v[224:227], v[16:19]
    ds_read_b128 v[240:243], v248 offset:28672
    v_mfma_f32_16x16x32_bf16 v[16:19], v[196:199], v[228:231], v[16:19]
    ds_read_b128 v[244:247], v249 offset:28672
    v_mfma_f32_16x16x32_bf16 v[48:51], v[200:203], v[224:227], v[48:51]
    v_mfma_f32_16x16x32_bf16 v[48:51], v[204:207], v[228:231], v[48:51]
    v_mfma_f32_16x16x32_bf16 v[80:83], v[208:211], v[224:227], v[80:83]
    v_mfma_f32_16x16x32_bf16 v[80:83], v[212:215], v[228:231], v[80:83]
    v_mfma_f32_16x16x32_bf16 v[112:115], v[216:219], v[224:227], v[112:115]
    v_mfma_f32_16x16x32_bf16 v[112:115], v[220:223], v[228:231], v[112:115]
    s_waitcnt lgkmcnt(2)
    v_mfma_f32_16x16x32_bf16 v[116:119], v[216:219], v[232:235], v[116:119]
    ds_read_b128 v[224:227], v248 offset:30720
    v_mfma_f32_16x16x32_bf16 v[116:119], v[220:223], v[236:239], v[116:119]
    ds_read_b128 v[228:231], v249 offset:30720
    v_mfma_f32_16x16x32_bf16 v[84:87], v[208:211], v[232:235], v[84:87]
    v_mfma_f32_16x16x32_bf16 v[84:87], v[212:215], v[236:239], v[84:87]
    v_mfma_f32_16x16x32_bf16 v[52:55], v[200:203], v[232:235], v[52:55]
    v_mfma_f32_16x16x32_bf16 v[52:55], v[204:207], v[236:239], v[52:55]
    v_mfma_f32_16x16x32_bf16 v[20:23], v[192:195], v[232:235], v[20:23]
    v_mfma_f32_16x16x32_bf16 v[20:23], v[196:199], v[236:239], v[20:23]
    s_waitcnt lgkmcnt(2)
    v_mfma_f32_16x16x32_bf16 v[24:27], v[192:195], v[240:243], v[24:27]
    ds_read_b128 v[232:235], v248 offset:32768
    v_mfma_f32_16x16x32_bf16 v[24:27], v[196:199], v[244:247], v[24:27]
    ds_read_b128 v[236:239], v249 offset:32768
    v_mfma_f32_16x16x32_bf16 v[56:59], v[200:203], v[240:243], v[56:59]
    v_mfma_f32_16x16x32_bf16 v[56:59], v[204:207], v[244:247], v[56:59]
    v_mfma_f32_16x16x32_bf16 v[88:91], v[208:211], v[240:243], v[88:91]
    v_mfma_f32_16x16x32_bf16 v[88:91], v[212:215], v[244:247], v[88:91]
    v_mfma_f32_16x16x32_bf16 v[120:123], v[216:219], v[240:243], v[120:123]
    v_mfma_f32_16x16x32_bf16 v[120:123], v[220:223], v[244:247], v[120:123]
    s_waitcnt lgkmcnt(2)
    v_mfma_f32_16x16x32_bf16 v[124:127], v[216:219], v[224:227], v[124:127]
    ds_read_b128 v[240:243], v248 offset:34816
    v_mfma_f32_16x16x32_bf16 v[124:127], v[220:223], v[228:231], v[124:127]
    ds_read_b128 v[244:247], v249 offset:34816
    v_mfma_f32_16x16x32_bf16 v[92:95], v[208:211], v[224:227], v[92:95]
    v_mfma_f32_16x16x32_bf16 v[92:95], v[212:215], v[228:231], v[92:95]
    s_mov_b32 s46, 286720
    v_mfma_f32_16x16x32_bf16 v[60:63], v[200:203], v[224:227], v[60:63]
    s_mov_b32 s47, 290816
    v_mfma_f32_16x16x32_bf16 v[60:63], v[204:207], v[228:231], v[60:63]
    v_mfma_f32_16x16x32_bf16 v[28:31], v[192:195], v[224:227], v[28:31]
    v_mfma_f32_16x16x32_bf16 v[28:31], v[196:199], v[228:231], v[28:31]
    s_waitcnt vmcnt(4) lgkmcnt(2)
    v_mfma_f32_16x16x32_bf16 v[0:3], v[160:163], v[232:235], v[0:3]
    ds_read_b128 v[224:227], v248 offset:36864
    v_mfma_f32_16x16x32_bf16 v[0:3], v[164:167], v[236:239], v[0:3]
    ds_read_b128 v[228:231], v249 offset:36864
    v_mfma_f32_16x16x32_bf16 v[32:35], v[168:171], v[232:235], v[32:35]
    buffer_load_dwordx4 v[192:195], v250, s[60:63], s46 offen offset:0 sc1
    v_mfma_f32_16x16x32_bf16 v[32:35], v[172:175], v[236:239], v[32:35]
    s_waitcnt vmcnt(1)
    v_mfma_f32_16x16x32_bf16 v[64:67], v[176:179], v[232:235], v[64:67]
    v_mfma_f32_16x16x32_bf16 v[64:67], v[180:183], v[236:239], v[64:67]
    buffer_load_dwordx4 v[196:199], v250, s[60:63], s46 offen offset:1024 sc1
    v_mfma_f32_16x16x32_bf16 v[96:99], v[184:187], v[232:235], v[96:99]
    v_mfma_f32_16x16x32_bf16 v[96:99], v[188:191], v[236:239], v[96:99]
    s_waitcnt lgkmcnt(2)
    v_mfma_f32_16x16x32_bf16 v[100:103], v[184:187], v[240:243], v[100:103]
    ds_read_b128 v[232:235], v248 offset:38912
    v_mfma_f32_16x16x32_bf16 v[100:103], v[188:191], v[244:247], v[100:103]
    ds_read_b128 v[236:239], v249 offset:38912
    v_mfma_f32_16x16x32_bf16 v[68:71], v[176:179], v[240:243], v[68:71]
    buffer_load_dwordx4 v[200:203], v250, s[60:63], s46 offen offset:2048 sc1
    v_mfma_f32_16x16x32_bf16 v[68:71], v[180:183], v[244:247], v[68:71]
    v_mfma_f32_16x16x32_bf16 v[36:39], v[168:171], v[240:243], v[36:39]
    v_mfma_f32_16x16x32_bf16 v[36:39], v[172:175], v[244:247], v[36:39]
    buffer_load_dwordx4 v[204:207], v250, s[60:63], s46 offen offset:3072 sc1
    v_mfma_f32_16x16x32_bf16 v[4:7], v[160:163], v[240:243], v[4:7]
    v_mfma_f32_16x16x32_bf16 v[4:7], v[164:167], v[244:247], v[4:7]
    s_waitcnt lgkmcnt(2)
    v_mfma_f32_16x16x32_bf16 v[8:11], v[160:163], v[224:227], v[8:11]
    ds_read_b128 v[240:243], v248 offset:40960
    v_mfma_f32_16x16x32_bf16 v[8:11], v[164:167], v[228:231], v[8:11]
    ds_read_b128 v[244:247], v249 offset:40960
    v_mfma_f32_16x16x32_bf16 v[40:43], v[168:171], v[224:227], v[40:43]
    buffer_load_dwordx4 v[208:211], v250, s[60:63], s47 offen offset:0 sc1
    v_mfma_f32_16x16x32_bf16 v[40:43], v[172:175], v[228:231], v[40:43]
    v_mfma_f32_16x16x32_bf16 v[72:75], v[176:179], v[224:227], v[72:75]
    v_mfma_f32_16x16x32_bf16 v[72:75], v[180:183], v[228:231], v[72:75]
    buffer_load_dwordx4 v[212:215], v250, s[60:63], s47 offen offset:1024 sc1
    v_mfma_f32_16x16x32_bf16 v[104:107], v[184:187], v[224:227], v[104:107]
    v_mfma_f32_16x16x32_bf16 v[104:107], v[188:191], v[228:231], v[104:107]
    s_waitcnt lgkmcnt(2)
    v_mfma_f32_16x16x32_bf16 v[108:111], v[184:187], v[232:235], v[108:111]
    ds_read_b128 v[224:227], v248 offset:43008
    v_mfma_f32_16x16x32_bf16 v[108:111], v[188:191], v[236:239], v[108:111]
    ds_read_b128 v[228:231], v249 offset:43008
    v_mfma_f32_16x16x32_bf16 v[76:79], v[176:179], v[232:235], v[76:79]
    buffer_load_dwordx4 v[216:219], v250, s[60:63], s47 offen offset:2048 sc1
    v_mfma_f32_16x16x32_bf16 v[76:79], v[180:183], v[236:239], v[76:79]
    v_mfma_f32_16x16x32_bf16 v[44:47], v[168:171], v[232:235], v[44:47]
    v_mfma_f32_16x16x32_bf16 v[44:47], v[172:175], v[236:239], v[44:47]
    buffer_load_dwordx4 v[220:223], v250, s[60:63], s47 offen offset:3072 sc1
    v_mfma_f32_16x16x32_bf16 v[12:15], v[160:163], v[232:235], v[12:15]
    v_mfma_f32_16x16x32_bf16 v[12:15], v[164:167], v[236:239], v[12:15]
    s_waitcnt lgkmcnt(2)
    v_mfma_f32_16x16x32_bf16 v[16:19], v[160:163], v[240:243], v[16:19]
    ds_read_b128 v[232:235], v248 offset:45056
    v_mfma_f32_16x16x32_bf16 v[16:19], v[164:167], v[244:247], v[16:19]
    ds_read_b128 v[236:239], v249 offset:45056
    v_mfma_f32_16x16x32_bf16 v[48:51], v[168:171], v[240:243], v[48:51]
    v_mfma_f32_16x16x32_bf16 v[48:51], v[172:175], v[244:247], v[48:51]
    v_mfma_f32_16x16x32_bf16 v[80:83], v[176:179], v[240:243], v[80:83]
    v_mfma_f32_16x16x32_bf16 v[80:83], v[180:183], v[244:247], v[80:83]
    v_mfma_f32_16x16x32_bf16 v[112:115], v[184:187], v[240:243], v[112:115]
    v_mfma_f32_16x16x32_bf16 v[112:115], v[188:191], v[244:247], v[112:115]
    s_waitcnt lgkmcnt(2)
    v_mfma_f32_16x16x32_bf16 v[116:119], v[184:187], v[224:227], v[116:119]
    ds_read_b128 v[240:243], v248 offset:47104
    v_mfma_f32_16x16x32_bf16 v[116:119], v[188:191], v[228:231], v[116:119]
    ds_read_b128 v[244:247], v249 offset:47104
    v_mfma_f32_16x16x32_bf16 v[84:87], v[176:179], v[224:227], v[84:87]
    v_mfma_f32_16x16x32_bf16 v[84:87], v[180:183], v[228:231], v[84:87]
    v_mfma_f32_16x16x32_bf16 v[52:55], v[168:171], v[224:227], v[52:55]
    v_mfma_f32_16x16x32_bf16 v[52:55], v[172:175], v[228:231], v[52:55]
    v_mfma_f32_16x16x32_bf16 v[20:23], v[160:163], v[224:227], v[20:23]
    v_mfma_f32_16x16x32_bf16 v[20:23], v[164:167], v[228:231], v[20:23]
    s_waitcnt lgkmcnt(2)
    v_mfma_f32_16x16x32_bf16 v[24:27], v[160:163], v[232:235], v[24:27]
    ds_read_b128 v[224:227], v248 offset:49152
    v_mfma_f32_16x16x32_bf16 v[24:27], v[164:167], v[236:239], v[24:27]
    ds_read_b128 v[228:231], v249 offset:49152
    v_mfma_f32_16x16x32_bf16 v[56:59], v[168:171], v[232:235], v[56:59]
    v_mfma_f32_16x16x32_bf16 v[56:59], v[172:175], v[236:239], v[56:59]
    v_mfma_f32_16x16x32_bf16 v[88:91], v[176:179], v[232:235], v[88:91]
    v_mfma_f32_16x16x32_bf16 v[88:91], v[180:183], v[236:239], v[88:91]
    v_mfma_f32_16x16x32_bf16 v[120:123], v[184:187], v[232:235], v[120:123]
    v_mfma_f32_16x16x32_bf16 v[120:123], v[188:191], v[236:239], v[120:123]
    s_waitcnt lgkmcnt(2)
    v_mfma_f32_16x16x32_bf16 v[124:127], v[184:187], v[240:243], v[124:127]
    ds_read_b128 v[232:235], v248 offset:51200
    v_mfma_f32_16x16x32_bf16 v[124:127], v[188:191], v[244:247], v[124:127]
    ds_read_b128 v[236:239], v249 offset:51200
    v_mfma_f32_16x16x32_bf16 v[92:95], v[176:179], v[240:243], v[92:95]
    v_mfma_f32_16x16x32_bf16 v[92:95], v[180:183], v[244:247], v[92:95]
    s_mov_b32 s46, 294912
    v_mfma_f32_16x16x32_bf16 v[60:63], v[168:171], v[240:243], v[60:63]
    s_mov_b32 s47, 299008
    v_mfma_f32_16x16x32_bf16 v[60:63], v[172:175], v[244:247], v[60:63]
    v_mfma_f32_16x16x32_bf16 v[28:31], v[160:163], v[240:243], v[28:31]
    v_mfma_f32_16x16x32_bf16 v[28:31], v[164:167], v[244:247], v[28:31]
    s_waitcnt vmcnt(4) lgkmcnt(2)
    v_mfma_f32_16x16x32_bf16 v[0:3], v[192:195], v[224:227], v[0:3]
    ds_read_b128 v[240:243], v248 offset:53248
    v_mfma_f32_16x16x32_bf16 v[0:3], v[196:199], v[228:231], v[0:3]
    ds_read_b128 v[244:247], v249 offset:53248
    v_mfma_f32_16x16x32_bf16 v[32:35], v[200:203], v[224:227], v[32:35]
    buffer_load_dwordx4 v[160:163], v250, s[60:63], s46 offen offset:0 sc1
    v_mfma_f32_16x16x32_bf16 v[32:35], v[204:207], v[228:231], v[32:35]
    s_waitcnt vmcnt(1)
    v_mfma_f32_16x16x32_bf16 v[64:67], v[208:211], v[224:227], v[64:67]
    v_mfma_f32_16x16x32_bf16 v[64:67], v[212:215], v[228:231], v[64:67]
    buffer_load_dwordx4 v[164:167], v250, s[60:63], s46 offen offset:1024 sc1
    v_mfma_f32_16x16x32_bf16 v[96:99], v[216:219], v[224:227], v[96:99]
    v_mfma_f32_16x16x32_bf16 v[96:99], v[220:223], v[228:231], v[96:99]
    s_waitcnt lgkmcnt(2)
    v_mfma_f32_16x16x32_bf16 v[100:103], v[216:219], v[232:235], v[100:103]
    ds_read_b128 v[224:227], v248 offset:55296
    v_mfma_f32_16x16x32_bf16 v[100:103], v[220:223], v[236:239], v[100:103]
    ds_read_b128 v[228:231], v249 offset:55296
    v_mfma_f32_16x16x32_bf16 v[68:71], v[208:211], v[232:235], v[68:71]
    buffer_load_dwordx4 v[168:171], v250, s[60:63], s46 offen offset:2048 sc1
    v_mfma_f32_16x16x32_bf16 v[68:71], v[212:215], v[236:239], v[68:71]
    v_mfma_f32_16x16x32_bf16 v[36:39], v[200:203], v[232:235], v[36:39]
    v_mfma_f32_16x16x32_bf16 v[36:39], v[204:207], v[236:239], v[36:39]
    buffer_load_dwordx4 v[172:175], v250, s[60:63], s46 offen offset:3072 sc1
    v_mfma_f32_16x16x32_bf16 v[4:7], v[192:195], v[232:235], v[4:7]
    v_mfma_f32_16x16x32_bf16 v[4:7], v[196:199], v[236:239], v[4:7]
    s_waitcnt lgkmcnt(2)
    v_mfma_f32_16x16x32_bf16 v[8:11], v[192:195], v[240:243], v[8:11]
    ds_read_b128 v[232:235], v248 offset:57344
    v_mfma_f32_16x16x32_bf16 v[8:11], v[196:199], v[244:247], v[8:11]
    ds_read_b128 v[236:239], v249 offset:57344
    v_mfma_f32_16x16x32_bf16 v[40:43], v[200:203], v[240:243], v[40:43]
    buffer_load_dwordx4 v[176:179], v250, s[60:63], s47 offen offset:0 sc1
    v_mfma_f32_16x16x32_bf16 v[40:43], v[204:207], v[244:247], v[40:43]
    v_mfma_f32_16x16x32_bf16 v[72:75], v[208:211], v[240:243], v[72:75]
    v_mfma_f32_16x16x32_bf16 v[72:75], v[212:215], v[244:247], v[72:75]
    buffer_load_dwordx4 v[180:183], v250, s[60:63], s47 offen offset:1024 sc1
    v_mfma_f32_16x16x32_bf16 v[104:107], v[216:219], v[240:243], v[104:107]
    v_mfma_f32_16x16x32_bf16 v[104:107], v[220:223], v[244:247], v[104:107]
    s_waitcnt lgkmcnt(2)
    v_mfma_f32_16x16x32_bf16 v[108:111], v[216:219], v[224:227], v[108:111]
    ds_read_b128 v[240:243], v248 offset:59392
    v_mfma_f32_16x16x32_bf16 v[108:111], v[220:223], v[228:231], v[108:111]
    ds_read_b128 v[244:247], v249 offset:59392
    v_mfma_f32_16x16x32_bf16 v[76:79], v[208:211], v[224:227], v[76:79]
    buffer_load_dwordx4 v[184:187], v250, s[60:63], s47 offen offset:2048 sc1
    v_mfma_f32_16x16x32_bf16 v[76:79], v[212:215], v[228:231], v[76:79]
    v_mfma_f32_16x16x32_bf16 v[44:47], v[200:203], v[224:227], v[44:47]
    v_mfma_f32_16x16x32_bf16 v[44:47], v[204:207], v[228:231], v[44:47]
    buffer_load_dwordx4 v[188:191], v250, s[60:63], s47 offen offset:3072 sc1
    v_mfma_f32_16x16x32_bf16 v[12:15], v[192:195], v[224:227], v[12:15]
    v_mfma_f32_16x16x32_bf16 v[12:15], v[196:199], v[228:231], v[12:15]
    s_waitcnt lgkmcnt(2)
    v_mfma_f32_16x16x32_bf16 v[16:19], v[192:195], v[232:235], v[16:19]
    ds_read_b128 v[224:227], v248 offset:61440
    v_mfma_f32_16x16x32_bf16 v[16:19], v[196:199], v[236:239], v[16:19]
    ds_read_b128 v[228:231], v249 offset:61440
    v_mfma_f32_16x16x32_bf16 v[48:51], v[200:203], v[232:235], v[48:51]
    v_mfma_f32_16x16x32_bf16 v[48:51], v[204:207], v[236:239], v[48:51]
    v_mfma_f32_16x16x32_bf16 v[80:83], v[208:211], v[232:235], v[80:83]
    s_setprio 2
    v_mfma_f32_16x16x32_bf16 v[80:83], v[212:215], v[236:239], v[80:83]
    v_mfma_f32_16x16x32_bf16 v[112:115], v[216:219], v[232:235], v[112:115]
    v_mfma_f32_16x16x32_bf16 v[112:115], v[220:223], v[236:239], v[112:115]
    s_waitcnt lgkmcnt(2)
    v_mfma_f32_16x16x32_bf16 v[116:119], v[216:219], v[240:243], v[116:119]
    ds_read_b128 v[232:235], v248 offset:63488
    v_mfma_f32_16x16x32_bf16 v[116:119], v[220:223], v[244:247], v[116:119]
    ds_read_b128 v[236:239], v249 offset:63488
    v_mfma_f32_16x16x32_bf16 v[84:87], v[208:211], v[240:243], v[84:87]
    v_mfma_f32_16x16x32_bf16 v[84:87], v[212:215], v[244:247], v[84:87]
    v_add_u32 v248, 0x10000, v248
    v_mfma_f32_16x16x32_bf16 v[52:55], v[200:203], v[240:243], v[52:55]
    v_add_u32 v249, 0x10000, v249
    v_mfma_f32_16x16x32_bf16 v[52:55], v[204:207], v[244:247], v[52:55]
    v_mfma_f32_16x16x32_bf16 v[20:23], v[192:195], v[240:243], v[20:23]
    v_mfma_f32_16x16x32_bf16 v[20:23], v[196:199], v[244:247], v[20:23]
    s_waitcnt lgkmcnt(2)
    v_mfma_f32_16x16x32_bf16 v[24:27], v[192:195], v[224:227], v[24:27]
    ds_read_b128 v[240:243], v248 offset:0
    v_mfma_f32_16x16x32_bf16 v[24:27], v[196:199], v[228:231], v[24:27]
    ds_read_b128 v[244:247], v249 offset:0
    v_mfma_f32_16x16x32_bf16 v[56:59], v[200:203], v[224:227], v[56:59]
    v_mfma_f32_16x16x32_bf16 v[56:59], v[204:207], v[228:231], v[56:59]
    v_mfma_f32_16x16x32_bf16 v[88:91], v[208:211], v[224:227], v[88:91]
    v_mfma_f32_16x16x32_bf16 v[88:91], v[212:215], v[228:231], v[88:91]
    v_mfma_f32_16x16x32_bf16 v[120:123], v[216:219], v[224:227], v[120:123]
    v_mfma_f32_16x16x32_bf16 v[120:123], v[220:223], v[228:231], v[120:123]
    s_waitcnt lgkmcnt(2)
    v_mfma_f32_16x16x32_bf16 v[124:127], v[216:219], v[232:235], v[124:127]
    ds_read_b128 v[224:227], v248 offset:2048
    v_mfma_f32_16x16x32_bf16 v[124:127], v[220:223], v[236:239], v[124:127]
    ds_read_b128 v[228:231], v249 offset:2048
    v_mfma_f32_16x16x32_bf16 v[92:95], v[208:211], v[232:235], v[92:95]
    v_mfma_f32_16x16x32_bf16 v[92:95], v[212:215], v[236:239], v[92:95]
    s_mov_b32 s46, 303104
    v_mfma_f32_16x16x32_bf16 v[60:63], v[200:203], v[232:235], v[60:63]
    s_mov_b32 s47, 307200
    v_mfma_f32_16x16x32_bf16 v[60:63], v[204:207], v[236:239], v[60:63]
    v_mfma_f32_16x16x32_bf16 v[28:31], v[192:195], v[232:235], v[28:31]
    v_mfma_f32_16x16x32_bf16 v[28:31], v[196:199], v[236:239], v[28:31]
    s_waitcnt vmcnt(4) lgkmcnt(2)
    v_mfma_f32_16x16x32_bf16 v[0:3], v[160:163], v[240:243], v[0:3]
    ds_read_b128 v[232:235], v248 offset:4096
    v_mfma_f32_16x16x32_bf16 v[0:3], v[164:167], v[244:247], v[0:3]
    ds_read_b128 v[236:239], v249 offset:4096
    v_mfma_f32_16x16x32_bf16 v[32:35], v[168:171], v[240:243], v[32:35]
    buffer_load_dwordx4 v[192:195], v250, s[60:63], s46 offen offset:0 sc1
    v_mfma_f32_16x16x32_bf16 v[32:35], v[172:175], v[244:247], v[32:35]
    s_waitcnt vmcnt(1)
    v_mfma_f32_16x16x32_bf16 v[64:67], v[176:179], v[240:243], v[64:67]
    v_mfma_f32_16x16x32_bf16 v[64:67], v[180:183], v[244:247], v[64:67]
    buffer_load_dwordx4 v[196:199], v250, s[60:63], s46 offen offset:1024 sc1
    v_mfma_f32_16x16x32_bf16 v[96:99], v[184:187], v[240:243], v[96:99]
    v_mfma_f32_16x16x32_bf16 v[96:99], v[188:191], v[244:247], v[96:99]
    s_waitcnt lgkmcnt(2)
    v_mfma_f32_16x16x32_bf16 v[100:103], v[184:187], v[224:227], v[100:103]
    ds_read_b128 v[240:243], v248 offset:6144
    v_mfma_f32_16x16x32_bf16 v[100:103], v[188:191], v[228:231], v[100:103]
    ds_read_b128 v[244:247], v249 offset:6144
    v_mfma_f32_16x16x32_bf16 v[68:71], v[176:179], v[224:227], v[68:71]
    buffer_load_dwordx4 v[200:203], v250, s[60:63], s46 offen offset:2048 sc1
    v_mfma_f32_16x16x32_bf16 v[68:71], v[180:183], v[228:231], v[68:71]
    v_mfma_f32_16x16x32_bf16 v[36:39], v[168:171], v[224:227], v[36:39]
    v_mfma_f32_16x16x32_bf16 v[36:39], v[172:175], v[228:231], v[36:39]
    buffer_load_dwordx4 v[204:207], v250, s[60:63], s46 offen offset:3072 sc1
    v_mfma_f32_16x16x32_bf16 v[4:7], v[160:163], v[224:227], v[4:7]
    v_mfma_f32_16x16x32_bf16 v[4:7], v[164:167], v[228:231], v[4:7]
    s_waitcnt lgkmcnt(2)
    v_mfma_f32_16x16x32_bf16 v[8:11], v[160:163], v[232:235], v[8:11]
    ds_read_b128 v[224:227], v248 offset:8192
    v_mfma_f32_16x16x32_bf16 v[8:11], v[164:167], v[236:239], v[8:11]
    ds_read_b128 v[228:231], v249 offset:8192
    v_mfma_f32_16x16x32_bf16 v[40:43], v[168:171], v[232:235], v[40:43]
    buffer_load_dwordx4 v[208:211], v250, s[60:63], s47 offen offset:0 sc1
    v_mfma_f32_16x16x32_bf16 v[40:43], v[172:175], v[236:239], v[40:43]
    v_mfma_f32_16x16x32_bf16 v[72:75], v[176:179], v[232:235], v[72:75]
    v_mfma_f32_16x16x32_bf16 v[72:75], v[180:183], v[236:239], v[72:75]
    buffer_load_dwordx4 v[212:215], v250, s[60:63], s47 offen offset:1024 sc1
    v_mfma_f32_16x16x32_bf16 v[104:107], v[184:187], v[232:235], v[104:107]
    v_mfma_f32_16x16x32_bf16 v[104:107], v[188:191], v[236:239], v[104:107]
    s_waitcnt lgkmcnt(2)
    v_mfma_f32_16x16x32_bf16 v[108:111], v[184:187], v[240:243], v[108:111]
    ds_read_b128 v[232:235], v248 offset:10240
    v_mfma_f32_16x16x32_bf16 v[108:111], v[188:191], v[244:247], v[108:111]
    ds_read_b128 v[236:239], v249 offset:10240
    v_mfma_f32_16x16x32_bf16 v[76:79], v[176:179], v[240:243], v[76:79]
    buffer_load_dwordx4 v[216:219], v250, s[60:63], s47 offen offset:2048 sc1
    v_mfma_f32_16x16x32_bf16 v[76:79], v[180:183], v[244:247], v[76:79]
    v_mfma_f32_16x16x32_bf16 v[44:47], v[168:171], v[240:243], v[44:47]
    v_mfma_f32_16x16x32_bf16 v[44:47], v[172:175], v[244:247], v[44:47]
    buffer_load_dwordx4 v[220:223], v250, s[60:63], s47 offen offset:3072 sc1
    v_mfma_f32_16x16x32_bf16 v[12:15], v[160:163], v[240:243], v[12:15]
    v_mfma_f32_16x16x32_bf16 v[12:15], v[164:167], v[244:247], v[12:15]
    s_waitcnt lgkmcnt(2)
    v_mfma_f32_16x16x32_bf16 v[16:19], v[160:163], v[224:227], v[16:19]
    ds_read_b128 v[240:243], v248 offset:12288
    v_mfma_f32_16x16x32_bf16 v[16:19], v[164:167], v[228:231], v[16:19]
    ds_read_b128 v[244:247], v249 offset:12288
    v_mfma_f32_16x16x32_bf16 v[48:51], v[168:171], v[224:227], v[48:51]
    v_mfma_f32_16x16x32_bf16 v[48:51], v[172:175], v[228:231], v[48:51]
    v_mfma_f32_16x16x32_bf16 v[80:83], v[176:179], v[224:227], v[80:83]
    v_mfma_f32_16x16x32_bf16 v[80:83], v[180:183], v[228:231], v[80:83]
    v_mfma_f32_16x16x32_bf16 v[112:115], v[184:187], v[224:227], v[112:115]
    v_mfma_f32_16x16x32_bf16 v[112:115], v[188:191], v[228:231], v[112:115]
    s_waitcnt lgkmcnt(2)
    v_mfma_f32_16x16x32_bf16 v[116:119], v[184:187], v[232:235], v[116:119]
    ds_read_b128 v[224:227], v248 offset:14336
    v_mfma_f32_16x16x32_bf16 v[116:119], v[188:191], v[236:239], v[116:119]
    ds_read_b128 v[228:231], v249 offset:14336
    v_mfma_f32_16x16x32_bf16 v[84:87], v[176:179], v[232:235], v[84:87]
    v_mfma_f32_16x16x32_bf16 v[84:87], v[180:183], v[236:239], v[84:87]
    v_mfma_f32_16x16x32_bf16 v[52:55], v[168:171], v[232:235], v[52:55]
    v_mfma_f32_16x16x32_bf16 v[52:55], v[172:175], v[236:239], v[52:55]
    v_mfma_f32_16x16x32_bf16 v[20:23], v[160:163], v[232:235], v[20:23]
    v_mfma_f32_16x16x32_bf16 v[20:23], v[164:167], v[236:239], v[20:23]
    s_waitcnt lgkmcnt(2)
    v_mfma_f32_16x16x32_bf16 v[24:27], v[160:163], v[240:243], v[24:27]
    ds_read_b128 v[232:235], v248 offset:16384
    v_mfma_f32_16x16x32_bf16 v[24:27], v[164:167], v[244:247], v[24:27]
    ds_read_b128 v[236:239], v249 offset:16384
    v_mfma_f32_16x16x32_bf16 v[56:59], v[168:171], v[240:243], v[56:59]
    v_mfma_f32_16x16x32_bf16 v[56:59], v[172:175], v[244:247], v[56:59]
    v_mfma_f32_16x16x32_bf16 v[88:91], v[176:179], v[240:243], v[88:91]
    v_mfma_f32_16x16x32_bf16 v[88:91], v[180:183], v[244:247], v[88:91]
    v_mfma_f32_16x16x32_bf16 v[120:123], v[184:187], v[240:243], v[120:123]
    v_mfma_f32_16x16x32_bf16 v[120:123], v[188:191], v[244:247], v[120:123]
    s_waitcnt lgkmcnt(2)
    v_mfma_f32_16x16x32_bf16 v[124:127], v[184:187], v[224:227], v[124:127]
    ds_read_b128 v[240:243], v248 offset:18432
    v_mfma_f32_16x16x32_bf16 v[124:127], v[188:191], v[228:231], v[124:127]
    ds_read_b128 v[244:247], v249 offset:18432
    v_mfma_f32_16x16x32_bf16 v[92:95], v[176:179], v[224:227], v[92:95]
    v_mfma_f32_16x16x32_bf16 v[92:95], v[180:183], v[228:231], v[92:95]
    s_mov_b32 s46, 311296
    v_mfma_f32_16x16x32_bf16 v[60:63], v[168:171], v[224:227], v[60:63]
    s_mov_b32 s47, 315392
    v_mfma_f32_16x16x32_bf16 v[60:63], v[172:175], v[228:231], v[60:63]
    v_mfma_f32_16x16x32_bf16 v[28:31], v[160:163], v[224:227], v[28:31]
    v_mfma_f32_16x16x32_bf16 v[28:31], v[164:167], v[228:231], v[28:31]
    s_waitcnt vmcnt(4) lgkmcnt(2)
    v_mfma_f32_16x16x32_bf16 v[0:3], v[192:195], v[232:235], v[0:3]
    ds_read_b128 v[224:227], v248 offset:20480
    v_mfma_f32_16x16x32_bf16 v[0:3], v[196:199], v[236:239], v[0:3]
    ds_read_b128 v[228:231], v249 offset:20480
    v_mfma_f32_16x16x32_bf16 v[32:35], v[200:203], v[232:235], v[32:35]
    buffer_load_dwordx4 v[160:163], v250, s[60:63], s46 offen offset:0 sc1
    v_mfma_f32_16x16x32_bf16 v[32:35], v[204:207], v[236:239], v[32:35]
    s_waitcnt vmcnt(1)
    v_mfma_f32_16x16x32_bf16 v[64:67], v[208:211], v[232:235], v[64:67]
    v_mfma_f32_16x16x32_bf16 v[64:67], v[212:215], v[236:239], v[64:67]
    buffer_load_dwordx4 v[164:167], v250, s[60:63], s46 offen offset:1024 sc1
    v_mfma_f32_16x16x32_bf16 v[96:99], v[216:219], v[232:235], v[96:99]
    v_mfma_f32_16x16x32_bf16 v[96:99], v[220:223], v[236:239], v[96:99]
    s_waitcnt lgkmcnt(2)
    v_mfma_f32_16x16x32_bf16 v[100:103], v[216:219], v[240:243], v[100:103]
    ds_read_b128 v[232:235], v248 offset:22528
    v_mfma_f32_16x16x32_bf16 v[100:103], v[220:223], v[244:247], v[100:103]
    ds_read_b128 v[236:239], v249 offset:22528
    v_mfma_f32_16x16x32_bf16 v[68:71], v[208:211], v[240:243], v[68:71]
    buffer_load_dwordx4 v[168:171], v250, s[60:63], s46 offen offset:2048 sc1
    v_mfma_f32_16x16x32_bf16 v[68:71], v[212:215], v[244:247], v[68:71]
    v_mfma_f32_16x16x32_bf16 v[36:39], v[200:203], v[240:243], v[36:39]
    v_mfma_f32_16x16x32_bf16 v[36:39], v[204:207], v[244:247], v[36:39]
    buffer_load_dwordx4 v[172:175], v250, s[60:63], s46 offen offset:3072 sc1
    v_mfma_f32_16x16x32_bf16 v[4:7], v[192:195], v[240:243], v[4:7]
    v_mfma_f32_16x16x32_bf16 v[4:7], v[196:199], v[244:247], v[4:7]
    s_waitcnt lgkmcnt(2)
    v_mfma_f32_16x16x32_bf16 v[8:11], v[192:195], v[224:227], v[8:11]
    ds_read_b128 v[240:243], v248 offset:24576
    v_mfma_f32_16x16x32_bf16 v[8:11], v[196:199], v[228:231], v[8:11]
    ds_read_b128 v[244:247], v249 offset:24576
    v_mfma_f32_16x16x32_bf16 v[40:43], v[200:203], v[224:227], v[40:43]
    buffer_load_dwordx4 v[176:179], v250, s[60:63], s47 offen offset:0 sc1
    v_mfma_f32_16x16x32_bf16 v[40:43], v[204:207], v[228:231], v[40:43]
    v_mfma_f32_16x16x32_bf16 v[72:75], v[208:211], v[224:227], v[72:75]
    v_mfma_f32_16x16x32_bf16 v[72:75], v[212:215], v[228:231], v[72:75]
    buffer_load_dwordx4 v[180:183], v250, s[60:63], s47 offen offset:1024 sc1
    v_mfma_f32_16x16x32_bf16 v[104:107], v[216:219], v[224:227], v[104:107]
    v_mfma_f32_16x16x32_bf16 v[104:107], v[220:223], v[228:231], v[104:107]
    s_waitcnt lgkmcnt(2)
    v_mfma_f32_16x16x32_bf16 v[108:111], v[216:219], v[232:235], v[108:111]
    ds_read_b128 v[224:227], v248 offset:26624
    v_mfma_f32_16x16x32_bf16 v[108:111], v[220:223], v[236:239], v[108:111]
    ds_read_b128 v[228:231], v249 offset:26624
    v_mfma_f32_16x16x32_bf16 v[76:79], v[208:211], v[232:235], v[76:79]
    buffer_load_dwordx4 v[184:187], v250, s[60:63], s47 offen offset:2048 sc1
    v_mfma_f32_16x16x32_bf16 v[76:79], v[212:215], v[236:239], v[76:79]
    v_mfma_f32_16x16x32_bf16 v[44:47], v[200:203], v[232:235], v[44:47]
    v_mfma_f32_16x16x32_bf16 v[44:47], v[204:207], v[236:239], v[44:47]
    buffer_load_dwordx4 v[188:191], v250, s[60:63], s47 offen offset:3072 sc1
    v_mfma_f32_16x16x32_bf16 v[12:15], v[192:195], v[232:235], v[12:15]
    v_mfma_f32_16x16x32_bf16 v[12:15], v[196:199], v[236:239], v[12:15]
    s_waitcnt lgkmcnt(2)
    v_mfma_f32_16x16x32_bf16 v[16:19], v[192:195], v[240:243], v[16:19]
    ds_read_b128 v[232:235], v248 offset:28672
    v_mfma_f32_16x16x32_bf16 v[16:19], v[196:199], v[244:247], v[16:19]
    ds_read_b128 v[236:239], v249 offset:28672
    v_mfma_f32_16x16x32_bf16 v[48:51], v[200:203], v[240:243], v[48:51]
    v_mfma_f32_16x16x32_bf16 v[48:51], v[204:207], v[244:247], v[48:51]
    v_mfma_f32_16x16x32_bf16 v[80:83], v[208:211], v[240:243], v[80:83]
    v_mfma_f32_16x16x32_bf16 v[80:83], v[212:215], v[244:247], v[80:83]
    v_mfma_f32_16x16x32_bf16 v[112:115], v[216:219], v[240:243], v[112:115]
    v_mfma_f32_16x16x32_bf16 v[112:115], v[220:223], v[244:247], v[112:115]
    s_waitcnt lgkmcnt(2)
    v_mfma_f32_16x16x32_bf16 v[116:119], v[216:219], v[224:227], v[116:119]
    ds_read_b128 v[240:243], v248 offset:30720
    v_mfma_f32_16x16x32_bf16 v[116:119], v[220:223], v[228:231], v[116:119]
    ds_read_b128 v[244:247], v249 offset:30720
    v_mfma_f32_16x16x32_bf16 v[84:87], v[208:211], v[224:227], v[84:87]
    v_mfma_f32_16x16x32_bf16 v[84:87], v[212:215], v[228:231], v[84:87]
    v_mfma_f32_16x16x32_bf16 v[52:55], v[200:203], v[224:227], v[52:55]
    v_mfma_f32_16x16x32_bf16 v[52:55], v[204:207], v[228:231], v[52:55]
    v_mfma_f32_16x16x32_bf16 v[20:23], v[192:195], v[224:227], v[20:23]
    v_mfma_f32_16x16x32_bf16 v[20:23], v[196:199], v[228:231], v[20:23]
    s_waitcnt lgkmcnt(2)
    v_mfma_f32_16x16x32_bf16 v[24:27], v[192:195], v[232:235], v[24:27]
    ds_read_b128 v[224:227], v248 offset:32768
    v_mfma_f32_16x16x32_bf16 v[24:27], v[196:199], v[236:239], v[24:27]
    ds_read_b128 v[228:231], v249 offset:32768
    v_mfma_f32_16x16x32_bf16 v[56:59], v[200:203], v[232:235], v[56:59]
    v_mfma_f32_16x16x32_bf16 v[56:59], v[204:207], v[236:239], v[56:59]
    v_mfma_f32_16x16x32_bf16 v[88:91], v[208:211], v[232:235], v[88:91]
    v_mfma_f32_16x16x32_bf16 v[88:91], v[212:215], v[236:239], v[88:91]
    v_mfma_f32_16x16x32_bf16 v[120:123], v[216:219], v[232:235], v[120:123]
    v_mfma_f32_16x16x32_bf16 v[120:123], v[220:223], v[236:239], v[120:123]
    s_waitcnt lgkmcnt(2)
    v_mfma_f32_16x16x32_bf16 v[124:127], v[216:219], v[240:243], v[124:127]
    ds_read_b128 v[232:235], v248 offset:34816
    v_mfma_f32_16x16x32_bf16 v[124:127], v[220:223], v[244:247], v[124:127]
    ds_read_b128 v[236:239], v249 offset:34816
    v_mfma_f32_16x16x32_bf16 v[92:95], v[208:211], v[240:243], v[92:95]
    v_mfma_f32_16x16x32_bf16 v[92:95], v[212:215], v[244:247], v[92:95]
    s_mov_b32 s46, 319488
    v_mfma_f32_16x16x32_bf16 v[60:63], v[200:203], v[240:243], v[60:63]
    s_mov_b32 s47, 323584
    v_mfma_f32_16x16x32_bf16 v[60:63], v[204:207], v[244:247], v[60:63]
    v_mfma_f32_16x16x32_bf16 v[28:31], v[192:195], v[240:243], v[28:31]
    v_mfma_f32_16x16x32_bf16 v[28:31], v[196:199], v[244:247], v[28:31]
    s_waitcnt vmcnt(4) lgkmcnt(2)
    v_mfma_f32_16x16x32_bf16 v[0:3], v[160:163], v[224:227], v[0:3]
    ds_read_b128 v[240:243], v248 offset:36864
    v_mfma_f32_16x16x32_bf16 v[0:3], v[164:167], v[228:231], v[0:3]
    ds_read_b128 v[244:247], v249 offset:36864
    v_mfma_f32_16x16x32_bf16 v[32:35], v[168:171], v[224:227], v[32:35]
    buffer_load_dwordx4 v[192:195], v250, s[60:63], s46 offen offset:0 sc1
    v_mfma_f32_16x16x32_bf16 v[32:35], v[172:175], v[228:231], v[32:35]
    s_waitcnt vmcnt(1)
    v_mfma_f32_16x16x32_bf16 v[64:67], v[176:179], v[224:227], v[64:67]
    v_mfma_f32_16x16x32_bf16 v[64:67], v[180:183], v[228:231], v[64:67]
    buffer_load_dwordx4 v[196:199], v250, s[60:63], s46 offen offset:1024 sc1
    v_mfma_f32_16x16x32_bf16 v[96:99], v[184:187], v[224:227], v[96:99]
    v_mfma_f32_16x16x32_bf16 v[96:99], v[188:191], v[228:231], v[96:99]
    s_waitcnt lgkmcnt(2)
    v_mfma_f32_16x16x32_bf16 v[100:103], v[184:187], v[232:235], v[100:103]
    ds_read_b128 v[224:227], v248 offset:38912
    v_mfma_f32_16x16x32_bf16 v[100:103], v[188:191], v[236:239], v[100:103]
    ds_read_b128 v[228:231], v249 offset:38912
    v_mfma_f32_16x16x32_bf16 v[68:71], v[176:179], v[232:235], v[68:71]
    buffer_load_dwordx4 v[200:203], v250, s[60:63], s46 offen offset:2048 sc1
    v_mfma_f32_16x16x32_bf16 v[68:71], v[180:183], v[236:239], v[68:71]
    v_mfma_f32_16x16x32_bf16 v[36:39], v[168:171], v[232:235], v[36:39]
    v_mfma_f32_16x16x32_bf16 v[36:39], v[172:175], v[236:239], v[36:39]
    buffer_load_dwordx4 v[204:207], v250, s[60:63], s46 offen offset:3072 sc1
    v_mfma_f32_16x16x32_bf16 v[4:7], v[160:163], v[232:235], v[4:7]
    v_mfma_f32_16x16x32_bf16 v[4:7], v[164:167], v[236:239], v[4:7]
    s_waitcnt lgkmcnt(2)
    v_mfma_f32_16x16x32_bf16 v[8:11], v[160:163], v[240:243], v[8:11]
    ds_read_b128 v[232:235], v248 offset:40960
    v_mfma_f32_16x16x32_bf16 v[8:11], v[164:167], v[244:247], v[8:11]
    ds_read_b128 v[236:239], v249 offset:40960
    v_mfma_f32_16x16x32_bf16 v[40:43], v[168:171], v[240:243], v[40:43]
    buffer_load_dwordx4 v[208:211], v250, s[60:63], s47 offen offset:0 sc1
    v_mfma_f32_16x16x32_bf16 v[40:43], v[172:175], v[244:247], v[40:43]
    v_mfma_f32_16x16x32_bf16 v[72:75], v[176:179], v[240:243], v[72:75]
    v_mfma_f32_16x16x32_bf16 v[72:75], v[180:183], v[244:247], v[72:75]
    buffer_load_dwordx4 v[212:215], v250, s[60:63], s47 offen offset:1024 sc1
    v_mfma_f32_16x16x32_bf16 v[104:107], v[184:187], v[240:243], v[104:107]
    v_mfma_f32_16x16x32_bf16 v[104:107], v[188:191], v[244:247], v[104:107]
    s_waitcnt lgkmcnt(2)
    v_mfma_f32_16x16x32_bf16 v[108:111], v[184:187], v[224:227], v[108:111]
    ds_read_b128 v[240:243], v248 offset:43008
    v_mfma_f32_16x16x32_bf16 v[108:111], v[188:191], v[228:231], v[108:111]
    ds_read_b128 v[244:247], v249 offset:43008
    v_mfma_f32_16x16x32_bf16 v[76:79], v[176:179], v[224:227], v[76:79]
    buffer_load_dwordx4 v[216:219], v250, s[60:63], s47 offen offset:2048 sc1
    v_mfma_f32_16x16x32_bf16 v[76:79], v[180:183], v[228:231], v[76:79]
    v_mfma_f32_16x16x32_bf16 v[44:47], v[168:171], v[224:227], v[44:47]
    v_mfma_f32_16x16x32_bf16 v[44:47], v[172:175], v[228:231], v[44:47]
    buffer_load_dwordx4 v[220:223], v250, s[60:63], s47 offen offset:3072 sc1
    v_mfma_f32_16x16x32_bf16 v[12:15], v[160:163], v[224:227], v[12:15]
    v_mfma_f32_16x16x32_bf16 v[12:15], v[164:167], v[228:231], v[12:15]
    s_waitcnt lgkmcnt(2)
    v_mfma_f32_16x16x32_bf16 v[16:19], v[160:163], v[232:235], v[16:19]
    ds_read_b128 v[224:227], v248 offset:45056
    v_mfma_f32_16x16x32_bf16 v[16:19], v[164:167], v[236:239], v[16:19]
    ds_read_b128 v[228:231], v249 offset:45056
    v_mfma_f32_16x16x32_bf16 v[48:51], v[168:171], v[232:235], v[48:51]
    v_mfma_f32_16x16x32_bf16 v[48:51], v[172:175], v[236:239], v[48:51]
    v_mfma_f32_16x16x32_bf16 v[80:83], v[176:179], v[232:235], v[80:83]
    v_mfma_f32_16x16x32_bf16 v[80:83], v[180:183], v[236:239], v[80:83]
    v_mfma_f32_16x16x32_bf16 v[112:115], v[184:187], v[232:235], v[112:115]
    v_mfma_f32_16x16x32_bf16 v[112:115], v[188:191], v[236:239], v[112:115]
    s_waitcnt lgkmcnt(2)
    v_mfma_f32_16x16x32_bf16 v[116:119], v[184:187], v[240:243], v[116:119]
    ds_read_b128 v[232:235], v248 offset:47104
    v_mfma_f32_16x16x32_bf16 v[116:119], v[188:191], v[244:247], v[116:119]
    ds_read_b128 v[236:239], v249 offset:47104
    v_mfma_f32_16x16x32_bf16 v[84:87], v[176:179], v[240:243], v[84:87]
    v_mfma_f32_16x16x32_bf16 v[84:87], v[180:183], v[244:247], v[84:87]
    v_mfma_f32_16x16x32_bf16 v[52:55], v[168:171], v[240:243], v[52:55]
    v_mfma_f32_16x16x32_bf16 v[52:55], v[172:175], v[244:247], v[52:55]
    v_mfma_f32_16x16x32_bf16 v[20:23], v[160:163], v[240:243], v[20:23]
    v_mfma_f32_16x16x32_bf16 v[20:23], v[164:167], v[244:247], v[20:23]
    s_waitcnt lgkmcnt(2)
    v_mfma_f32_16x16x32_bf16 v[24:27], v[160:163], v[224:227], v[24:27]
    ds_read_b128 v[240:243], v248 offset:49152
    v_mfma_f32_16x16x32_bf16 v[24:27], v[164:167], v[228:231], v[24:27]
    ds_read_b128 v[244:247], v249 offset:49152
    v_mfma_f32_16x16x32_bf16 v[56:59], v[168:171], v[224:227], v[56:59]
    v_mfma_f32_16x16x32_bf16 v[56:59], v[172:175], v[228:231], v[56:59]
    v_mfma_f32_16x16x32_bf16 v[88:91], v[176:179], v[224:227], v[88:91]
    v_mfma_f32_16x16x32_bf16 v[88:91], v[180:183], v[228:231], v[88:91]
    v_mfma_f32_16x16x32_bf16 v[120:123], v[184:187], v[224:227], v[120:123]
    v_mfma_f32_16x16x32_bf16 v[120:123], v[188:191], v[228:231], v[120:123]
    s_waitcnt lgkmcnt(2)
    v_mfma_f32_16x16x32_bf16 v[124:127], v[184:187], v[232:235], v[124:127]
    ds_read_b128 v[224:227], v248 offset:51200
    v_mfma_f32_16x16x32_bf16 v[124:127], v[188:191], v[236:239], v[124:127]
    ds_read_b128 v[228:231], v249 offset:51200
    v_mfma_f32_16x16x32_bf16 v[92:95], v[176:179], v[232:235], v[92:95]
    v_mfma_f32_16x16x32_bf16 v[92:95], v[180:183], v[236:239], v[92:95]
    v_mfma_f32_16x16x32_bf16 v[60:63], v[168:171], v[232:235], v[60:63]
    v_mfma_f32_16x16x32_bf16 v[60:63], v[172:175], v[236:239], v[60:63]
    v_mfma_f32_16x16x32_bf16 v[28:31], v[160:163], v[232:235], v[28:31]
    v_mfma_f32_16x16x32_bf16 v[28:31], v[164:167], v[236:239], v[28:31]
    s_waitcnt vmcnt(4) lgkmcnt(2)
    v_mfma_f32_16x16x32_bf16 v[0:3], v[192:195], v[240:243], v[0:3]
    ds_read_b128 v[232:235], v248 offset:53248
    v_mfma_f32_16x16x32_bf16 v[0:3], v[196:199], v[244:247], v[0:3]
    ds_read_b128 v[236:239], v249 offset:53248
    v_mfma_f32_16x16x32_bf16 v[32:35], v[200:203], v[240:243], v[32:35]
    v_mfma_f32_16x16x32_bf16 v[32:35], v[204:207], v[244:247], v[32:35]
    s_waitcnt vmcnt(0)
    v_mfma_f32_16x16x32_bf16 v[64:67], v[208:211], v[240:243], v[64:67]
    v_mfma_f32_16x16x32_bf16 v[64:67], v[212:215], v[244:247], v[64:67]
    v_mfma_f32_16x16x32_bf16 v[96:99], v[216:219], v[240:243], v[96:99]
    v_mfma_f32_16x16x32_bf16 v[96:99], v[220:223], v[244:247], v[96:99]
    s_waitcnt lgkmcnt(2)
    v_mfma_f32_16x16x32_bf16 v[100:103], v[216:219], v[224:227], v[100:103]
    ds_read_b128 v[240:243], v248 offset:55296
    v_mfma_f32_16x16x32_bf16 v[100:103], v[220:223], v[228:231], v[100:103]
    ds_read_b128 v[244:247], v249 offset:55296
    v_mfma_f32_16x16x32_bf16 v[68:71], v[208:211], v[224:227], v[68:71]
    v_mfma_f32_16x16x32_bf16 v[68:71], v[212:215], v[228:231], v[68:71]
    v_mfma_f32_16x16x32_bf16 v[36:39], v[200:203], v[224:227], v[36:39]
    v_mfma_f32_16x16x32_bf16 v[36:39], v[204:207], v[228:231], v[36:39]
    v_mfma_f32_16x16x32_bf16 v[4:7], v[192:195], v[224:227], v[4:7]
    v_mfma_f32_16x16x32_bf16 v[4:7], v[196:199], v[228:231], v[4:7]
    s_waitcnt lgkmcnt(2)
    v_mfma_f32_16x16x32_bf16 v[8:11], v[192:195], v[232:235], v[8:11]
    ds_read_b128 v[224:227], v248 offset:57344
    v_mfma_f32_16x16x32_bf16 v[8:11], v[196:199], v[236:239], v[8:11]
    ds_read_b128 v[228:231], v249 offset:57344
    v_mfma_f32_16x16x32_bf16 v[40:43], v[200:203], v[232:235], v[40:43]
    v_mfma_f32_16x16x32_bf16 v[40:43], v[204:207], v[236:239], v[40:43]
    v_mfma_f32_16x16x32_bf16 v[72:75], v[208:211], v[232:235], v[72:75]
    v_mfma_f32_16x16x32_bf16 v[72:75], v[212:215], v[236:239], v[72:75]
    v_mfma_f32_16x16x32_bf16 v[104:107], v[216:219], v[232:235], v[104:107]
    v_mfma_f32_16x16x32_bf16 v[104:107], v[220:223], v[236:239], v[104:107]
    s_waitcnt lgkmcnt(2)
    v_mfma_f32_16x16x32_bf16 v[108:111], v[216:219], v[240:243], v[108:111]
    ds_read_b128 v[232:235], v248 offset:59392
    v_mfma_f32_16x16x32_bf16 v[108:111], v[220:223], v[244:247], v[108:111]
    ds_read_b128 v[236:239], v249 offset:59392
    v_mfma_f32_16x16x32_bf16 v[76:79], v[208:211], v[240:243], v[76:79]
    v_mfma_f32_16x16x32_bf16 v[76:79], v[212:215], v[244:247], v[76:79]
    v_mfma_f32_16x16x32_bf16 v[44:47], v[200:203], v[240:243], v[44:47]
    v_mfma_f32_16x16x32_bf16 v[44:47], v[204:207], v[244:247], v[44:47]
    v_mfma_f32_16x16x32_bf16 v[12:15], v[192:195], v[240:243], v[12:15]
    v_mfma_f32_16x16x32_bf16 v[12:15], v[196:199], v[244:247], v[12:15]
    s_waitcnt lgkmcnt(2)
    v_mfma_f32_16x16x32_bf16 v[16:19], v[192:195], v[224:227], v[16:19]
    ds_read_b128 v[240:243], v248 offset:61440
    v_mfma_f32_16x16x32_bf16 v[16:19], v[196:199], v[228:231], v[16:19]
    ds_read_b128 v[244:247], v249 offset:61440
    v_mfma_f32_16x16x32_bf16 v[48:51], v[200:203], v[224:227], v[48:51]
    v_mfma_f32_16x16x32_bf16 v[48:51], v[204:207], v[228:231], v[48:51]
    v_mfma_f32_16x16x32_bf16 v[80:83], v[208:211], v[224:227], v[80:83]
    v_mfma_f32_16x16x32_bf16 v[80:83], v[212:215], v[228:231], v[80:83]
    v_mfma_f32_16x16x32_bf16 v[112:115], v[216:219], v[224:227], v[112:115]
    v_mfma_f32_16x16x32_bf16 v[112:115], v[220:223], v[228:231], v[112:115]
    s_waitcnt lgkmcnt(2)
    v_mfma_f32_16x16x32_bf16 v[116:119], v[216:219], v[232:235], v[116:119]
    ds_read_b128 v[224:227], v248 offset:63488
    v_mfma_f32_16x16x32_bf16 v[116:119], v[220:223], v[236:239], v[116:119]
    ds_read_b128 v[228:231], v249 offset:63488
    v_mfma_f32_16x16x32_bf16 v[84:87], v[208:211], v[232:235], v[84:87]
    v_mfma_f32_16x16x32_bf16 v[84:87], v[212:215], v[236:239], v[84:87]
    v_mfma_f32_16x16x32_bf16 v[52:55], v[200:203], v[232:235], v[52:55]
    v_mfma_f32_16x16x32_bf16 v[52:55], v[204:207], v[236:239], v[52:55]
    v_mfma_f32_16x16x32_bf16 v[20:23], v[192:195], v[232:235], v[20:23]
    v_mfma_f32_16x16x32_bf16 v[20:23], v[196:199], v[236:239], v[20:23]
    s_waitcnt lgkmcnt(2)
    v_mfma_f32_16x16x32_bf16 v[24:27], v[192:195], v[240:243], v[24:27]
    v_mfma_f32_16x16x32_bf16 v[24:27], v[196:199], v[244:247], v[24:27]
    v_mfma_f32_16x16x32_bf16 v[56:59], v[200:203], v[240:243], v[56:59]
    v_mfma_f32_16x16x32_bf16 v[56:59], v[204:207], v[244:247], v[56:59]
    v_mfma_f32_16x16x32_bf16 v[88:91], v[208:211], v[240:243], v[88:91]
    v_mfma_f32_16x16x32_bf16 v[88:91], v[212:215], v[244:247], v[88:91]
    v_mfma_f32_16x16x32_bf16 v[120:123], v[216:219], v[240:243], v[120:123]
    v_mfma_f32_16x16x32_bf16 v[120:123], v[220:223], v[244:247], v[120:123]
    s_waitcnt lgkmcnt(0)
    v_mfma_f32_16x16x32_bf16 v[124:127], v[216:219], v[224:227], v[124:127]
    v_mfma_f32_16x16x32_bf16 v[124:127], v[220:223], v[228:231], v[124:127]
    v_mfma_f32_16x16x32_bf16 v[92:95], v[208:211], v[224:227], v[92:95]
    v_mfma_f32_16x16x32_bf16 v[92:95], v[212:215], v[228:231], v[92:95]
    v_mfma_f32_16x16x32_bf16 v[60:63], v[200:203], v[224:227], v[60:63]
    v_mfma_f32_16x16x32_bf16 v[60:63], v[204:207], v[228:231], v[60:63]
    v_mfma_f32_16x16x32_bf16 v[28:31], v[192:195], v[224:227], v[28:31]
    v_mfma_f32_16x16x32_bf16 v[28:31], v[196:199], v[228:231], v[28:31]
    s_setprio 0
    s_movk_i32 s49, 16384
    s_nop 5
    v_mul_f32 v72, s50, v72
    v_mul_f32 v73, s50, v73
    v_mul_f32 v74, s50, v74
    v_mul_f32 v75, s50, v75
    s_lshl_b32 s48, s96, 11
    s_add_u32 s48, s48, 1048576
    s_add_u32 s0, s58, s48
    s_addc_u32 s1, s59, 0
    v_mul_f32 v104, s50, v104
    v_mul_f32 v105, s50, v105
    v_mul_f32 v106, s50, v106
    v_mul_f32 v107, s50, v107
    v_exp_f32 v72, v72
    v_exp_f32 v73, v73
    v_exp_f32 v74, v74
    v_exp_f32 v75, v75
    v_exp_f32 v104, v104
    v_exp_f32 v105, v105
    v_exp_f32 v106, v106
    v_exp_f32 v107, v107
    s_load_dword s3, s[0:1], 0
    v_fma_f32 v72, v72, s51, s51
    v_fma_f32 v73, v73, s51, s51
    v_fma_f32 v74, v74, s51, s51
    v_fma_f32 v75, v75, s51, s51
    v_fma_f32 v104, v104, s51, s51
    v_fma_f32 v105, v105, s51, s51
    v_fma_f32 v106, v106, s51, s51
    v_fma_f32 v107, v107, s51, s51
    buffer_load_dwordx4 v[192:195], v252, s[20:23], s49 offen offset:0 sc1
    v_rcp_f32 v72, v72
    v_rcp_f32 v73, v73
    v_rcp_f32 v74, v74
    v_rcp_f32 v75, v75
    s_load_dword s3, s[0:1], 64
    v_rcp_f32 v104, v104
    v_rcp_f32 v105, v105
    v_rcp_f32 v106, v106
    v_rcp_f32 v107, v107
    buffer_load_dwordx4 v[196:199], v252, s[20:23], s49 offen offset:64 sc1
    v_mul_f32 v8, v8, v72
    v_mul_f32 v9, v9, v73
    v_mul_f32 v10, v10, v74
    v_mul_f32 v11, v11, v75
    v_mul_f32 v40, v40, v104
    v_mul_f32 v41, v41, v105
    v_mul_f32 v42, v42, v106
    v_mul_f32 v43, v43, v107
    s_load_dword s3, s[0:1], 128
    buffer_load_dwordx4 v[200:203], v252, s[20:23], s49 offen offset:128 sc1
    v_mul_f32 v76, s50, v76
    v_mul_f32 v77, s50, v77
    v_mul_f32 v78, s50, v78
    v_mul_f32 v79, s50, v79
    v_mul_f32 v108, s50, v108
    v_mul_f32 v109, s50, v109
    v_mul_f32 v110, s50, v110
    v_mul_f32 v111, s50, v111
    buffer_load_dwordx4 v[204:207], v252, s[20:23], s49 offen offset:192 sc1
    v_exp_f32 v76, v76
    v_exp_f32 v77, v77
    v_exp_f32 v78, v78
    v_exp_f32 v79, v79
    s_load_dword s3, s[0:1], 192
    v_exp_f32 v108, v108
    v_exp_f32 v109, v109
    v_exp_f32 v110, v110
    v_exp_f32 v111, v111
    buffer_load_dwordx4 v[208:211], v252, s[20:23], s49 offen offset:1024 sc1
    v_fma_f32 v76, v76, s51, s51
    v_fma_f32 v77, v77, s51, s51
    v_fma_f32 v78, v78, s51, s51
    v_fma_f32 v79, v79, s51, s51
    v_fma_f32 v108, v108, s51, s51
    v_fma_f32 v109, v109, s51, s51
    v_fma_f32 v110, v110, s51, s51
    v_fma_f32 v111, v111, s51, s51
    s_load_dword s3, s[0:1], 256
    buffer_load_dwordx4 v[212:215], v252, s[20:23], s49 offen offset:1088 sc1
    v_rcp_f32 v76, v76
    v_rcp_f32 v77, v77
    v_rcp_f32 v78, v78
    v_rcp_f32 v79, v79
    v_rcp_f32 v108, v108
    v_rcp_f32 v109, v109
    v_rcp_f32 v110, v110
    v_rcp_f32 v111, v111
    buffer_load_dwordx4 v[216:219], v252, s[20:23], s49 offen offset:1152 sc1
    v_mul_f32 v12, v12, v76
    v_mul_f32 v13, v13, v77
    v_mul_f32 v14, v14, v78
    v_mul_f32 v15, v15, v79
    s_load_dword s3, s[0:1], 320
    v_mul_f32 v44, v44, v108
    v_mul_f32 v45, v45, v109
    v_mul_f32 v46, v46, v110
    v_mul_f32 v47, v47, v111
    buffer_load_dwordx4 v[220:223], v252, s[20:23], s49 offen offset:1216 sc1
    v_mul_f32 v64, s50, v64
    v_mul_f32 v65, s50, v65
    v_mul_f32 v66, s50, v66
    v_mul_f32 v67, s50, v67
    v_mul_f32 v96, s50, v96
    v_mul_f32 v97, s50, v97
    v_mul_f32 v98, s50, v98
    v_mul_f32 v99, s50, v99
    s_load_dword s3, s[0:1], 384
    v_exp_f32 v64, v64
    v_exp_f32 v65, v65
    v_exp_f32 v66, v66
    v_exp_f32 v67, v67
    v_exp_f32 v96, v96
    v_exp_f32 v97, v97
    v_exp_f32 v98, v98
    v_exp_f32 v99, v99
    v_fma_f32 v64, v64, s51, s51
    v_fma_f32 v65, v65, s51, s51
    v_fma_f32 v66, v66, s51, s51
    v_fma_f32 v67, v67, s51, s51
    s_load_dword s3, s[0:1], 448
    v_fma_f32 v96, v96, s51, s51
    v_fma_f32 v97, v97, s51, s51
    v_fma_f32 v98, v98, s51, s51
    v_fma_f32 v99, v99, s51, s51
    v_rcp_f32 v64, v64
    v_rcp_f32 v65, v65
    v_rcp_f32 v66, v66
    v_rcp_f32 v67, v67
    v_rcp_f32 v96, v96
    v_rcp_f32 v97, v97
    v_rcp_f32 v98, v98
    v_rcp_f32 v99, v99
    s_load_dword s3, s[0:1], 512
    v_mul_f32 v0, v0, v64
    v_mul_f32 v1, v1, v65
    v_mul_f32 v2, v2, v66
    v_mul_f32 v3, v3, v67
    v_mul_f32 v32, v32, v96
    v_mul_f32 v33, v33, v97
    v_mul_f32 v34, v34, v98
    v_mul_f32 v35, v35, v99
    v_mul_f32 v68, s50, v68
    v_mul_f32 v69, s50, v69
    v_mul_f32 v70, s50, v70
    v_mul_f32 v71, s50, v71
    s_load_dword s3, s[0:1], 576
    v_mul_f32 v100, s50, v100
    v_mul_f32 v101, s50, v101
    v_mul_f32 v102, s50, v102
    v_mul_f32 v103, s50, v103
    v_exp_f32 v68, v68
    v_exp_f32 v69, v69
    v_exp_f32 v70, v70
    v_exp_f32 v71, v71
    v_exp_f32 v100, v100
    v_exp_f32 v101, v101
    v_exp_f32 v102, v102
    v_exp_f32 v103, v103
    s_load_dword s3, s[0:1], 640
    v_fma_f32 v68, v68, s51, s51
    v_fma_f32 v69, v69, s51, s51
    v_fma_f32 v70, v70, s51, s51
    v_fma_f32 v71, v71, s51, s51
    v_fma_f32 v100, v100, s51, s51
    v_fma_f32 v101, v101, s51, s51
    v_fma_f32 v102, v102, s51, s51
    v_fma_f32 v103, v103, s51, s51
    v_rcp_f32 v68, v68
    v_rcp_f32 v69, v69
    v_rcp_f32 v70, v70
    v_rcp_f32 v71, v71
    s_load_dword s3, s[0:1], 704
    v_rcp_f32 v100, v100
    v_rcp_f32 v101, v101
    v_rcp_f32 v102, v102
    v_rcp_f32 v103, v103
    v_mul_f32 v4, v4, v68
    v_mul_f32 v5, v5, v69
    v_mul_f32 v6, v6, v70
    v_mul_f32 v7, v7, v71
    v_mul_f32 v36, v36, v100
    v_mul_f32 v37, v37, v101
    v_mul_f32 v38, v38, v102
    v_mul_f32 v39, v39, v103
    s_load_dword s3, s[0:1], 768
    v_cvt_pk_bf16_f32 v161, v8, v12
    v_cvt_pk_bf16_f32 v167, v9, v13
    v_cvt_pk_bf16_f32 v173, v10, v14
    v_cvt_pk_bf16_f32 v179, v11, v15
    v_cvt_pk_bf16_f32 v185, v40, v44
    v_cvt_pk_bf16_f32 v225, v41, v45
    v_cvt_pk_bf16_f32 v231, v42, v46
    v_cvt_pk_bf16_f32 v237, v43, v47
    v_cvt_pk_bf16_f32 v160, v0, v4
    v_cvt_pk_bf16_f32 v166, v1, v5
    v_cvt_pk_bf16_f32 v172, v2, v6
    v_cvt_pk_bf16_f32 v178, v3, v7
    s_load_dword s3, s[0:1], 832
    v_cvt_pk_bf16_f32 v184, v32, v36
    v_cvt_pk_bf16_f32 v224, v33, v37
    v_cvt_pk_bf16_f32 v230, v34, v38
    v_cvt_pk_bf16_f32 v236, v35, v39
    v_min_u32 v72, -2, v161
    v_min_u32 v73, -2, v167
    v_min_u32 v74, -2, v173
    v_min_u32 v75, -2, v179
    v_min_u32 v104, -2, v185
    v_min_u32 v105, -2, v225
    v_min_u32 v106, -2, v231
    v_min_u32 v107, -2, v237
    s_waitcnt lgkmcnt(13)
    s_load_dword s3, s[0:1], 896
    s_cmp_lg_u32 s34, 4096
    s_cbranch_scc1 L_exp22
    v_min_u32_dpp v72, v160, v253 row_shr:1 row_mask:0xf bank_mask:0xf
    v_min_u32_dpp v73, v166, v253 row_shr:1 row_mask:0xf bank_mask:0xf
    v_min_u32_dpp v74, v172, v253 row_shr:1 row_mask:0xf bank_mask:0xf
    v_min_u32_dpp v75, v178, v253 row_shr:1 row_mask:0xf bank_mask:0xf
    v_min_u32_dpp v104, v184, v253 row_shr:1 row_mask:0xf bank_mask:0xf
    v_min_u32_dpp v105, v224, v253 row_shr:1 row_mask:0xf bank_mask:0xf
    v_min_u32_dpp v106, v230, v253 row_shr:1 row_mask:0xf bank_mask:0xf
    v_min_u32_dpp v107, v236, v253 row_shr:1 row_mask:0xf bank_mask:0xf
L_exp22:
    v_mul_f32 v80, s50, v80
    v_mul_f32 v81, s50, v81
    v_mul_f32 v82, s50, v82
    v_mul_f32 v83, s50, v83
    v_mul_f32 v112, s50, v112
    v_mul_f32 v113, s50, v113
    v_mul_f32 v114, s50, v114
    v_mul_f32 v115, s50, v115
    v_exp_f32 v80, v80
    v_exp_f32 v81, v81
    v_exp_f32 v82, v82
    v_exp_f32 v83, v83
    s_waitcnt lgkmcnt(13)
    s_load_dword s3, s[0:1], 960
    v_exp_f32 v112, v112
    v_exp_f32 v113, v113
    v_exp_f32 v114, v114
    v_exp_f32 v115, v115
    v_fma_f32 v80, v80, s51, s51
    v_fma_f32 v81, v81, s51, s51
    v_fma_f32 v82, v82, s51, s51
    v_fma_f32 v83, v83, s51, s51
    v_fma_f32 v112, v112, s51, s51
    v_fma_f32 v113, v113, s51, s51
    v_fma_f32 v114, v114, s51, s51
    v_fma_f32 v115, v115, s51, s51
    s_waitcnt lgkmcnt(13)
    s_load_dword s3, s[0:1], 1024
    v_rcp_f32 v80, v80
    v_rcp_f32 v81, v81
    v_rcp_f32 v82, v82
    v_rcp_f32 v83, v83
    v_rcp_f32 v112, v112
    v_rcp_f32 v113, v113
    v_rcp_f32 v114, v114
    v_rcp_f32 v115, v115
    v_mul_f32 v16, v16, v80
    v_mul_f32 v17, v17, v81
    v_mul_f32 v18, v18, v82
    v_mul_f32 v19, v19, v83
    s_waitcnt lgkmcnt(13)
    s_load_dword s3, s[0:1], 1088
    v_mul_f32 v48, v48, v112
    v_mul_f32 v49, v49, v113
    v_mul_f32 v50, v50, v114
    v_mul_f32 v51, v51, v115
    buffer_store_dwordx4 v[72:75], v254, s[32:35], s38 offen offset:1024 sc0 sc1
    buffer_store_dwordx4 v[104:107], v254, s[32:35], s38 offen offset:1088 sc0 sc1
    v_mul_f32 v84, s50, v84
    v_mul_f32 v85, s50, v85
    v_mul_f32 v86, s50, v86
    v_mul_f32 v87, s50, v87
    v_mul_f32 v116, s50, v116
    v_mul_f32 v117, s50, v117
    v_mul_f32 v118, s50, v118
    v_mul_f32 v119, s50, v119
    s_waitcnt lgkmcnt(13)
    s_load_dword s3, s[0:1], 1152
    v_exp_f32 v84, v84
    v_exp_f32 v85, v85
    v_exp_f32 v86, v86
    v_exp_f32 v87, v87
    v_exp_f32 v116, v116
    v_exp_f32 v117, v117
    v_exp_f32 v118, v118
    v_exp_f32 v119, v119
    v_fma_f32 v84, v84, s51, s51
    v_fma_f32 v85, v85, s51, s51
    v_fma_f32 v86, v86, s51, s51
    v_fma_f32 v87, v87, s51, s51
    s_waitcnt lgkmcnt(13)
    s_load_dword s3, s[0:1], 1216
    v_fma_f32 v116, v116, s51, s51
    v_fma_f32 v117, v117, s51, s51
    v_fma_f32 v118, v118, s51, s51
    v_fma_f32 v119, v119, s51, s51
    v_rcp_f32 v84, v84
    v_rcp_f32 v85, v85
    v_rcp_f32 v86, v86
    v_rcp_f32 v87, v87
    v_rcp_f32 v116, v116
    v_rcp_f32 v117, v117
    v_rcp_f32 v118, v118
    v_rcp_f32 v119, v119
    s_waitcnt lgkmcnt(13)
    s_load_dword s3, s[0:1], 1280
    v_mul_f32 v20, v20, v84
    v_mul_f32 v21, v21, v85
    v_mul_f32 v22, v22, v86
    v_mul_f32 v23, v23, v87
    v_mul_f32 v52, v52, v116
    v_mul_f32 v53, v53, v117
    v_mul_f32 v54, v54, v118
    v_mul_f32 v55, v55, v119
    v_mul_f32 v88, s50, v88
    v_mul_f32 v89, s50, v89
    v_mul_f32 v90, s50, v90
    v_mul_f32 v91, s50, v91
    s_waitcnt lgkmcnt(13)
    s_load_dword s3, s[0:1], 1344
    v_mul_f32 v120, s50, v120
    v_mul_f32 v121, s50, v121
    v_mul_f32 v122, s50, v122
    v_mul_f32 v123, s50, v123
    v_exp_f32 v88, v88
    v_exp_f32 v89, v89
    v_exp_f32 v90, v90
    v_exp_f32 v91, v91
    v_exp_f32 v120, v120
    v_exp_f32 v121, v121
    v_exp_f32 v122, v122
    v_exp_f32 v123, v123
    s_waitcnt lgkmcnt(13)
    s_load_dword s3, s[0:1], 1408
    v_fma_f32 v88, v88, s51, s51
    v_fma_f32 v89, v89, s51, s51
    v_fma_f32 v90, v90, s51, s51
    v_fma_f32 v91, v91, s51, s51
    v_fma_f32 v120, v120, s51, s51
    v_fma_f32 v121, v121, s51, s51
    v_fma_f32 v122, v122, s51, s51
    v_fma_f32 v123, v123, s51, s51
    v_rcp_f32 v88, v88
    v_rcp_f32 v89, v89
    v_rcp_f32 v90, v90
    v_rcp_f32 v91, v91
    s_waitcnt lgkmcnt(13)
    s_load_dword s3, s[0:1], 1472
    v_rcp_f32 v120, v120
    v_rcp_f32 v121, v121
    v_rcp_f32 v122, v122
    v_rcp_f32 v123, v123
    v_mul_f32 v24, v24, v88
    v_mul_f32 v25, v25, v89
    v_mul_f32 v26, v26, v90
    v_mul_f32 v27, v27, v91
    v_mul_f32 v56, v56, v120
    v_mul_f32 v57, v57, v121
    v_mul_f32 v58, v58, v122
    v_mul_f32 v59, v59, v123
    s_waitcnt lgkmcnt(13)
    s_load_dword s3, s[0:1], 1536
    v_mul_f32 v92, s50, v92
    v_mul_f32 v93, s50, v93
    v_mul_f32 v94, s50, v94
    v_mul_f32 v95, s50, v95
    v_mul_f32 v124, s50, v124
    v_mul_f32 v125, s50, v125
    v_mul_f32 v126, s50, v126
    v_mul_f32 v127, s50, v127
    v_exp_f32 v92, v92
    v_exp_f32 v93, v93
    v_exp_f32 v94, v94
    v_exp_f32 v95, v95
    s_waitcnt lgkmcnt(13)
    s_load_dword s3, s[0:1], 1600
    v_exp_f32 v124, v124
    v_exp_f32 v125, v125
    v_exp_f32 v126, v126
    v_exp_f32 v127, v127
    v_fma_f32 v92, v92, s51, s51
    v_fma_f32 v93, v93, s51, s51
    v_fma_f32 v94, v94, s51, s51
    v_fma_f32 v95, v95, s51, s51
    v_fma_f32 v124, v124, s51, s51
    v_fma_f32 v125, v125, s51, s51
    v_fma_f32 v126, v126, s51, s51
    v_fma_f32 v127, v127, s51, s51
    s_waitcnt lgkmcnt(13)
    s_load_dword s3, s[0:1], 1664
    v_rcp_f32 v92, v92
    v_rcp_f32 v93, v93
    v_rcp_f32 v94, v94
    v_rcp_f32 v95, v95
    v_rcp_f32 v124, v124
    v_rcp_f32 v125, v125
    v_rcp_f32 v126, v126
    v_rcp_f32 v127, v127
    v_mul_f32 v28, v28, v92
    v_mul_f32 v29, v29, v93
    v_mul_f32 v30, v30, v94
    v_mul_f32 v31, v31, v95
    s_waitcnt lgkmcnt(13)
    s_load_dword s3, s[0:1], 1728
    v_mul_f32 v60, v60, v124
    v_mul_f32 v61, v61, v125
    v_mul_f32 v62, v62, v126
    v_mul_f32 v63, v63, v127
    v_cvt_pk_bf16_f32 v162, v16, v20
    v_cvt_pk_bf16_f32 v163, v24, v28
    v_cvt_pk_bf16_f32 v168, v17, v21
    v_cvt_pk_bf16_f32 v169, v25, v29
    s_waitcnt vmcnt(2)
    s_setprio 3
    v_mfma_f32_16x16x32_bf16 v[64:67], v[192:195], v[160:163], 0
    v_cvt_pk_bf16_f32 v174, v18, v22
    v_cvt_pk_bf16_f32 v175, v26, v30
    v_mfma_f32_16x16x32_bf16 v[72:75], v[196:199], v[166:169], 0
    v_cvt_pk_bf16_f32 v180, v19, v23
    v_cvt_pk_bf16_f32 v181, v27, v31
    s_waitcnt lgkmcnt(13)
    s_load_dword s3, s[0:1], 1792
    v_mfma_f32_16x16x32_bf16 v[80:83], v[200:203], v[172:175], 0
    v_cvt_pk_bf16_f32 v186, v48, v52
    v_cvt_pk_bf16_f32 v187, v56, v60
    v_mfma_f32_16x16x32_bf16 v[88:91], v[204:207], v[178:181], 0
    v_cvt_pk_bf16_f32 v226, v49, v53
    v_cvt_pk_bf16_f32 v227, v57, v61
    v_mfma_f32_16x16x32_bf16 v[96:99], v[208:211], v[184:187], 0
    v_cvt_pk_bf16_f32 v232, v50, v54
    v_cvt_pk_bf16_f32 v233, v58, v62
    v_mfma_f32_16x16x32_bf16 v[104:107], v[212:215], v[224:227], 0
    v_cvt_pk_bf16_f32 v238, v51, v55
    v_cvt_pk_bf16_f32 v239, v59, v63
    s_nop 0
    v_mfma_f32_16x16x32_bf16 v[112:115], v[216:219], v[230:233], 0
    v_mfma_f32_16x16x32_bf16 v[120:123], v[220:223], v[236:239], 0
    s_setprio 0
    s_waitcnt lgkmcnt(13)
    s_load_dword s3, s[0:1], 1856
    s_waitcnt lgkmcnt(13)
    s_load_dword s3, s[0:1], 1920
    s_waitcnt lgkmcnt(13)
    s_load_dword s3, s[0:1], 1984
    v_exp_f32 v32, v64
    v_exp_f32 v33, v72
    v_exp_f32 v34, v80
    v_exp_f32 v35, v88
    v_exp_f32 v36, v96
    v_exp_f32 v37, v104
    v_exp_f32 v38, v112
    v_exp_f32 v39, v120
    v_fma_f32 v32, v32, s50, s50
    v_fma_f32 v33, v33, s50, s50
    v_fma_f32 v34, v34, s50, s50
    v_fma_f32 v35, v35, s50, s50
    v_fma_f32 v36, v36, s50, s50
    v_fma_f32 v37, v37, s50, s50
    v_fma_f32 v38, v38, s50, s50
    v_fma_f32 v39, v39, s50, s50
    v_rcp_f32 v32, v32
    v_rcp_f32 v33, v33
    v_rcp_f32 v34, v34
    v_rcp_f32 v35, v35
    v_rcp_f32 v36, v36
    v_rcp_f32 v37, v37
    v_rcp_f32 v38, v38
    v_rcp_f32 v39, v39
    v_mul_f32 v64, v64, v32
    v_mul_f32 v72, v72, v33
    v_mul_f32 v80, v80, v34
    v_mul_f32 v88, v88, v35
    v_mul_f32 v96, v96, v36
    v_mul_f32 v104, v104, v37
    v_mul_f32 v112, v112, v38
    v_mul_f32 v120, v120, v39
    v_cvt_pk_bf16_f32 v0, v64, v72
    v_cvt_pk_bf16_f32 v1, v80, v88
    v_cvt_pk_bf16_f32 v2, v96, v104
    v_cvt_pk_bf16_f32 v3, v112, v120
    buffer_load_dwordx4 v[40:43], v251, s[24:27], s38 offen offset:1024 sc0 sc1
    buffer_load_dwordx4 v[44:47], v251, s[24:27], s38 offen offset:1088 sc0 sc1
    v_exp_f32 v32, v65
    v_exp_f32 v33, v73
    v_exp_f32 v34, v81
    v_exp_f32 v35, v89
    v_exp_f32 v36, v97
    v_exp_f32 v37, v105
    v_exp_f32 v38, v113
    v_exp_f32 v39, v121
    v_fma_f32 v32, v32, s50, s50
    v_fma_f32 v33, v33, s50, s50
    v_fma_f32 v34, v34, s50, s50
    v_fma_f32 v35, v35, s50, s50
    v_fma_f32 v36, v36, s50, s50
    v_fma_f32 v37, v37, s50, s50
    v_fma_f32 v38, v38, s50, s50
    v_fma_f32 v39, v39, s50, s50
    v_rcp_f32 v32, v32
    v_rcp_f32 v33, v33
    v_rcp_f32 v34, v34
    v_rcp_f32 v35, v35
    v_rcp_f32 v36, v36
    v_rcp_f32 v37, v37
    v_rcp_f32 v38, v38
    v_rcp_f32 v39, v39
    v_mul_f32 v65, v65, v32
    v_mul_f32 v73, v73, v33
    v_mul_f32 v81, v81, v34
    v_mul_f32 v89, v89, v35
    v_mul_f32 v97, v97, v36
    v_mul_f32 v105, v105, v37
    v_mul_f32 v113, v113, v38
    v_mul_f32 v121, v121, v39
    v_cvt_pk_bf16_f32 v4, v65, v73
    v_cvt_pk_bf16_f32 v5, v81, v89
    v_cvt_pk_bf16_f32 v6, v97, v105
    v_cvt_pk_bf16_f32 v7, v113, v121
    v_exp_f32 v32, v66
    v_exp_f32 v33, v74
    v_exp_f32 v34, v82
    v_exp_f32 v35, v90
    v_exp_f32 v36, v98
    v_exp_f32 v37, v106
    v_exp_f32 v38, v114
    v_exp_f32 v39, v122
    v_fma_f32 v32, v32, s50, s50
    v_fma_f32 v33, v33, s50, s50
    v_fma_f32 v34, v34, s50, s50
    v_fma_f32 v35, v35, s50, s50
    v_fma_f32 v36, v36, s50, s50
    v_fma_f32 v37, v37, s50, s50
    v_fma_f32 v38, v38, s50, s50
    v_fma_f32 v39, v39, s50, s50
    v_rcp_f32 v32, v32
    v_rcp_f32 v33, v33
    v_rcp_f32 v34, v34
    v_rcp_f32 v35, v35
    v_rcp_f32 v36, v36
    v_rcp_f32 v37, v37
    v_rcp_f32 v38, v38
    v_rcp_f32 v39, v39
    v_mul_f32 v66, v66, v32
    v_mul_f32 v74, v74, v33
    v_mul_f32 v82, v82, v34
    v_mul_f32 v90, v90, v35
    v_mul_f32 v98, v98, v36
    v_mul_f32 v106, v106, v37
    v_mul_f32 v114, v114, v38
    v_mul_f32 v122, v122, v39
    v_cvt_pk_bf16_f32 v8, v66, v74
    v_cvt_pk_bf16_f32 v9, v82, v90
    v_cvt_pk_bf16_f32 v10, v98, v106
    v_cvt_pk_bf16_f32 v11, v114, v122
    s_waitcnt lgkmcnt(0)
    v_mov_b32_dpp v165, v161 row_shl:1 row_mask:0xf bank_mask:0xf bound_ctrl:1
    v_mov_b32_dpp v171, v167 row_shl:1 row_mask:0xf bank_mask:0xf bound_ctrl:1
    v_mov_b32_dpp v177, v173 row_shl:1 row_mask:0xf bank_mask:0xf bound_ctrl:1
    v_mov_b32_dpp v183, v179 row_shl:1 row_mask:0xf bank_mask:0xf bound_ctrl:1
    v_mov_b32_dpp v189, v185 row_shl:1 row_mask:0xf bank_mask:0xf bound_ctrl:1
    v_mov_b32_dpp v229, v225 row_shl:1 row_mask:0xf bank_mask:0xf bound_ctrl:1
    v_mov_b32_dpp v235, v231 row_shl:1 row_mask:0xf bank_mask:0xf bound_ctrl:1
    v_mov_b32_dpp v241, v237 row_shl:1 row_mask:0xf bank_mask:0xf bound_ctrl:1
    s_mov_b32 s48, 4000000
    s_waitcnt vmcnt(0)
L_poll2:
    v_max3_u32 v32, v40, v41, v42
    v_max3_u32 v33, v43, v44, v45
    v_max3_u32 v32, v32, v46, v47
    v_max_u32 v32, v32, v33
    v_cmp_eq_u32 vcc, -1, v32
    s_sub_u32 s48, s48, 1
    s_cbranch_scc1 L_poll2_ok
    s_cbranch_vccz L_poll2_ok
    buffer_load_dwordx4 v[40:43], v251, s[24:27], s38 offen offset:1024 sc0 sc1
    buffer_load_dwordx4 v[44:47], v251, s[24:27], s38 offen offset:1088 sc0 sc1
    s_waitcnt vmcnt(0)
    s_branch L_poll2
L_poll2_ok:
    s_mov_b32 vcc_lo, 2147516416
    s_mov_b32 vcc_hi, 2147516416
    s_cmp_lg_u32 s26, 4096
    s_cbranch_scc1 L_imp22
    v_mov_b32_dpp v165, v40 row_shr:15 row_mask:0xf bank_mask:0xf
    v_mov_b32_dpp v171, v41 row_shr:15 row_mask:0xf bank_mask:0xf
    v_mov_b32_dpp v177, v42 row_shr:15 row_mask:0xf bank_mask:0xf
    v_mov_b32_dpp v183, v43 row_shr:15 row_mask:0xf bank_mask:0xf
    v_mov_b32_dpp v189, v44 row_shr:15 row_mask:0xf bank_mask:0xf
    v_mov_b32_dpp v229, v45 row_shr:15 row_mask:0xf bank_mask:0xf
    v_mov_b32_dpp v235, v46 row_shr:15 row_mask:0xf bank_mask:0xf
    v_mov_b32_dpp v241, v47 row_shr:15 row_mask:0xf bank_mask:0xf
L_imp22:
    v_cndmask_b32_dpp v164, v160, v40, vcc row_shl:1 row_mask:0xf bank_mask:0xf bound_ctrl:1
    v_cndmask_b32_dpp v170, v166, v41, vcc row_shl:1 row_mask:0xf bank_mask:0xf bound_ctrl:1
    v_cndmask_b32_dpp v176, v172, v42, vcc row_shl:1 row_mask:0xf bank_mask:0xf bound_ctrl:1
    v_cndmask_b32_dpp v182, v178, v43, vcc row_shl:1 row_mask:0xf bank_mask:0xf bound_ctrl:1
    v_cndmask_b32_dpp v188, v184, v44, vcc row_shl:1 row_mask:0xf bank_mask:0xf bound_ctrl:1
    v_cndmask_b32_dpp v228, v224, v45, vcc row_shl:1 row_mask:0xf bank_mask:0xf bound_ctrl:1
    v_cndmask_b32_dpp v234, v230, v46, vcc row_shl:1 row_mask:0xf bank_mask:0xf bound_ctrl:1
    v_cndmask_b32_dpp v240, v236, v47, vcc row_shl:1 row_mask:0xf bank_mask:0xf bound_ctrl:1
    s_setprio 3
    v_mfma_f32_16x16x32_bf16 v[68:71], v[192:195], v[162:165], 0
    v_exp_f32 v32, v67
    v_mfma_f32_16x16x32_bf16 v[76:79], v[196:199], v[168:171], 0
    v_exp_f32 v33, v75
    v_mfma_f32_16x16x32_bf16 v[84:87], v[200:203], v[174:177], 0
    v_exp_f32 v34, v83
    v_mfma_f32_16x16x32_bf16 v[92:95], v[204:207], v[180:183], 0
    v_exp_f32 v35, v91
    v_mfma_f32_16x16x32_bf16 v[100:103], v[208:211], v[186:189], 0
    v_exp_f32 v36, v99
    v_mfma_f32_16x16x32_bf16 v[108:111], v[212:215], v[226:229], 0
    v_exp_f32 v37, v107
    v_mfma_f32_16x16x32_bf16 v[116:119], v[216:219], v[232:235], 0
    v_exp_f32 v38, v115
    v_mfma_f32_16x16x32_bf16 v[124:127], v[220:223], v[238:241], 0
    v_exp_f32 v39, v123
    s_setprio 0
    v_fma_f32 v32, v32, s50, s50
    v_fma_f32 v33, v33, s50, s50
    v_fma_f32 v34, v34, s50, s50
    v_fma_f32 v35, v35, s50, s50
    v_fma_f32 v36, v36, s50, s50
    v_fma_f32 v37, v37, s50, s50
    v_fma_f32 v38, v38, s50, s50
    v_fma_f32 v39, v39, s50, s50
    v_rcp_f32 v32, v32
    v_rcp_f32 v33, v33
    v_rcp_f32 v34, v34
    v_rcp_f32 v35, v35
    v_rcp_f32 v36, v36
    v_rcp_f32 v37, v37
    v_rcp_f32 v38, v38
    v_rcp_f32 v39, v39
    v_mul_f32 v67, v67, v32
    v_mul_f32 v75, v75, v33
    v_mul_f32 v83, v83, v34
    v_mul_f32 v91, v91, v35
    v_mul_f32 v99, v99, v36
    v_mul_f32 v107, v107, v37
    v_mul_f32 v115, v115, v38
    v_mul_f32 v123, v123, v39
    v_cvt_pk_bf16_f32 v12, v67, v75
    v_cvt_pk_bf16_f32 v13, v83, v91
    v_cvt_pk_bf16_f32 v14, v99, v107
    v_cvt_pk_bf16_f32 v15, v115, v123
    v_exp_f32 v32, v68
    v_exp_f32 v33, v76
    v_exp_f32 v34, v84
    v_exp_f32 v35, v92
    v_exp_f32 v36, v100
    v_exp_f32 v37, v108
    v_exp_f32 v38, v116
    v_exp_f32 v39, v124
    v_fma_f32 v32, v32, s50, s50
    v_fma_f32 v33, v33, s50, s50
    v_fma_f32 v34, v34, s50, s50
    v_fma_f32 v35, v35, s50, s50
    v_fma_f32 v36, v36, s50, s50
    v_fma_f32 v37, v37, s50, s50
    v_fma_f32 v38, v38, s50, s50
    v_fma_f32 v39, v39, s50, s50
    v_rcp_f32 v32, v32
    v_rcp_f32 v33, v33
    v_rcp_f32 v34, v34
    v_rcp_f32 v35, v35
    v_rcp_f32 v36, v36
    v_rcp_f32 v37, v37
    v_rcp_f32 v38, v38
    v_rcp_f32 v39, v39
    v_mul_f32 v68, v68, v32
    v_mul_f32 v76, v76, v33
    v_mul_f32 v84, v84, v34
    v_mul_f32 v92, v92, v35
    v_mul_f32 v100, v100, v36
    v_mul_f32 v108, v108, v37
    v_mul_f32 v116, v116, v38
    v_mul_f32 v124, v124, v39
    v_cvt_pk_bf16_f32 v16, v68, v76
    v_cvt_pk_bf16_f32 v17, v84, v92
    v_cvt_pk_bf16_f32 v18, v100, v108
    v_cvt_pk_bf16_f32 v19, v116, v124
    v_exp_f32 v32, v69
    v_exp_f32 v33, v77
    v_exp_f32 v34, v85
    v_exp_f32 v35, v93
    v_exp_f32 v36, v101
    v_exp_f32 v37, v109
    v_exp_f32 v38, v117
    v_exp_f32 v39, v125
    v_fma_f32 v32, v32, s50, s50
    v_fma_f32 v33, v33, s50, s50
    v_fma_f32 v34, v34, s50, s50
    v_fma_f32 v35, v35, s50, s50
    v_fma_f32 v36, v36, s50, s50
    v_fma_f32 v37, v37, s50, s50
    v_fma_f32 v38, v38, s50, s50
    v_fma_f32 v39, v39, s50, s50
    v_rcp_f32 v32, v32
    v_rcp_f32 v33, v33
    v_rcp_f32 v34, v34
    v_rcp_f32 v35, v35
    v_rcp_f32 v36, v36
    v_rcp_f32 v37, v37
    v_rcp_f32 v38, v38
    v_rcp_f32 v39, v39
    v_mul_f32 v69, v69, v32
    v_mul_f32 v77, v77, v33
    v_mul_f32 v85, v85, v34
    v_mul_f32 v93, v93, v35
    v_mul_f32 v101, v101, v36
    v_mul_f32 v109, v109, v37
    v_mul_f32 v117, v117, v38
    v_mul_f32 v125, v125, v39
    v_cvt_pk_bf16_f32 v20, v69, v77
    v_cvt_pk_bf16_f32 v21, v85, v93
    v_cvt_pk_bf16_f32 v22, v101, v109
    v_cvt_pk_bf16_f32 v23, v117, v125
    s_setprio 1
    v_exp_f32 v32, v70
    v_exp_f32 v33, v78
    s_mov_b32 s46, 802816
    v_exp_f32 v34, v86
    v_exp_f32 v35, v94
    s_mov_b32 s47, 806912
    v_exp_f32 v36, v102
    v_exp_f32 v37, v110
    buffer_load_dwordx4 v[160:163], v250, s[60:63], s46 offen offset:0 sc1
    v_exp_f32 v38, v118
    v_exp_f32 v39, v126
    v_fma_f32 v32, v32, s50, s50
    v_fma_f32 v33, v33, s50, s50
    v_fma_f32 v34, v34, s50, s50
    v_fma_f32 v35, v35, s50, s50
    buffer_load_dwordx4 v[164:167], v250, s[60:63], s46 offen offset:1024 sc1
    v_fma_f32 v36, v36, s50, s50
    v_fma_f32 v37, v37, s50, s50
    v_fma_f32 v38, v38, s50, s50
    v_fma_f32 v39, v39, s50, s50
    v_rcp_f32 v32, v32
    v_rcp_f32 v33, v33
    buffer_load_dwordx4 v[168:171], v250, s[60:63], s46 offen offset:2048 sc1
    v_rcp_f32 v34, v34
    v_rcp_f32 v35, v35
    v_rcp_f32 v36, v36
    v_rcp_f32 v37, v37
    v_rcp_f32 v38, v38
    v_rcp_f32 v39, v39
    buffer_load_dwordx4 v[172:175], v250, s[60:63], s46 offen offset:3072 sc1
    v_mul_f32 v70, v70, v32
    v_mul_f32 v78, v78, v33
    v_mul_f32 v86, v86, v34
    v_mul_f32 v94, v94, v35
    v_mul_f32 v102, v102, v36
    v_mul_f32 v110, v110, v37
    buffer_load_dwordx4 v[176:179], v250, s[60:63], s47 offen offset:0 sc1
    v_mul_f32 v118, v118, v38
    v_mul_f32 v126, v126, v39
    v_cvt_pk_bf16_f32 v24, v70, v78
    v_cvt_pk_bf16_f32 v25, v86, v94
    v_cvt_pk_bf16_f32 v26, v102, v110
    v_cvt_pk_bf16_f32 v27, v118, v126
    buffer_load_dwordx4 v[180:183], v250, s[60:63], s47 offen offset:1024 sc1
    v_exp_f32 v32, v71
    v_exp_f32 v33, v79
    v_exp_f32 v34, v87
    v_exp_f32 v35, v95
    v_exp_f32 v36, v103
    v_exp_f32 v37, v111
    buffer_load_dwordx4 v[184:187], v250, s[60:63], s47 offen offset:2048 sc1
    v_exp_f32 v38, v119
    v_exp_f32 v39, v127
    v_fma_f32 v32, v32, s50, s50
    v_fma_f32 v33, v33, s50, s50
    v_fma_f32 v34, v34, s50, s50
    v_fma_f32 v35, v35, s50, s50
    buffer_load_dwordx4 v[188:191], v250, s[60:63], s47 offen offset:3072 sc1
    v_fma_f32 v36, v36, s50, s50
    v_fma_f32 v37, v37, s50, s50
    v_fma_f32 v38, v38, s50, s50
    v_fma_f32 v39, v39, s50, s50
    v_rcp_f32 v32, v32
    v_rcp_f32 v33, v33
    s_mov_b32 s46, 811008
    v_rcp_f32 v34, v34
    v_rcp_f32 v35, v35
    s_mov_b32 s47, 815104
    v_rcp_f32 v36, v36
    v_rcp_f32 v37, v37
    v_rcp_f32 v38, v38
    v_rcp_f32 v39, v39
    v_mul_f32 v71, v71, v32
    v_mul_f32 v79, v79, v33
    v_mul_f32 v87, v87, v34
    v_mul_f32 v95, v95, v35
    v_mul_f32 v103, v103, v36
    v_mul_f32 v111, v111, v37
    v_mul_f32 v119, v119, v38
    v_mul_f32 v127, v127, v39
    v_cvt_pk_bf16_f32 v28, v71, v79
    v_cvt_pk_bf16_f32 v29, v87, v95
    v_cvt_pk_bf16_f32 v30, v103, v111
    v_cvt_pk_bf16_f32 v31, v119, v127
    v_subrev_u32 v249, s39, v250
    v_add_u32 v248, 98304, v249
    v_add_u32 v249, 32768, v249
    v_mbcnt_lo_u32_b32 v64, -1, 0
    v_mbcnt_hi_u32_b32 v64, -1, v64
    s_lshl_b32 s48, s52, 7
    v_bfe_u32 v65, v64, 1, 3
    v_lshl_add_u32 v252, v65, 14, s48
    v_bfe_u32 v66, v64, 4, 1
    v_lshl_add_u32 v252, v66, 5, v252
    v_lshrrev_b32 v66, 5, v64
    v_lshl_add_u32 v252, v66, 6, v252
    v_and_b32 v66, 1, v64
    v_lshl_add_u32 v252, v66, 4, v252
    v_add_u32 v253, 8192, v252
    s_movk_i32 s49, 4096
    s_mov_b32 vcc_lo, 0x55555555
    s_mov_b32 vcc_hi, 0x55555555
    s_barrier
    ds_write_b128 v250, v[0:3] offset:32768
    ds_write_b128 v250, v[4:7] offset:34816
    ds_read_b128 v[224:227], v248 offset:32768
    ds_read_b128 v[228:231], v248 offset:33792
    ds_read_b128 v[232:235], v248 offset:34816
    ds_read_b128 v[236:239], v248 offset:35840
    ds_write_b128 v250, v[8:11] offset:36864
    s_setprio 1
    s_waitcnt vmcnt(7) lgkmcnt(4)
    v_mfma_f32_16x16x32_bf16 v[0:3], v[160:163], v[224:227], 0
    ds_read_b128 v[240:243], v248 offset:36864
    s_waitcnt vmcnt(6) lgkmcnt(4)
    v_mfma_f32_16x16x32_bf16 v[0:3], v[164:167], v[228:231], v[0:3]
    ds_read_b128 v[244:247], v248 offset:37888
    s_waitcnt vmcnt(5)
    v_mfma_f32_16x16x32_bf16 v[32:35], v[168:171], v[224:227], 0
    buffer_load_dwordx4 v[192:195], v250, s[60:63], s46 offen offset:0 sc1
    s_waitcnt vmcnt(5)
    v_mfma_f32_16x16x32_bf16 v[32:35], v[172:175], v[228:231], v[32:35]
    s_waitcnt vmcnt(1)
    v_mfma_f32_16x16x32_bf16 v[64:67], v[176:179], v[224:227], 0
    ds_write_b128 v250, v[12:15] offset:38912
    v_mfma_f32_16x16x32_bf16 v[64:67], v[180:183], v[228:231], v[64:67]
    buffer_load_dwordx4 v[196:199], v250, s[60:63], s46 offen offset:1024 sc1
    v_mfma_f32_16x16x32_bf16 v[96:99], v[184:187], v[224:227], 0
    v_mfma_f32_16x16x32_bf16 v[96:99], v[188:191], v[228:231], v[96:99]
    s_waitcnt lgkmcnt(4)
    v_mfma_f32_16x16x32_bf16 v[100:103], v[184:187], v[232:235], 0
    ds_read_b128 v[224:227], v248 offset:38912
    v_mfma_f32_16x16x32_bf16 v[100:103], v[188:191], v[236:239], v[100:103]
    ds_read_b128 v[228:231], v248 offset:39936
    v_mfma_f32_16x16x32_bf16 v[68:71], v[176:179], v[232:235], 0
    buffer_load_dwordx4 v[200:203], v250, s[60:63], s46 offen offset:2048 sc1
    v_mfma_f32_16x16x32_bf16 v[68:71], v[180:183], v[236:239], v[68:71]
    v_mfma_f32_16x16x32_bf16 v[36:39], v[168:171], v[232:235], 0
    ds_write_b128 v250, v[16:19] offset:40960
    v_mfma_f32_16x16x32_bf16 v[36:39], v[172:175], v[236:239], v[36:39]
    buffer_load_dwordx4 v[204:207], v250, s[60:63], s46 offen offset:3072 sc1
    v_mfma_f32_16x16x32_bf16 v[4:7], v[160:163], v[232:235], 0
    v_mfma_f32_16x16x32_bf16 v[4:7], v[164:167], v[236:239], v[4:7]
    s_waitcnt lgkmcnt(4)
    v_mfma_f32_16x16x32_bf16 v[8:11], v[160:163], v[240:243], 0
    ds_read_b128 v[232:235], v248 offset:40960
    v_mfma_f32_16x16x32_bf16 v[8:11], v[164:167], v[244:247], v[8:11]
    ds_read_b128 v[236:239], v248 offset:41984
    v_mfma_f32_16x16x32_bf16 v[40:43], v[168:171], v[240:243], 0
    buffer_load_dwordx4 v[208:211], v250, s[60:63], s47 offen offset:0 sc1
    v_mfma_f32_16x16x32_bf16 v[40:43], v[172:175], v[244:247], v[40:43]
    v_mfma_f32_16x16x32_bf16 v[72:75], v[176:179], v[240:243], 0
    ds_write_b128 v250, v[20:23] offset:43008
    v_mfma_f32_16x16x32_bf16 v[72:75], v[180:183], v[244:247], v[72:75]
    buffer_load_dwordx4 v[212:215], v250, s[60:63], s47 offen offset:1024 sc1
    v_mfma_f32_16x16x32_bf16 v[104:107], v[184:187], v[240:243], 0
    v_mfma_f32_16x16x32_bf16 v[104:107], v[188:191], v[244:247], v[104:107]
    s_waitcnt lgkmcnt(4)
    v_mfma_f32_16x16x32_bf16 v[108:111], v[184:187], v[224:227], 0
    ds_read_b128 v[240:243], v248 offset:43008
    v_mfma_f32_16x16x32_bf16 v[108:111], v[188:191], v[228:231], v[108:111]
    ds_read_b128 v[244:247], v248 offset:44032
    v_mfma_f32_16x16x32_bf16 v[76:79], v[176:179], v[224:227], 0
    buffer_load_dwordx4 v[216:219], v250, s[60:63], s47 offen offset:2048 sc1
    v_mfma_f32_16x16x32_bf16 v[76:79], v[180:183], v[228:231], v[76:79]
    v_mfma_f32_16x16x32_bf16 v[44:47], v[168:171], v[224:227], 0
    ds_write_b128 v250, v[24:27] offset:45056
    v_mfma_f32_16x16x32_bf16 v[44:47], v[172:175], v[228:231], v[44:47]
    buffer_load_dwordx4 v[220:223], v250, s[60:63], s47 offen offset:3072 sc1
    v_mfma_f32_16x16x32_bf16 v[12:15], v[160:163], v[224:227], 0
    v_mfma_f32_16x16x32_bf16 v[12:15], v[164:167], v[228:231], v[12:15]
    s_waitcnt lgkmcnt(4)
    v_mfma_f32_16x16x32_bf16 v[16:19], v[160:163], v[232:235], 0
    ds_read_b128 v[224:227], v248 offset:45056
    v_mfma_f32_16x16x32_bf16 v[16:19], v[164:167], v[236:239], v[16:19]
    ds_read_b128 v[228:231], v248 offset:46080
    v_mfma_f32_16x16x32_bf16 v[48:51], v[168:171], v[232:235], 0
    v_mfma_f32_16x16x32_bf16 v[48:51], v[172:175], v[236:239], v[48:51]
    v_mfma_f32_16x16x32_bf16 v[80:83], v[176:179], v[232:235], 0
    ds_write_b128 v250, v[28:31] offset:47104
    v_mfma_f32_16x16x32_bf16 v[80:83], v[180:183], v[236:239], v[80:83]
    v_mfma_f32_16x16x32_bf16 v[112:115], v[184:187], v[232:235], 0
    v_mfma_f32_16x16x32_bf16 v[112:115], v[188:191], v[236:239], v[112:115]
    s_waitcnt lgkmcnt(4)
    v_mfma_f32_16x16x32_bf16 v[116:119], v[184:187], v[240:243], 0
    ds_read_b128 v[232:235], v248 offset:47104
    v_mfma_f32_16x16x32_bf16 v[116:119], v[188:191], v[244:247], v[116:119]
    ds_read_b128 v[236:239], v248 offset:48128
    v_mfma_f32_16x16x32_bf16 v[84:87], v[176:179], v[240:243], 0
    v_mfma_f32_16x16x32_bf16 v[84:87], v[180:183], v[244:247], v[84:87]
    v_mfma_f32_16x16x32_bf16 v[52:55], v[168:171], v[240:243], 0
    ds_write_b128 v250, v[128:131] offset:0
    v_mfma_f32_16x16x32_bf16 v[52:55], v[172:175], v[244:247], v[52:55]
    v_mfma_f32_16x16x32_bf16 v[20:23], v[160:163], v[240:243], 0
    v_mfma_f32_16x16x32_bf16 v[20:23], v[164:167], v[244:247], v[20:23]
    s_waitcnt lgkmcnt(4)
    v_mfma_f32_16x16x32_bf16 v[24:27], v[160:163], v[224:227], 0
    ds_read_b128 v[240:243], v248 offset:49152
    v_mfma_f32_16x16x32_bf16 v[24:27], v[164:167], v[228:231], v[24:27]
    ds_read_b128 v[244:247], v248 offset:50176
    v_mfma_f32_16x16x32_bf16 v[56:59], v[168:171], v[224:227], 0
    v_mfma_f32_16x16x32_bf16 v[56:59], v[172:175], v[228:231], v[56:59]
    v_mfma_f32_16x16x32_bf16 v[88:91], v[176:179], v[224:227], 0
    ds_write_b128 v250, v[132:135] offset:2048
    v_mfma_f32_16x16x32_bf16 v[88:91], v[180:183], v[228:231], v[88:91]
    v_mfma_f32_16x16x32_bf16 v[120:123], v[184:187], v[224:227], 0
    v_mfma_f32_16x16x32_bf16 v[120:123], v[188:191], v[228:231], v[120:123]
    s_waitcnt lgkmcnt(4)
    v_mfma_f32_16x16x32_bf16 v[124:127], v[184:187], v[232:235], 0
    ds_read_b128 v[224:227], v248 offset:51200
    v_mfma_f32_16x16x32_bf16 v[124:127], v[188:191], v[236:239], v[124:127]
    ds_read_b128 v[228:231], v248 offset:52224
    v_mfma_f32_16x16x32_bf16 v[92:95], v[176:179], v[232:235], 0
    v_mfma_f32_16x16x32_bf16 v[92:95], v[180:183], v[236:239], v[92:95]
    s_mov_b32 s46, 819200
    v_mfma_f32_16x16x32_bf16 v[60:63], v[168:171], v[232:235], 0
    s_mov_b32 s47, 823296
    v_mfma_f32_16x16x32_bf16 v[60:63], v[172:175], v[236:239], v[60:63]
    v_mfma_f32_16x16x32_bf16 v[28:31], v[160:163], v[232:235], 0
    v_mfma_f32_16x16x32_bf16 v[28:31], v[164:167], v[236:239], v[28:31]
    s_waitcnt vmcnt(4) lgkmcnt(3)
    v_mfma_f32_16x16x32_bf16 v[0:3], v[192:195], v[240:243], v[0:3]
    ds_read_b128 v[232:235], v248 offset:53248
    v_mfma_f32_16x16x32_bf16 v[0:3], v[196:199], v[244:247], v[0:3]
    ds_read_b128 v[236:239], v248 offset:54272
    v_mfma_f32_16x16x32_bf16 v[32:35], v[200:203], v[240:243], v[32:35]
    buffer_load_dwordx4 v[160:163], v250, s[60:63], s46 offen offset:0 sc1
    v_mfma_f32_16x16x32_bf16 v[32:35], v[204:207], v[244:247], v[32:35]
    s_waitcnt vmcnt(1)
    v_mfma_f32_16x16x32_bf16 v[64:67], v[208:211], v[240:243], v[64:67]
    ds_write_b128 v250, v[136:139] offset:4096
    v_mfma_f32_16x16x32_bf16 v[64:67], v[212:215], v[244:247], v[64:67]
    buffer_load_dwordx4 v[164:167], v250, s[60:63], s46 offen offset:1024 sc1
    v_mfma_f32_16x16x32_bf16 v[96:99], v[216:219], v[240:243], v[96:99]
    v_mfma_f32_16x16x32_bf16 v[96:99], v[220:223], v[244:247], v[96:99]
    s_waitcnt lgkmcnt(3)
    v_mfma_f32_16x16x32_bf16 v[100:103], v[216:219], v[224:227], v[100:103]
    ds_read_b128 v[240:243], v248 offset:55296
    v_mfma_f32_16x16x32_bf16 v[100:103], v[220:223], v[228:231], v[100:103]
    ds_read_b128 v[244:247], v248 offset:56320
    v_mfma_f32_16x16x32_bf16 v[68:71], v[208:211], v[224:227], v[68:71]
    buffer_load_dwordx4 v[168:171], v250, s[60:63], s46 offen offset:2048 sc1
    v_mfma_f32_16x16x32_bf16 v[68:71], v[212:215], v[228:231], v[68:71]
    v_mfma_f32_16x16x32_bf16 v[36:39], v[200:203], v[224:227], v[36:39]
    ds_write_b128 v250, v[140:143] offset:6144
    v_mfma_f32_16x16x32_bf16 v[36:39], v[204:207], v[228:231], v[36:39]
    buffer_load_dwordx4 v[172:175], v250, s[60:63], s46 offen offset:3072 sc1
    v_mfma_f32_16x16x32_bf16 v[4:7], v[192:195], v[224:227], v[4:7]
    v_mfma_f32_16x16x32_bf16 v[4:7], v[196:199], v[228:231], v[4:7]
    s_waitcnt lgkmcnt(4)
    v_mfma_f32_16x16x32_bf16 v[8:11], v[192:195], v[232:235], v[8:11]
    ds_read_b128 v[224:227], v248 offset:57344
    v_mfma_f32_16x16x32_bf16 v[8:11], v[196:199], v[236:239], v[8:11]
    ds_read_b128 v[228:231], v248 offset:58368
    v_mfma_f32_16x16x32_bf16 v[40:43], v[200:203], v[232:235], v[40:43]
    buffer_load_dwordx4 v[176:179], v250, s[60:63], s47 offen offset:0 sc1
    v_mfma_f32_16x16x32_bf16 v[40:43], v[204:207], v[236:239], v[40:43]
    v_mfma_f32_16x16x32_bf16 v[72:75], v[208:211], v[232:235], v[72:75]
    ds_write_b128 v250, v[144:147] offset:8192
    v_mfma_f32_16x16x32_bf16 v[72:75], v[212:215], v[236:239], v[72:75]
    buffer_load_dwordx4 v[180:183], v250, s[60:63], s47 offen offset:1024 sc1
    v_mfma_f32_16x16x32_bf16 v[104:107], v[216:219], v[232:235], v[104:107]
    v_mfma_f32_16x16x32_bf16 v[104:107], v[220:223], v[236:239], v[104:107]
    s_waitcnt lgkmcnt(4)
    v_mfma_f32_16x16x32_bf16 v[108:111], v[216:219], v[240:243], v[108:111]
    ds_read_b128 v[232:235], v248 offset:59392
    v_mfma_f32_16x16x32_bf16 v[108:111], v[220:223], v[244:247], v[108:111]
    ds_read_b128 v[236:239], v248 offset:60416
    v_mfma_f32_16x16x32_bf16 v[76:79], v[208:211], v[240:243], v[76:79]
    buffer_load_dwordx4 v[184:187], v250, s[60:63], s47 offen offset:2048 sc1
    v_mfma_f32_16x16x32_bf16 v[76:79], v[212:215], v[244:247], v[76:79]
    v_mfma_f32_16x16x32_bf16 v[44:47], v[200:203], v[240:243], v[44:47]
    ds_write_b128 v250, v[148:151] offset:10240
    v_mfma_f32_16x16x32_bf16 v[44:47], v[204:207], v[244:247], v[44:47]
    buffer_load_dwordx4 v[188:191], v250, s[60:63], s47 offen offset:3072 sc1
    v_mfma_f32_16x16x32_bf16 v[12:15], v[192:195], v[240:243], v[12:15]
    v_mfma_f32_16x16x32_bf16 v[12:15], v[196:199], v[244:247], v[12:15]
    s_waitcnt lgkmcnt(4)
    v_mfma_f32_16x16x32_bf16 v[16:19], v[192:195], v[224:227], v[16:19]
    ds_read_b128 v[240:243], v248 offset:61440
    v_mfma_f32_16x16x32_bf16 v[16:19], v[196:199], v[228:231], v[16:19]
    ds_read_b128 v[244:247], v248 offset:62464
    v_mfma_f32_16x16x32_bf16 v[48:51], v[200:203], v[224:227], v[48:51]
    ds_write_b128 v250, v[152:155] offset:12288
    v_mfma_f32_16x16x32_bf16 v[48:51], v[204:207], v[228:231], v[48:51]
    v_mfma_f32_16x16x32_bf16 v[80:83], v[208:211], v[224:227], v[80:83]
    v_mfma_f32_16x16x32_bf16 v[80:83], v[212:215], v[228:231], v[80:83]
    v_mfma_f32_16x16x32_bf16 v[112:115], v[216:219], v[224:227], v[112:115]
    ds_write_b128 v250, v[156:159] offset:14336
    v_mfma_f32_16x16x32_bf16 v[112:115], v[220:223], v[228:231], v[112:115]
    s_waitcnt lgkmcnt(5)
    v_mfma_f32_16x16x32_bf16 v[116:119], v[216:219], v[232:235], v[116:119]
    ds_read_b128 v[224:227], v248 offset:63488
    v_mfma_f32_16x16x32_bf16 v[116:119], v[220:223], v[236:239], v[116:119]
    ds_read_b128 v[228:231], v248 offset:64512
    v_mfma_f32_16x16x32_bf16 v[84:87], v[208:211], v[232:235], v[84:87]
    v_mfma_f32_16x16x32_bf16 v[84:87], v[212:215], v[236:239], v[84:87]
    v_mfma_f32_16x16x32_bf16 v[52:55], v[200:203], v[232:235], v[52:55]
    v_mfma_f32_16x16x32_bf16 v[52:55], v[204:207], v[236:239], v[52:55]
    v_mfma_f32_16x16x32_bf16 v[20:23], v[192:195], v[232:235], v[20:23]
    v_mfma_f32_16x16x32_bf16 v[20:23], v[196:199], v[236:239], v[20:23]
    s_waitcnt lgkmcnt(4)
    v_mfma_f32_16x16x32_bf16 v[24:27], v[192:195], v[240:243], v[24:27]
    s_waitcnt lgkmcnt(2)
    s_barrier
    ds_read_b128 v[232:235], v249 offset:32768
    v_mfma_f32_16x16x32_bf16 v[24:27], v[196:199], v[244:247], v[24:27]
    ds_read_b128 v[236:239], v249 offset:33792
    v_mfma_f32_16x16x32_bf16 v[56:59], v[200:203], v[240:243], v[56:59]
    v_mfma_f32_16x16x32_bf16 v[56:59], v[204:207], v[244:247], v[56:59]
    v_mfma_f32_16x16x32_bf16 v[88:91], v[208:211], v[240:243], v[88:91]
    v_mfma_f32_16x16x32_bf16 v[88:91], v[212:215], v[244:247], v[88:91]
    v_mfma_f32_16x16x32_bf16 v[120:123], v[216:219], v[240:243], v[120:123]
    v_mfma_f32_16x16x32_bf16 v[120:123], v[220:223], v[244:247], v[120:123]
    s_waitcnt lgkmcnt(2)
    v_mfma_f32_16x16x32_bf16 v[124:127], v[216:219], v[224:227], v[124:127]
    ds_read_b128 v[240:243], v249 offset:34816
    v_mfma_f32_16x16x32_bf16 v[124:127], v[220:223], v[228:231], v[124:127]
    ds_read_b128 v[244:247], v249 offset:35840
    v_mfma_f32_16x16x32_bf16 v[92:95], v[208:211], v[224:227], v[92:95]
    v_mfma_f32_16x16x32_bf16 v[92:95], v[212:215], v[228:231], v[92:95]
    s_mov_b32 s46, 827392
    v_mfma_f32_16x16x32_bf16 v[60:63], v[200:203], v[224:227], v[60:63]
    s_mov_b32 s47, 831488
    v_mfma_f32_16x16x32_bf16 v[60:63], v[204:207], v[228:231], v[60:63]
    v_mfma_f32_16x16x32_bf16 v[28:31], v[192:195], v[224:227], v[28:31]
    v_mfma_f32_16x16x32_bf16 v[28:31], v[196:199], v[228:231], v[28:31]
    s_waitcnt vmcnt(4) lgkmcnt(2)
    v_mfma_f32_16x16x32_bf16 v[0:3], v[160:163], v[232:235], v[0:3]
    ds_read_b128 v[224:227], v249 offset:36864
    v_mfma_f32_16x16x32_bf16 v[0:3], v[164:167], v[236:239], v[0:3]
    ds_read_b128 v[228:231], v249 offset:37888
    v_mfma_f32_16x16x32_bf16 v[32:35], v[168:171], v[232:235], v[32:35]
    buffer_load_dwordx4 v[192:195], v250, s[60:63], s46 offen offset:0 sc1
    v_mfma_f32_16x16x32_bf16 v[32:35], v[172:175], v[236:239], v[32:35]
    s_waitcnt vmcnt(1)
    v_mfma_f32_16x16x32_bf16 v[64:67], v[176:179], v[232:235], v[64:67]
    v_mfma_f32_16x16x32_bf16 v[64:67], v[180:183], v[236:239], v[64:67]
    buffer_load_dwordx4 v[196:199], v250, s[60:63], s46 offen offset:1024 sc1
    v_mfma_f32_16x16x32_bf16 v[96:99], v[184:187], v[232:235], v[96:99]
    v_mfma_f32_16x16x32_bf16 v[96:99], v[188:191], v[236:239], v[96:99]
    s_waitcnt lgkmcnt(2)
    v_mfma_f32_16x16x32_bf16 v[100:103], v[184:187], v[240:243], v[100:103]
    ds_read_b128 v[232:235], v249 offset:38912
    v_mfma_f32_16x16x32_bf16 v[100:103], v[188:191], v[244:247], v[100:103]
    ds_read_b128 v[236:239], v249 offset:39936
    v_mfma_f32_16x16x32_bf16 v[68:71], v[176:179], v[240:243], v[68:71]
    buffer_load_dwordx4 v[200:203], v250, s[60:63], s46 offen offset:2048 sc1
    v_mfma_f32_16x16x32_bf16 v[68:71], v[180:183], v[244:247], v[68:71]
    v_mfma_f32_16x16x32_bf16 v[36:39], v[168:171], v[240:243], v[36:39]
    v_mfma_f32_16x16x32_bf16 v[36:39], v[172:175], v[244:247], v[36:39]
    buffer_load_dwordx4 v[204:207], v250, s[60:63], s46 offen offset:3072 sc1
    v_mfma_f32_16x16x32_bf16 v[4:7], v[160:163], v[240:243], v[4:7]
    v_mfma_f32_16x16x32_bf16 v[4:7], v[164:167], v[244:247], v[4:7]
    s_waitcnt lgkmcnt(2)
    v_mfma_f32_16x16x32_bf16 v[8:11], v[160:163], v[224:227], v[8:11]
    ds_read_b128 v[240:243], v249 offset:40960
    v_mfma_f32_16x16x32_bf16 v[8:11], v[164:167], v[228:231], v[8:11]
    ds_read_b128 v[244:247], v249 offset:41984
    v_mfma_f32_16x16x32_bf16 v[40:43], v[168:171], v[224:227], v[40:43]
    buffer_load_dwordx4 v[208:211], v250, s[60:63], s47 offen offset:0 sc1
    v_mfma_f32_16x16x32_bf16 v[40:43], v[172:175], v[228:231], v[40:43]
    v_mfma_f32_16x16x32_bf16 v[72:75], v[176:179], v[224:227], v[72:75]
    v_mfma_f32_16x16x32_bf16 v[72:75], v[180:183], v[228:231], v[72:75]
    buffer_load_dwordx4 v[212:215], v250, s[60:63], s47 offen offset:1024 sc1
    v_mfma_f32_16x16x32_bf16 v[104:107], v[184:187], v[224:227], v[104:107]
    v_mfma_f32_16x16x32_bf16 v[104:107], v[188:191], v[228:231], v[104:107]
    s_waitcnt lgkmcnt(2)
    v_mfma_f32_16x16x32_bf16 v[108:111], v[184:187], v[232:235], v[108:111]
    ds_read_b128 v[224:227], v249 offset:43008
    v_mfma_f32_16x16x32_bf16 v[108:111], v[188:191], v[236:239], v[108:111]
    ds_read_b128 v[228:231], v249 offset:44032
    v_mfma_f32_16x16x32_bf16 v[76:79], v[176:179], v[232:235], v[76:79]
    buffer_load_dwordx4 v[216:219], v250, s[60:63], s47 offen offset:2048 sc1
    v_mfma_f32_16x16x32_bf16 v[76:79], v[180:183], v[236:239], v[76:79]
    v_mfma_f32_16x16x32_bf16 v[44:47], v[168:171], v[232:235], v[44:47]
    v_mfma_f32_16x16x32_bf16 v[44:47], v[172:175], v[236:239], v[44:47]
    buffer_load_dwordx4 v[220:223], v250, s[60:63], s47 offen offset:3072 sc1
    v_mfma_f32_16x16x32_bf16 v[12:15], v[160:163], v[232:235], v[12:15]
    v_mfma_f32_16x16x32_bf16 v[12:15], v[164:167], v[236:239], v[12:15]
    s_waitcnt lgkmcnt(2)
    v_mfma_f32_16x16x32_bf16 v[16:19], v[160:163], v[240:243], v[16:19]
    ds_read_b128 v[232:235], v249 offset:45056
    v_mfma_f32_16x16x32_bf16 v[16:19], v[164:167], v[244:247], v[16:19]
    ds_read_b128 v[236:239], v249 offset:46080
    v_mfma_f32_16x16x32_bf16 v[48:51], v[168:171], v[240:243], v[48:51]
    v_mfma_f32_16x16x32_bf16 v[48:51], v[172:175], v[244:247], v[48:51]
    v_mfma_f32_16x16x32_bf16 v[80:83], v[176:179], v[240:243], v[80:83]
    v_mfma_f32_16x16x32_bf16 v[80:83], v[180:183], v[244:247], v[80:83]
    v_mfma_f32_16x16x32_bf16 v[112:115], v[184:187], v[240:243], v[112:115]
    v_mfma_f32_16x16x32_bf16 v[112:115], v[188:191], v[244:247], v[112:115]
    s_waitcnt lgkmcnt(2)
    v_mfma_f32_16x16x32_bf16 v[116:119], v[184:187], v[224:227], v[116:119]
    ds_read_b128 v[240:243], v249 offset:47104
    v_mfma_f32_16x16x32_bf16 v[116:119], v[188:191], v[228:231], v[116:119]
    ds_read_b128 v[244:247], v249 offset:48128
    v_mfma_f32_16x16x32_bf16 v[84:87], v[176:179], v[224:227], v[84:87]
    v_mfma_f32_16x16x32_bf16 v[84:87], v[180:183], v[228:231], v[84:87]
    v_mfma_f32_16x16x32_bf16 v[52:55], v[168:171], v[224:227], v[52:55]
    v_mfma_f32_16x16x32_bf16 v[52:55], v[172:175], v[228:231], v[52:55]
    v_mfma_f32_16x16x32_bf16 v[20:23], v[160:163], v[224:227], v[20:23]
    v_mfma_f32_16x16x32_bf16 v[20:23], v[164:167], v[228:231], v[20:23]
    s_waitcnt lgkmcnt(2)
    v_mfma_f32_16x16x32_bf16 v[24:27], v[160:163], v[232:235], v[24:27]
    ds_read_b128 v[224:227], v249 offset:49152
    v_mfma_f32_16x16x32_bf16 v[24:27], v[164:167], v[236:239], v[24:27]
    ds_read_b128 v[228:231], v249 offset:50176
    v_mfma_f32_16x16x32_bf16 v[56:59], v[168:171], v[232:235], v[56:59]
    v_mfma_f32_16x16x32_bf16 v[56:59], v[172:175], v[236:239], v[56:59]
    v_mfma_f32_16x16x32_bf16 v[88:91], v[176:179], v[232:235], v[88:91]
    v_mfma_f32_16x16x32_bf16 v[88:91], v[180:183], v[236:239], v[88:91]
    v_mfma_f32_16x16x32_bf16 v[120:123], v[184:187], v[232:235], v[120:123]
    v_mfma_f32_16x16x32_bf16 v[120:123], v[188:191], v[236:239], v[120:123]
    s_waitcnt lgkmcnt(2)
    v_mfma_f32_16x16x32_bf16 v[124:127], v[184:187], v[240:243], v[124:127]
    ds_read_b128 v[232:235], v249 offset:51200
    v_mfma_f32_16x16x32_bf16 v[124:127], v[188:191], v[244:247], v[124:127]
    ds_read_b128 v[236:239], v249 offset:52224
    v_mfma_f32_16x16x32_bf16 v[92:95], v[176:179], v[240:243], v[92:95]
    v_mfma_f32_16x16x32_bf16 v[92:95], v[180:183], v[244:247], v[92:95]
    s_mov_b32 s46, 786432
    v_mfma_f32_16x16x32_bf16 v[60:63], v[168:171], v[240:243], v[60:63]
    s_mov_b32 s47, 790528
    v_mfma_f32_16x16x32_bf16 v[60:63], v[172:175], v[244:247], v[60:63]
    v_mfma_f32_16x16x32_bf16 v[28:31], v[160:163], v[240:243], v[28:31]
    v_mfma_f32_16x16x32_bf16 v[28:31], v[164:167], v[244:247], v[28:31]
    s_waitcnt vmcnt(4) lgkmcnt(2)
    v_mfma_f32_16x16x32_bf16 v[0:3], v[192:195], v[224:227], v[0:3]
    ds_read_b128 v[240:243], v249 offset:53248
    v_mfma_f32_16x16x32_bf16 v[0:3], v[196:199], v[228:231], v[0:3]
    ds_read_b128 v[244:247], v249 offset:54272
    v_mfma_f32_16x16x32_bf16 v[32:35], v[200:203], v[224:227], v[32:35]
    buffer_load_dwordx4 v[160:163], v250, s[60:63], s46 offen offset:0 sc1
    v_mfma_f32_16x16x32_bf16 v[32:35], v[204:207], v[228:231], v[32:35]
    s_waitcnt vmcnt(1)
    v_mfma_f32_16x16x32_bf16 v[64:67], v[208:211], v[224:227], v[64:67]
    v_mfma_f32_16x16x32_bf16 v[64:67], v[212:215], v[228:231], v[64:67]
    buffer_load_dwordx4 v[164:167], v250, s[60:63], s46 offen offset:1024 sc1
    v_mfma_f32_16x16x32_bf16 v[96:99], v[216:219], v[224:227], v[96:99]
    v_mfma_f32_16x16x32_bf16 v[96:99], v[220:223], v[228:231], v[96:99]
    s_waitcnt lgkmcnt(2)
    v_mfma_f32_16x16x32_bf16 v[100:103], v[216:219], v[232:235], v[100:103]
    ds_read_b128 v[224:227], v249 offset:55296
    v_mfma_f32_16x16x32_bf16 v[100:103], v[220:223], v[236:239], v[100:103]
    ds_read_b128 v[228:231], v249 offset:56320
    v_mfma_f32_16x16x32_bf16 v[68:71], v[208:211], v[232:235], v[68:71]
    buffer_load_dwordx4 v[168:171], v250, s[60:63], s46 offen offset:2048 sc1
    v_mfma_f32_16x16x32_bf16 v[68:71], v[212:215], v[236:239], v[68:71]
    v_mfma_f32_16x16x32_bf16 v[36:39], v[200:203], v[232:235], v[36:39]
    v_mfma_f32_16x16x32_bf16 v[36:39], v[204:207], v[236:239], v[36:39]
    buffer_load_dwordx4 v[172:175], v250, s[60:63], s46 offen offset:3072 sc1
    v_mfma_f32_16x16x32_bf16 v[4:7], v[192:195], v[232:235], v[4:7]
    v_mfma_f32_16x16x32_bf16 v[4:7], v[196:199], v[236:239], v[4:7]
    s_waitcnt lgkmcnt(2)
    v_mfma_f32_16x16x32_bf16 v[8:11], v[192:195], v[240:243], v[8:11]
    ds_read_b128 v[232:235], v249 offset:57344
    v_mfma_f32_16x16x32_bf16 v[8:11], v[196:199], v[244:247], v[8:11]
    ds_read_b128 v[236:239], v249 offset:58368
    v_mfma_f32_16x16x32_bf16 v[40:43], v[200:203], v[240:243], v[40:43]
    buffer_load_dwordx4 v[176:179], v250, s[60:63], s47 offen offset:0 sc1
    v_mfma_f32_16x16x32_bf16 v[40:43], v[204:207], v[244:247], v[40:43]
    v_mfma_f32_16x16x32_bf16 v[72:75], v[208:211], v[240:243], v[72:75]
    v_mfma_f32_16x16x32_bf16 v[72:75], v[212:215], v[244:247], v[72:75]
    buffer_load_dwordx4 v[180:183], v250, s[60:63], s47 offen offset:1024 sc1
    v_mfma_f32_16x16x32_bf16 v[104:107], v[216:219], v[240:243], v[104:107]
    v_mfma_f32_16x16x32_bf16 v[104:107], v[220:223], v[244:247], v[104:107]
    s_waitcnt lgkmcnt(2)
    v_mfma_f32_16x16x32_bf16 v[108:111], v[216:219], v[224:227], v[108:111]
    ds_read_b128 v[240:243], v249 offset:59392
    v_mfma_f32_16x16x32_bf16 v[108:111], v[220:223], v[228:231], v[108:111]
    ds_read_b128 v[244:247], v249 offset:60416
    v_mfma_f32_16x16x32_bf16 v[76:79], v[208:211], v[224:227], v[76:79]
    buffer_load_dwordx4 v[184:187], v250, s[60:63], s47 offen offset:2048 sc1
    v_mfma_f32_16x16x32_bf16 v[76:79], v[212:215], v[228:231], v[76:79]
    v_mfma_f32_16x16x32_bf16 v[44:47], v[200:203], v[224:227], v[44:47]
    v_mfma_f32_16x16x32_bf16 v[44:47], v[204:207], v[228:231], v[44:47]
    buffer_load_dwordx4 v[188:191], v250, s[60:63], s47 offen offset:3072 sc1
    v_mfma_f32_16x16x32_bf16 v[12:15], v[192:195], v[224:227], v[12:15]
    v_mfma_f32_16x16x32_bf16 v[12:15], v[196:199], v[228:231], v[12:15]
    s_waitcnt lgkmcnt(2)
    v_mfma_f32_16x16x32_bf16 v[16:19], v[192:195], v[232:235], v[16:19]
    ds_read_b128 v[224:227], v249 offset:61440
    v_mfma_f32_16x16x32_bf16 v[16:19], v[196:199], v[236:239], v[16:19]
    ds_read_b128 v[228:231], v249 offset:62464
    v_mfma_f32_16x16x32_bf16 v[48:51], v[200:203], v[232:235], v[48:51]
    v_mfma_f32_16x16x32_bf16 v[48:51], v[204:207], v[236:239], v[48:51]
    v_mfma_f32_16x16x32_bf16 v[80:83], v[208:211], v[232:235], v[80:83]
    s_setprio 2
    v_mfma_f32_16x16x32_bf16 v[80:83], v[212:215], v[236:239], v[80:83]
    v_mfma_f32_16x16x32_bf16 v[112:115], v[216:219], v[232:235], v[112:115]
    v_mfma_f32_16x16x32_bf16 v[112:115], v[220:223], v[236:239], v[112:115]
    s_waitcnt lgkmcnt(2)
    v_mfma_f32_16x16x32_bf16 v[116:119], v[216:219], v[240:243], v[116:119]
    ds_read_b128 v[232:235], v249 offset:63488
    v_mfma_f32_16x16x32_bf16 v[116:119], v[220:223], v[244:247], v[116:119]
    ds_read_b128 v[236:239], v249 offset:64512
    v_mfma_f32_16x16x32_bf16 v[84:87], v[208:211], v[240:243], v[84:87]
    v_mfma_f32_16x16x32_bf16 v[84:87], v[212:215], v[244:247], v[84:87]
    v_mfma_f32_16x16x32_bf16 v[52:55], v[200:203], v[240:243], v[52:55]
    v_mfma_f32_16x16x32_bf16 v[52:55], v[204:207], v[244:247], v[52:55]
    v_mfma_f32_16x16x32_bf16 v[20:23], v[192:195], v[240:243], v[20:23]
    v_mfma_f32_16x16x32_bf16 v[20:23], v[196:199], v[244:247], v[20:23]
    s_waitcnt lgkmcnt(2)
    v_mfma_f32_16x16x32_bf16 v[24:27], v[192:195], v[224:227], v[24:27]
    ds_read_b128 v[240:243], v249 offset:0
    v_mfma_f32_16x16x32_bf16 v[24:27], v[196:199], v[228:231], v[24:27]
    ds_read_b128 v[244:247], v249 offset:1024
    v_mfma_f32_16x16x32_bf16 v[56:59], v[200:203], v[224:227], v[56:59]
    v_mfma_f32_16x16x32_bf16 v[56:59], v[204:207], v[228:231], v[56:59]
    v_mfma_f32_16x16x32_bf16 v[88:91], v[208:211], v[224:227], v[88:91]
    v_mfma_f32_16x16x32_bf16 v[88:91], v[212:215], v[228:231], v[88:91]
    v_mfma_f32_16x16x32_bf16 v[120:123], v[216:219], v[224:227], v[120:123]
    v_mfma_f32_16x16x32_bf16 v[120:123], v[220:223], v[228:231], v[120:123]
    s_waitcnt lgkmcnt(2)
    v_mfma_f32_16x16x32_bf16 v[124:127], v[216:219], v[232:235], v[124:127]
    ds_read_b128 v[224:227], v249 offset:2048
    v_mfma_f32_16x16x32_bf16 v[124:127], v[220:223], v[236:239], v[124:127]
    ds_read_b128 v[228:231], v249 offset:3072
    v_mfma_f32_16x16x32_bf16 v[92:95], v[208:211], v[232:235], v[92:95]
    v_mfma_f32_16x16x32_bf16 v[92:95], v[212:215], v[236:239], v[92:95]
    s_mov_b32 s46, 794624
    v_mfma_f32_16x16x32_bf16 v[60:63], v[200:203], v[232:235], v[60:63]
    s_mov_b32 s47, 798720
    v_mfma_f32_16x16x32_bf16 v[60:63], v[204:207], v[236:239], v[60:63]
    v_mfma_f32_16x16x32_bf16 v[28:31], v[192:195], v[232:235], v[28:31]
    v_mfma_f32_16x16x32_bf16 v[28:31], v[196:199], v[236:239], v[28:31]
    s_waitcnt vmcnt(4) lgkmcnt(2)
    v_mfma_f32_16x16x32_bf16 v[0:3], v[160:163], v[240:243], v[0:3]
    ds_read_b128 v[232:235], v249 offset:4096
    v_mfma_f32_16x16x32_bf16 v[0:3], v[164:167], v[244:247], v[0:3]
    ds_read_b128 v[236:239], v249 offset:5120
    v_mfma_f32_16x16x32_bf16 v[32:35], v[168:171], v[240:243], v[32:35]
    buffer_load_dwordx4 v[192:195], v250, s[60:63], s46 offen offset:0 sc1
    v_mfma_f32_16x16x32_bf16 v[32:35], v[172:175], v[244:247], v[32:35]
    s_waitcnt vmcnt(1)
    v_mfma_f32_16x16x32_bf16 v[64:67], v[176:179], v[240:243], v[64:67]
    v_mfma_f32_16x16x32_bf16 v[64:67], v[180:183], v[244:247], v[64:67]
    buffer_load_dwordx4 v[196:199], v250, s[60:63], s46 offen offset:1024 sc1
    v_mfma_f32_16x16x32_bf16 v[96:99], v[184:187], v[240:243], v[96:99]
    v_mfma_f32_16x16x32_bf16 v[96:99], v[188:191], v[244:247], v[96:99]
    s_waitcnt lgkmcnt(2)
    v_mfma_f32_16x16x32_bf16 v[100:103], v[184:187], v[224:227], v[100:103]
    ds_read_b128 v[240:243], v249 offset:6144
    v_mfma_f32_16x16x32_bf16 v[100:103], v[188:191], v[228:231], v[100:103]
    ds_read_b128 v[244:247], v249 offset:7168
    v_mfma_f32_16x16x32_bf16 v[68:71], v[176:179], v[224:227], v[68:71]
    buffer_load_dwordx4 v[200:203], v250, s[60:63], s46 offen offset:2048 sc1
    v_mfma_f32_16x16x32_bf16 v[68:71], v[180:183], v[228:231], v[68:71]
    v_mfma_f32_16x16x32_bf16 v[36:39], v[168:171], v[224:227], v[36:39]
    v_mfma_f32_16x16x32_bf16 v[36:39], v[172:175], v[228:231], v[36:39]
    buffer_load_dwordx4 v[204:207], v250, s[60:63], s46 offen offset:3072 sc1
    v_mfma_f32_16x16x32_bf16 v[4:7], v[160:163], v[224:227], v[4:7]
    v_mfma_f32_16x16x32_bf16 v[4:7], v[164:167], v[228:231], v[4:7]
    s_waitcnt lgkmcnt(2)
    v_mfma_f32_16x16x32_bf16 v[8:11], v[160:163], v[232:235], v[8:11]
    ds_read_b128 v[224:227], v249 offset:8192
    v_mfma_f32_16x16x32_bf16 v[8:11], v[164:167], v[236:239], v[8:11]
    ds_read_b128 v[228:231], v249 offset:9216
    v_mfma_f32_16x16x32_bf16 v[40:43], v[168:171], v[232:235], v[40:43]
    buffer_load_dwordx4 v[208:211], v250, s[60:63], s47 offen offset:0 sc1
    v_mfma_f32_16x16x32_bf16 v[40:43], v[172:175], v[236:239], v[40:43]
    v_mfma_f32_16x16x32_bf16 v[72:75], v[176:179], v[232:235], v[72:75]
    v_mfma_f32_16x16x32_bf16 v[72:75], v[180:183], v[236:239], v[72:75]
    buffer_load_dwordx4 v[212:215], v250, s[60:63], s47 offen offset:1024 sc1
    v_mfma_f32_16x16x32_bf16 v[104:107], v[184:187], v[232:235], v[104:107]
    v_mfma_f32_16x16x32_bf16 v[104:107], v[188:191], v[236:239], v[104:107]
    s_waitcnt lgkmcnt(2)
    v_mfma_f32_16x16x32_bf16 v[108:111], v[184:187], v[240:243], v[108:111]
    ds_read_b128 v[232:235], v249 offset:10240
    v_mfma_f32_16x16x32_bf16 v[108:111], v[188:191], v[244:247], v[108:111]
    ds_read_b128 v[236:239], v249 offset:11264
    v_mfma_f32_16x16x32_bf16 v[76:79], v[176:179], v[240:243], v[76:79]
    buffer_load_dwordx4 v[216:219], v250, s[60:63], s47 offen offset:2048 sc1
    v_mfma_f32_16x16x32_bf16 v[76:79], v[180:183], v[244:247], v[76:79]
    v_mfma_f32_16x16x32_bf16 v[44:47], v[168:171], v[240:243], v[44:47]
    v_mfma_f32_16x16x32_bf16 v[44:47], v[172:175], v[244:247], v[44:47]
    buffer_load_dwordx4 v[220:223], v250, s[60:63], s47 offen offset:3072 sc1
    v_mfma_f32_16x16x32_bf16 v[12:15], v[160:163], v[240:243], v[12:15]
    s_mov_b32 s46, 843776
    v_mfma_f32_16x16x32_bf16 v[12:15], v[164:167], v[244:247], v[12:15]
    s_waitcnt lgkmcnt(2)
    s_mov_b32 s47, 847872
    v_mfma_f32_16x16x32_bf16 v[16:19], v[160:163], v[224:227], v[16:19]
    ds_read_b128 v[240:243], v249 offset:12288
    v_mfma_f32_16x16x32_bf16 v[16:19], v[164:167], v[228:231], v[16:19]
    ds_read_b128 v[244:247], v249 offset:13312
    v_mfma_f32_16x16x32_bf16 v[48:51], v[168:171], v[224:227], v[48:51]
    buffer_load_dwordx4 v[128:131], v250, s[60:63], s46 offen offset:0 sc1
    v_mfma_f32_16x16x32_bf16 v[48:51], v[172:175], v[228:231], v[48:51]
    v_mfma_f32_16x16x32_bf16 v[80:83], v[176:179], v[224:227], v[80:83]
    v_mfma_f32_16x16x32_bf16 v[80:83], v[180:183], v[228:231], v[80:83]
    buffer_load_dwordx4 v[132:135], v250, s[60:63], s46 offen offset:1024 sc1
    v_mfma_f32_16x16x32_bf16 v[112:115], v[184:187], v[224:227], v[112:115]
    v_mfma_f32_16x16x32_bf16 v[112:115], v[188:191], v[228:231], v[112:115]
    s_waitcnt lgkmcnt(2)
    v_mfma_f32_16x16x32_bf16 v[116:119], v[184:187], v[232:235], v[116:119]
    ds_read_b128 v[224:227], v249 offset:14336
    v_mfma_f32_16x16x32_bf16 v[116:119], v[188:191], v[236:239], v[116:119]
    ds_read_b128 v[228:231], v249 offset:15360
    v_mfma_f32_16x16x32_bf16 v[84:87], v[176:179], v[232:235], v[84:87]
    buffer_load_dwordx4 v[136:139], v250, s[60:63], s46 offen offset:2048 sc1
    v_mfma_f32_16x16x32_bf16 v[84:87], v[180:183], v[236:239], v[84:87]
    v_mfma_f32_16x16x32_bf16 v[52:55], v[168:171], v[232:235], v[52:55]
    v_mfma_f32_16x16x32_bf16 v[52:55], v[172:175], v[236:239], v[52:55]
    buffer_load_dwordx4 v[140:143], v250, s[60:63], s46 offen offset:3072 sc1
    v_mfma_f32_16x16x32_bf16 v[20:23], v[160:163], v[232:235], v[20:23]
    v_mfma_f32_16x16x32_bf16 v[20:23], v[164:167], v[236:239], v[20:23]
    s_waitcnt lgkmcnt(2)
    v_mfma_f32_16x16x32_bf16 v[24:27], v[160:163], v[240:243], v[24:27]
    ds_read_b128 v[232:235], v249 offset:16384
    v_mfma_f32_16x16x32_bf16 v[24:27], v[164:167], v[244:247], v[24:27]
    ds_read_b128 v[236:239], v249 offset:17408
    v_mfma_f32_16x16x32_bf16 v[56:59], v[168:171], v[240:243], v[56:59]
    buffer_load_dwordx4 v[144:147], v250, s[60:63], s47 offen offset:0 sc1
    v_mfma_f32_16x16x32_bf16 v[56:59], v[172:175], v[244:247], v[56:59]
    v_mfma_f32_16x16x32_bf16 v[88:91], v[176:179], v[240:243], v[88:91]
    v_mfma_f32_16x16x32_bf16 v[88:91], v[180:183], v[244:247], v[88:91]
    buffer_load_dwordx4 v[148:151], v250, s[60:63], s47 offen offset:1024 sc1
    v_mfma_f32_16x16x32_bf16 v[120:123], v[184:187], v[240:243], v[120:123]
    v_mfma_f32_16x16x32_bf16 v[120:123], v[188:191], v[244:247], v[120:123]
    s_waitcnt lgkmcnt(2)
    v_mfma_f32_16x16x32_bf16 v[124:127], v[184:187], v[224:227], v[124:127]
    ds_read_b128 v[240:243], v249 offset:18432
    v_mfma_f32_16x16x32_bf16 v[124:127], v[188:191], v[228:231], v[124:127]
    ds_read_b128 v[244:247], v249 offset:19456
    v_mfma_f32_16x16x32_bf16 v[92:95], v[176:179], v[224:227], v[92:95]
    buffer_load_dwordx4 v[152:155], v250, s[60:63], s47 offen offset:2048 sc1
    buffer_load_dwordx4 v[156:159], v250, s[60:63], s47 offen offset:3072 sc1
    v_mfma_f32_16x16x32_bf16 v[92:95], v[180:183], v[228:231], v[92:95]
    s_mov_b32 s46, 835584
    v_mfma_f32_16x16x32_bf16 v[60:63], v[168:171], v[224:227], v[60:63]
    s_mov_b32 s47, 839680
    v_mfma_f32_16x16x32_bf16 v[60:63], v[172:175], v[228:231], v[60:63]
    v_mfma_f32_16x16x32_bf16 v[28:31], v[160:163], v[224:227], v[28:31]
    v_mfma_f32_16x16x32_bf16 v[28:31], v[164:167], v[228:231], v[28:31]
    s_waitcnt vmcnt(12) lgkmcnt(2)
    v_mfma_f32_16x16x32_bf16 v[0:3], v[192:195], v[232:235], v[0:3]
    ds_read_b128 v[224:227], v249 offset:20480
    v_mfma_f32_16x16x32_bf16 v[0:3], v[196:199], v[236:239], v[0:3]
    ds_read_b128 v[228:231], v249 offset:21504
    v_mfma_f32_16x16x32_bf16 v[32:35], v[200:203], v[232:235], v[32:35]
    buffer_load_dwordx4 v[160:163], v250, s[60:63], s46 offen offset:0 sc1
    v_mfma_f32_16x16x32_bf16 v[32:35], v[204:207], v[236:239], v[32:35]
    s_waitcnt vmcnt(9)
    v_mfma_f32_16x16x32_bf16 v[64:67], v[208:211], v[232:235], v[64:67]
    v_mfma_f32_16x16x32_bf16 v[64:67], v[212:215], v[236:239], v[64:67]
    buffer_load_dwordx4 v[164:167], v250, s[60:63], s46 offen offset:1024 sc1
    v_mfma_f32_16x16x32_bf16 v[96:99], v[216:219], v[232:235], v[96:99]
    v_mfma_f32_16x16x32_bf16 v[96:99], v[220:223], v[236:239], v[96:99]
    s_waitcnt lgkmcnt(2)
    v_mfma_f32_16x16x32_bf16 v[100:103], v[216:219], v[240:243], v[100:103]
    ds_read_b128 v[232:235], v249 offset:22528
    v_mfma_f32_16x16x32_bf16 v[100:103], v[220:223], v[244:247], v[100:103]
    ds_read_b128 v[236:239], v249 offset:23552
    v_mfma_f32_16x16x32_bf16 v[68:71], v[208:211], v[240:243], v[68:71]
    buffer_load_dwordx4 v[168:171], v250, s[60:63], s46 offen offset:2048 sc1
    v_mfma_f32_16x16x32_bf16 v[68:71], v[212:215], v[244:247], v[68:71]
    v_mfma_f32_16x16x32_bf16 v[36:39], v[200:203], v[240:243], v[36:39]
    v_mfma_f32_16x16x32_bf16 v[36:39], v[204:207], v[244:247], v[36:39]
    buffer_load_dwordx4 v[172:175], v250, s[60:63], s46 offen offset:3072 sc1
    v_mfma_f32_16x16x32_bf16 v[4:7], v[192:195], v[240:243], v[4:7]
    v_mfma_f32_16x16x32_bf16 v[4:7], v[196:199], v[244:247], v[4:7]
    s_waitcnt lgkmcnt(2)
    v_mfma_f32_16x16x32_bf16 v[8:11], v[192:195], v[224:227], v[8:11]
    ds_read_b128 v[240:243], v249 offset:24576
    v_mfma_f32_16x16x32_bf16 v[8:11], v[196:199], v[228:231], v[8:11]
    ds_read_b128 v[244:247], v249 offset:25600
    v_mfma_f32_16x16x32_bf16 v[40:43], v[200:203], v[224:227], v[40:43]
    buffer_load_dwordx4 v[176:179], v250, s[60:63], s47 offen offset:0 sc1
    v_mfma_f32_16x16x32_bf16 v[40:43], v[204:207], v[228:231], v[40:43]
    v_mfma_f32_16x16x32_bf16 v[72:75], v[208:211], v[224:227], v[72:75]
    v_mfma_f32_16x16x32_bf16 v[72:75], v[212:215], v[228:231], v[72:75]
    buffer_load_dwordx4 v[180:183], v250, s[60:63], s47 offen offset:1024 sc1
    v_mfma_f32_16x16x32_bf16 v[104:107], v[216:219], v[224:227], v[104:107]
    v_mfma_f32_16x16x32_bf16 v[104:107], v[220:223], v[228:231], v[104:107]
    s_waitcnt lgkmcnt(2)
    v_mfma_f32_16x16x32_bf16 v[108:111], v[216:219], v[232:235], v[108:111]
    ds_read_b128 v[224:227], v249 offset:26624
    v_mfma_f32_16x16x32_bf16 v[108:111], v[220:223], v[236:239], v[108:111]
    ds_read_b128 v[228:231], v249 offset:27648
    v_mfma_f32_16x16x32_bf16 v[76:79], v[208:211], v[232:235], v[76:79]
    buffer_load_dwordx4 v[184:187], v250, s[60:63], s47 offen offset:2048 sc1
    v_mfma_f32_16x16x32_bf16 v[76:79], v[212:215], v[236:239], v[76:79]
    v_mfma_f32_16x16x32_bf16 v[44:47], v[200:203], v[232:235], v[44:47]
    v_mfma_f32_16x16x32_bf16 v[44:47], v[204:207], v[236:239], v[44:47]
    buffer_load_dwordx4 v[188:191], v250, s[60:63], s47 offen offset:3072 sc1
    v_mfma_f32_16x16x32_bf16 v[12:15], v[192:195], v[232:235], v[12:15]
    v_mfma_f32_16x16x32_bf16 v[12:15], v[196:199], v[236:239], v[12:15]
    s_waitcnt lgkmcnt(2)
    v_mfma_f32_16x16x32_bf16 v[16:19], v[192:195], v[240:243], v[16:19]
    ds_read_b128 v[232:235], v249 offset:28672
    v_mfma_f32_16x16x32_bf16 v[16:19], v[196:199], v[244:247], v[16:19]
    ds_read_b128 v[236:239], v249 offset:29696
    v_mfma_f32_16x16x32_bf16 v[48:51], v[200:203], v[240:243], v[48:51]
    v_mfma_f32_16x16x32_bf16 v[48:51], v[204:207], v[244:247], v[48:51]
    v_mfma_f32_16x16x32_bf16 v[80:83], v[208:211], v[240:243], v[80:83]
    v_mfma_f32_16x16x32_bf16 v[80:83], v[212:215], v[244:247], v[80:83]
    v_mfma_f32_16x16x32_bf16 v[112:115], v[216:219], v[240:243], v[112:115]
    v_mfma_f32_16x16x32_bf16 v[112:115], v[220:223], v[244:247], v[112:115]
    s_waitcnt lgkmcnt(2)
    v_mfma_f32_16x16x32_bf16 v[116:119], v[216:219], v[224:227], v[116:119]
    ds_read_b128 v[240:243], v249 offset:30720
    v_mfma_f32_16x16x32_bf16 v[116:119], v[220:223], v[228:231], v[116:119]
    ds_read_b128 v[244:247], v249 offset:31744
    v_mfma_f32_16x16x32_bf16 v[84:87], v[208:211], v[224:227], v[84:87]
    v_mfma_f32_16x16x32_bf16 v[84:87], v[212:215], v[228:231], v[84:87]
    v_mfma_f32_16x16x32_bf16 v[52:55], v[200:203], v[224:227], v[52:55]
    v_mfma_f32_16x16x32_bf16 v[52:55], v[204:207], v[228:231], v[52:55]
    v_mfma_f32_16x16x32_bf16 v[20:23], v[192:195], v[224:227], v[20:23]
    v_mfma_f32_16x16x32_bf16 v[20:23], v[196:199], v[228:231], v[20:23]
    s_waitcnt lgkmcnt(2)
    v_mfma_f32_16x16x32_bf16 v[24:27], v[192:195], v[232:235], v[24:27]
    s_barrier
    ds_read_b128 v[224:227], v248 offset:0
    v_mfma_f32_16x16x32_bf16 v[24:27], v[196:199], v[236:239], v[24:27]
    ds_read_b128 v[228:231], v248 offset:1024
    v_mfma_f32_16x16x32_bf16 v[56:59], v[200:203], v[232:235], v[56:59]
    v_mfma_f32_16x16x32_bf16 v[56:59], v[204:207], v[236:239], v[56:59]
    v_mfma_f32_16x16x32_bf16 v[88:91], v[208:211], v[232:235], v[88:91]
    v_mfma_f32_16x16x32_bf16 v[88:91], v[212:215], v[236:239], v[88:91]
    v_mfma_f32_16x16x32_bf16 v[120:123], v[216:219], v[232:235], v[120:123]
    v_mfma_f32_16x16x32_bf16 v[120:123], v[220:223], v[236:239], v[120:123]
    s_waitcnt lgkmcnt(2)
    v_mfma_f32_16x16x32_bf16 v[124:127], v[216:219], v[240:243], v[124:127]
    ds_read_b128 v[232:235], v248 offset:16384
    v_mfma_f32_16x16x32_bf16 v[124:127], v[220:223], v[244:247], v[124:127]
    ds_read_b128 v[236:239], v248 offset:17408
    v_mfma_f32_16x16x32_bf16 v[92:95], v[208:211], v[240:243], v[92:95]
    v_mfma_f32_16x16x32_bf16 v[92:95], v[212:215], v[244:247], v[92:95]
    v_mfma_f32_16x16x32_bf16 v[60:63], v[200:203], v[240:243], v[60:63]
    v_mfma_f32_16x16x32_bf16 v[60:63], v[204:207], v[244:247], v[60:63]
    v_mfma_f32_16x16x32_bf16 v[28:31], v[192:195], v[240:243], v[28:31]
    v_mfma_f32_16x16x32_bf16 v[28:31], v[196:199], v[244:247], v[28:31]
    s_waitcnt vmcnt(4) lgkmcnt(2)
    v_mfma_f32_16x16x32_bf16 v[0:3], v[160:163], v[224:227], v[0:3]
    ds_read_b128 v[240:243], v248 offset:2048
    v_mfma_f32_16x16x32_bf16 v[0:3], v[164:167], v[228:231], v[0:3]
    ds_read_b128 v[244:247], v248 offset:3072
    v_mfma_f32_16x16x32_bf16 v[32:35], v[168:171], v[224:227], v[32:35]
    v_mfma_f32_16x16x32_bf16 v[32:35], v[172:175], v[228:231], v[32:35]
    s_waitcnt vmcnt(0)
    v_mfma_f32_16x16x32_bf16 v[64:67], v[176:179], v[224:227], v[64:67]
    v_mfma_f32_16x16x32_bf16 v[64:67], v[180:183], v[228:231], v[64:67]
    v_mfma_f32_16x16x32_bf16 v[96:99], v[184:187], v[224:227], v[96:99]
    v_mfma_f32_16x16x32_bf16 v[96:99], v[188:191], v[228:231], v[96:99]
    s_waitcnt lgkmcnt(2)
    v_mfma_f32_16x16x32_bf16 v[96:99], v[152:155], v[232:235], v[96:99]
    ds_read_b128 v[224:227], v248 offset:18432
    v_mfma_f32_16x16x32_bf16 v[96:99], v[156:159], v[236:239], v[96:99]
    ds_read_b128 v[228:231], v248 offset:19456
    v_mfma_f32_16x16x32_bf16 v[64:67], v[144:147], v[232:235], v[64:67]
    v_mfma_f32_16x16x32_bf16 v[64:67], v[148:151], v[236:239], v[64:67]
    v_mfma_f32_16x16x32_bf16 v[32:35], v[136:139], v[232:235], v[32:35]
    v_mfma_f32_16x16x32_bf16 v[32:35], v[140:143], v[236:239], v[32:35]
    v_mfma_f32_16x16x32_bf16 v[0:3], v[128:131], v[232:235], v[0:3]
    v_mfma_f32_16x16x32_bf16 v[0:3], v[132:135], v[236:239], v[0:3]
    s_waitcnt lgkmcnt(2)
    v_mfma_f32_16x16x32_bf16 v[4:7], v[160:163], v[240:243], v[4:7]
    ds_read_b128 v[232:235], v248 offset:4096
    v_mfma_f32_16x16x32_bf16 v[4:7], v[164:167], v[244:247], v[4:7]
    ds_read_b128 v[236:239], v248 offset:5120
    v_mfma_f32_16x16x32_bf16 v[36:39], v[168:171], v[240:243], v[36:39]
    v_mfma_f32_16x16x32_bf16 v[36:39], v[172:175], v[244:247], v[36:39]
    v_mfma_f32_16x16x32_bf16 v[68:71], v[176:179], v[240:243], v[68:71]
    v_mfma_f32_16x16x32_bf16 v[68:71], v[180:183], v[244:247], v[68:71]
    v_mfma_f32_16x16x32_bf16 v[100:103], v[184:187], v[240:243], v[100:103]
    v_mfma_f32_16x16x32_bf16 v[100:103], v[188:191], v[244:247], v[100:103]
    s_waitcnt lgkmcnt(2)
    v_mfma_f32_16x16x32_bf16 v[100:103], v[152:155], v[224:227], v[100:103]
    ds_read_b128 v[240:243], v248 offset:20480
    v_mfma_f32_16x16x32_bf16 v[100:103], v[156:159], v[228:231], v[100:103]
    ds_read_b128 v[244:247], v248 offset:21504
    v_mfma_f32_16x16x32_bf16 v[68:71], v[144:147], v[224:227], v[68:71]
    v_mfma_f32_16x16x32_bf16 v[68:71], v[148:151], v[228:231], v[68:71]
    v_mfma_f32_16x16x32_bf16 v[36:39], v[136:139], v[224:227], v[36:39]
    v_mfma_f32_16x16x32_bf16 v[36:39], v[140:143], v[228:231], v[36:39]
    v_mfma_f32_16x16x32_bf16 v[4:7], v[128:131], v[224:227], v[4:7]
    v_mfma_f32_16x16x32_bf16 v[4:7], v[132:135], v[228:231], v[4:7]
    s_waitcnt lgkmcnt(2)
    v_mfma_f32_16x16x32_bf16 v[8:11], v[160:163], v[232:235], v[8:11]
    ds_read_b128 v[224:227], v248 offset:6144
    v_mfma_f32_16x16x32_bf16 v[8:11], v[164:167], v[236:239], v[8:11]
    ds_read_b128 v[228:231], v248 offset:7168
    v_mfma_f32_16x16x32_bf16 v[40:43], v[168:171], v[232:235], v[40:43]
    v_mfma_f32_16x16x32_bf16 v[40:43], v[172:175], v[236:239], v[40:43]
    v_mfma_f32_16x16x32_bf16 v[72:75], v[176:179], v[232:235], v[72:75]
    v_mfma_f32_16x16x32_bf16 v[72:75], v[180:183], v[236:239], v[72:75]
    v_mfma_f32_16x16x32_bf16 v[104:107], v[184:187], v[232:235], v[104:107]
    v_mfma_f32_16x16x32_bf16 v[104:107], v[188:191], v[236:239], v[104:107]
    s_waitcnt lgkmcnt(2)
    v_mfma_f32_16x16x32_bf16 v[104:107], v[152:155], v[240:243], v[104:107]
    ds_read_b128 v[232:235], v248 offset:22528
    v_mfma_f32_16x16x32_bf16 v[104:107], v[156:159], v[244:247], v[104:107]
    ds_read_b128 v[236:239], v248 offset:23552
    v_mfma_f32_16x16x32_bf16 v[72:75], v[144:147], v[240:243], v[72:75]
    v_mfma_f32_16x16x32_bf16 v[72:75], v[148:151], v[244:247], v[72:75]
    v_mfma_f32_16x16x32_bf16 v[40:43], v[136:139], v[240:243], v[40:43]
    v_mfma_f32_16x16x32_bf16 v[40:43], v[140:143], v[244:247], v[40:43]
    v_mfma_f32_16x16x32_bf16 v[8:11], v[128:131], v[240:243], v[8:11]
    v_mfma_f32_16x16x32_bf16 v[8:11], v[132:135], v[244:247], v[8:11]
    s_waitcnt lgkmcnt(2)
    v_mfma_f32_16x16x32_bf16 v[12:15], v[160:163], v[224:227], v[12:15]
    ds_read_b128 v[240:243], v248 offset:8192
    v_mfma_f32_16x16x32_bf16 v[12:15], v[164:167], v[228:231], v[12:15]
    ds_read_b128 v[244:247], v248 offset:9216
    v_mfma_f32_16x16x32_bf16 v[44:47], v[168:171], v[224:227], v[44:47]
    v_mfma_f32_16x16x32_bf16 v[44:47], v[172:175], v[228:231], v[44:47]
    v_mfma_f32_16x16x32_bf16 v[76:79], v[176:179], v[224:227], v[76:79]
    v_mfma_f32_16x16x32_bf16 v[76:79], v[180:183], v[228:231], v[76:79]
    v_mfma_f32_16x16x32_bf16 v[108:111], v[184:187], v[224:227], v[108:111]
    v_mfma_f32_16x16x32_bf16 v[108:111], v[188:191], v[228:231], v[108:111]
    s_waitcnt lgkmcnt(2)
    v_mfma_f32_16x16x32_bf16 v[108:111], v[152:155], v[232:235], v[108:111]
    ds_read_b128 v[224:227], v248 offset:24576
    v_mfma_f32_16x16x32_bf16 v[108:111], v[156:159], v[236:239], v[108:111]
    ds_read_b128 v[228:231], v248 offset:25600
    v_mfma_f32_16x16x32_bf16 v[76:79], v[144:147], v[232:235], v[76:79]
    v_mfma_f32_16x16x32_bf16 v[76:79], v[148:151], v[236:239], v[76:79]
    v_mfma_f32_16x16x32_bf16 v[44:47], v[136:139], v[232:235], v[44:47]
    v_mfma_f32_16x16x32_bf16 v[44:47], v[140:143], v[236:239], v[44:47]
    v_mfma_f32_16x16x32_bf16 v[12:15], v[128:131], v[232:235], v[12:15]
    v_mfma_f32_16x16x32_bf16 v[12:15], v[132:135], v[236:239], v[12:15]
    s_waitcnt lgkmcnt(2)
    v_mfma_f32_16x16x32_bf16 v[16:19], v[160:163], v[240:243], v[16:19]
    s_barrier
    ds_read_b128 v[232:235], v248 offset:10240
    v_mfma_f32_16x16x32_bf16 v[16:19], v[164:167], v[244:247], v[16:19]
    ds_read_b128 v[236:239], v248 offset:11264
    v_mfma_f32_16x16x32_bf16 v[48:51], v[168:171], v[240:243], v[48:51]
    v_mfma_f32_16x16x32_bf16 v[48:51], v[172:175], v[244:247], v[48:51]
    v_mfma_f32_16x16x32_bf16 v[80:83], v[176:179], v[240:243], v[80:83]
    v_mfma_f32_16x16x32_bf16 v[80:83], v[180:183], v[244:247], v[80:83]
    v_mfma_f32_16x16x32_bf16 v[112:115], v[184:187], v[240:243], v[112:115]
    v_mfma_f32_16x16x32_bf16 v[112:115], v[188:191], v[244:247], v[112:115]
    s_waitcnt lgkmcnt(2)
    v_mfma_f32_16x16x32_bf16 v[112:115], v[152:155], v[224:227], v[112:115]
    ds_read_b128 v[240:243], v248 offset:26624
    v_mfma_f32_16x16x32_bf16 v[112:115], v[156:159], v[228:231], v[112:115]
    ds_read_b128 v[244:247], v248 offset:27648
    v_mfma_f32_16x16x32_bf16 v[80:83], v[144:147], v[224:227], v[80:83]
    v_mfma_f32_16x16x32_bf16 v[80:83], v[148:151], v[228:231], v[80:83]
    v_mfma_f32_16x16x32_bf16 v[48:51], v[136:139], v[224:227], v[48:51]
    v_mfma_f32_16x16x32_bf16 v[48:51], v[140:143], v[228:231], v[48:51]
    v_mfma_f32_16x16x32_bf16 v[16:19], v[128:131], v[224:227], v[16:19]
    v_mfma_f32_16x16x32_bf16 v[16:19], v[132:135], v[228:231], v[16:19]
    s_waitcnt lgkmcnt(2)
    v_mfma_f32_16x16x32_bf16 v[20:23], v[160:163], v[232:235], v[20:23]
    ds_read_b128 v[224:227], v248 offset:12288
    v_mfma_f32_16x16x32_bf16 v[20:23], v[164:167], v[236:239], v[20:23]
    ds_read_b128 v[228:231], v248 offset:13312
    v_mfma_f32_16x16x32_bf16 v[52:55], v[168:171], v[232:235], v[52:55]
    v_mfma_f32_16x16x32_bf16 v[52:55], v[172:175], v[236:239], v[52:55]
    v_mfma_f32_16x16x32_bf16 v[84:87], v[176:179], v[232:235], v[84:87]
    v_mfma_f32_16x16x32_bf16 v[84:87], v[180:183], v[236:239], v[84:87]
    v_mfma_f32_16x16x32_bf16 v[116:119], v[184:187], v[232:235], v[116:119]
    v_mfma_f32_16x16x32_bf16 v[116:119], v[188:191], v[236:239], v[116:119]
    s_waitcnt lgkmcnt(2)
    v_mfma_f32_16x16x32_bf16 v[116:119], v[152:155], v[240:243], v[116:119]
    ds_read_b128 v[232:235], v248 offset:28672
    v_mfma_f32_16x16x32_bf16 v[116:119], v[156:159], v[244:247], v[116:119]
    ds_read_b128 v[236:239], v248 offset:29696
    v_mfma_f32_16x16x32_bf16 v[84:87], v[144:147], v[240:243], v[84:87]
    v_mfma_f32_16x16x32_bf16 v[84:87], v[148:151], v[244:247], v[84:87]
    v_mfma_f32_16x16x32_bf16 v[52:55], v[136:139], v[240:243], v[52:55]
    v_mfma_f32_16x16x32_bf16 v[52:55], v[140:143], v[244:247], v[52:55]
    v_mfma_f32_16x16x32_bf16 v[20:23], v[128:131], v[240:243], v[20:23]
    v_mfma_f32_16x16x32_bf16 v[20:23], v[132:135], v[244:247], v[20:23]
    s_waitcnt lgkmcnt(2)
    v_mfma_f32_16x16x32_bf16 v[24:27], v[160:163], v[224:227], v[24:27]
    s_barrier
    ds_read_b128 v[240:243], v248 offset:14336
    v_mfma_f32_16x16x32_bf16 v[24:27], v[164:167], v[228:231], v[24:27]
    ds_read_b128 v[244:247], v248 offset:15360
    v_mfma_f32_16x16x32_bf16 v[56:59], v[168:171], v[224:227], v[56:59]
    v_mfma_f32_16x16x32_bf16 v[56:59], v[172:175], v[228:231], v[56:59]
    v_mfma_f32_16x16x32_bf16 v[88:91], v[176:179], v[224:227], v[88:91]
    v_mfma_f32_16x16x32_bf16 v[88:91], v[180:183], v[228:231], v[88:91]
    v_mfma_f32_16x16x32_bf16 v[120:123], v[184:187], v[224:227], v[120:123]
    v_mfma_f32_16x16x32_bf16 v[120:123], v[188:191], v[228:231], v[120:123]
    s_waitcnt lgkmcnt(2)
    v_mfma_f32_16x16x32_bf16 v[120:123], v[152:155], v[232:235], v[120:123]
    ds_read_b128 v[224:227], v248 offset:30720
    v_mfma_f32_16x16x32_bf16 v[120:123], v[156:159], v[236:239], v[120:123]
    ds_read_b128 v[228:231], v248 offset:31744
    v_mfma_f32_16x16x32_bf16 v[88:91], v[144:147], v[232:235], v[88:91]
    v_mfma_f32_16x16x32_bf16 v[88:91], v[148:151], v[236:239], v[88:91]
    v_mfma_f32_16x16x32_bf16 v[56:59], v[136:139], v[232:235], v[56:59]
    v_mfma_f32_16x16x32_bf16 v[56:59], v[140:143], v[236:239], v[56:59]
    v_mfma_f32_16x16x32_bf16 v[24:27], v[128:131], v[232:235], v[24:27]
    v_mfma_f32_16x16x32_bf16 v[24:27], v[132:135], v[236:239], v[24:27]
    s_waitcnt lgkmcnt(2)
    v_mfma_f32_16x16x32_bf16 v[28:31], v[160:163], v[240:243], v[28:31]
    v_mfma_f32_16x16x32_bf16 v[28:31], v[164:167], v[244:247], v[28:31]
    v_mfma_f32_16x16x32_bf16 v[60:63], v[168:171], v[240:243], v[60:63]
    v_mfma_f32_16x16x32_bf16 v[60:63], v[172:175], v[244:247], v[60:63]
    v_mfma_f32_16x16x32_bf16 v[92:95], v[176:179], v[240:243], v[92:95]
    v_mfma_f32_16x16x32_bf16 v[92:95], v[180:183], v[244:247], v[92:95]
    v_mfma_f32_16x16x32_bf16 v[124:127], v[184:187], v[240:243], v[124:127]
    v_mfma_f32_16x16x32_bf16 v[124:127], v[188:191], v[244:247], v[124:127]
    s_waitcnt lgkmcnt(0)
    v_mfma_f32_16x16x32_bf16 v[124:127], v[152:155], v[224:227], v[124:127]
    v_mfma_f32_16x16x32_bf16 v[124:127], v[156:159], v[228:231], v[124:127]
    v_mfma_f32_16x16x32_bf16 v[92:95], v[144:147], v[224:227], v[92:95]
    v_mfma_f32_16x16x32_bf16 v[92:95], v[148:151], v[228:231], v[92:95]
    v_mfma_f32_16x16x32_bf16 v[60:63], v[136:139], v[224:227], v[60:63]
    v_mfma_f32_16x16x32_bf16 v[60:63], v[140:143], v[228:231], v[60:63]
    v_mfma_f32_16x16x32_bf16 v[28:31], v[128:131], v[224:227], v[28:31]
    v_mfma_f32_16x16x32_bf16 v[28:31], v[132:135], v[228:231], v[28:31]
    s_setprio 0
    s_nop 6
    v_cvt_pk_bf16_f32 v0, v0, v1
    v_cvt_pk_bf16_f32 v1, v2, v3
    v_cvt_pk_bf16_f32 v2, v32, v33
    v_cvt_pk_bf16_f32 v3, v34, v35
    v_cvt_pk_bf16_f32 v32, v64, v65
    v_cvt_pk_bf16_f32 v33, v66, v67
    v_cvt_pk_bf16_f32 v34, v96, v97
    v_cvt_pk_bf16_f32 v35, v98, v99
    v_cndmask_b32_dpp v64, v32, v0, vcc quad_perm:[1,0,3,2] row_mask:0xf bank_mask:0xf
    v_cndmask_b32_dpp v65, v33, v1, vcc quad_perm:[1,0,3,2] row_mask:0xf bank_mask:0xf
    v_cndmask_b32_dpp v66, v34, v2, vcc quad_perm:[1,0,3,2] row_mask:0xf bank_mask:0xf
    v_cndmask_b32_dpp v67, v35, v3, vcc quad_perm:[1,0,3,2] row_mask:0xf bank_mask:0xf
    s_not_b64 vcc, vcc
    v_cndmask_b32_dpp v96, v0, v32, vcc quad_perm:[1,0,3,2] row_mask:0xf bank_mask:0xf
    v_cndmask_b32_dpp v97, v1, v33, vcc quad_perm:[1,0,3,2] row_mask:0xf bank_mask:0xf
    v_cndmask_b32_dpp v98, v2, v34, vcc quad_perm:[1,0,3,2] row_mask:0xf bank_mask:0xf
    v_cndmask_b32_dpp v99, v3, v35, vcc quad_perm:[1,0,3,2] row_mask:0xf bank_mask:0xf
    v_cvt_pk_bf16_f32 v4, v4, v5
    v_cvt_pk_bf16_f32 v5, v6, v7
    v_cvt_pk_bf16_f32 v6, v36, v37
    v_cvt_pk_bf16_f32 v7, v38, v39
    v_cvt_pk_bf16_f32 v36, v68, v69
    v_cvt_pk_bf16_f32 v37, v70, v71
    v_cvt_pk_bf16_f32 v38, v100, v101
    v_cvt_pk_bf16_f32 v39, v102, v103
    v_cndmask_b32_dpp v100, v4, v36, vcc quad_perm:[1,0,3,2] row_mask:0xf bank_mask:0xf
    v_cndmask_b32_dpp v101, v5, v37, vcc quad_perm:[1,0,3,2] row_mask:0xf bank_mask:0xf
    v_cndmask_b32_dpp v102, v6, v38, vcc quad_perm:[1,0,3,2] row_mask:0xf bank_mask:0xf
    v_cndmask_b32_dpp v103, v7, v39, vcc quad_perm:[1,0,3,2] row_mask:0xf bank_mask:0xf
    s_not_b64 vcc, vcc
    v_cndmask_b32_dpp v68, v36, v4, vcc quad_perm:[1,0,3,2] row_mask:0xf bank_mask:0xf
    v_cndmask_b32_dpp v69, v37, v5, vcc quad_perm:[1,0,3,2] row_mask:0xf bank_mask:0xf
    v_cndmask_b32_dpp v70, v38, v6, vcc quad_perm:[1,0,3,2] row_mask:0xf bank_mask:0xf
    v_cndmask_b32_dpp v71, v39, v7, vcc quad_perm:[1,0,3,2] row_mask:0xf bank_mask:0xf
    s_barrier
    buffer_store_dwordx4 v[64:67], v252, s[16:19], 0 offen offset:0 nt
    buffer_store_dwordx4 v[96:99], v253, s[16:19], 0 offen offset:0 nt
    buffer_store_dwordx4 v[100:103], v253, s[16:19], 0 offen offset:1024 nt
    buffer_store_dwordx4 v[68:71], v252, s[16:19], 0 offen offset:1024 nt
    v_cvt_pk_bf16_f32 v8, v8, v9
    v_cvt_pk_bf16_f32 v9, v10, v11
    v_cvt_pk_bf16_f32 v10, v40, v41
    v_cvt_pk_bf16_f32 v11, v42, v43
    v_cvt_pk_bf16_f32 v40, v72, v73
    v_cvt_pk_bf16_f32 v41, v74, v75
    v_cvt_pk_bf16_f32 v42, v104, v105
    v_cvt_pk_bf16_f32 v43, v106, v107
    v_cndmask_b32_dpp v72, v40, v8, vcc quad_perm:[1,0,3,2] row_mask:0xf bank_mask:0xf
    v_cndmask_b32_dpp v73, v41, v9, vcc quad_perm:[1,0,3,2] row_mask:0xf bank_mask:0xf
    v_cndmask_b32_dpp v74, v42, v10, vcc quad_perm:[1,0,3,2] row_mask:0xf bank_mask:0xf
    v_cndmask_b32_dpp v75, v43, v11, vcc quad_perm:[1,0,3,2] row_mask:0xf bank_mask:0xf
    s_not_b64 vcc, vcc
    v_cndmask_b32_dpp v104, v8, v40, vcc quad_perm:[1,0,3,2] row_mask:0xf bank_mask:0xf
    v_cndmask_b32_dpp v105, v9, v41, vcc quad_perm:[1,0,3,2] row_mask:0xf bank_mask:0xf
    v_cndmask_b32_dpp v106, v10, v42, vcc quad_perm:[1,0,3,2] row_mask:0xf bank_mask:0xf
    v_cndmask_b32_dpp v107, v11, v43, vcc quad_perm:[1,0,3,2] row_mask:0xf bank_mask:0xf
    v_cvt_pk_bf16_f32 v12, v12, v13
    v_cvt_pk_bf16_f32 v13, v14, v15
    v_cvt_pk_bf16_f32 v14, v44, v45
    v_cvt_pk_bf16_f32 v15, v46, v47
    v_cvt_pk_bf16_f32 v44, v76, v77
    v_cvt_pk_bf16_f32 v45, v78, v79
    v_cvt_pk_bf16_f32 v46, v108, v109
    v_cvt_pk_bf16_f32 v47, v110, v111
    v_cndmask_b32_dpp v108, v12, v44, vcc quad_perm:[1,0,3,2] row_mask:0xf bank_mask:0xf
    v_cndmask_b32_dpp v109, v13, v45, vcc quad_perm:[1,0,3,2] row_mask:0xf bank_mask:0xf
    v_cndmask_b32_dpp v110, v14, v46, vcc quad_perm:[1,0,3,2] row_mask:0xf bank_mask:0xf
    v_cndmask_b32_dpp v111, v15, v47, vcc quad_perm:[1,0,3,2] row_mask:0xf bank_mask:0xf
    s_not_b64 vcc, vcc
    v_cndmask_b32_dpp v76, v44, v12, vcc quad_perm:[1,0,3,2] row_mask:0xf bank_mask:0xf
    v_cndmask_b32_dpp v77, v45, v13, vcc quad_perm:[1,0,3,2] row_mask:0xf bank_mask:0xf
    v_cndmask_b32_dpp v78, v46, v14, vcc quad_perm:[1,0,3,2] row_mask:0xf bank_mask:0xf
    v_cndmask_b32_dpp v79, v47, v15, vcc quad_perm:[1,0,3,2] row_mask:0xf bank_mask:0xf
    s_barrier
    buffer_store_dwordx4 v[72:75], v252, s[16:19], 0 offen offset:2048 nt
    buffer_store_dwordx4 v[104:107], v253, s[16:19], 0 offen offset:2048 nt
    buffer_store_dwordx4 v[108:111], v253, s[16:19], 0 offen offset:3072 nt
    buffer_store_dwordx4 v[76:79], v252, s[16:19], 0 offen offset:3072 nt
    v_cvt_pk_bf16_f32 v16, v16, v17
    v_cvt_pk_bf16_f32 v17, v18, v19
    v_cvt_pk_bf16_f32 v18, v48, v49
    v_cvt_pk_bf16_f32 v19, v50, v51
    v_cvt_pk_bf16_f32 v48, v80, v81
    v_cvt_pk_bf16_f32 v49, v82, v83
    v_cvt_pk_bf16_f32 v50, v112, v113
    v_cvt_pk_bf16_f32 v51, v114, v115
    v_cndmask_b32_dpp v80, v48, v16, vcc quad_perm:[1,0,3,2] row_mask:0xf bank_mask:0xf
    v_cndmask_b32_dpp v81, v49, v17, vcc quad_perm:[1,0,3,2] row_mask:0xf bank_mask:0xf
    v_cndmask_b32_dpp v82, v50, v18, vcc quad_perm:[1,0,3,2] row_mask:0xf bank_mask:0xf
    v_cndmask_b32_dpp v83, v51, v19, vcc quad_perm:[1,0,3,2] row_mask:0xf bank_mask:0xf
    s_not_b64 vcc, vcc
    v_cndmask_b32_dpp v112, v16, v48, vcc quad_perm:[1,0,3,2] row_mask:0xf bank_mask:0xf
    v_cndmask_b32_dpp v113, v17, v49, vcc quad_perm:[1,0,3,2] row_mask:0xf bank_mask:0xf
    v_cndmask_b32_dpp v114, v18, v50, vcc quad_perm:[1,0,3,2] row_mask:0xf bank_mask:0xf
    v_cndmask_b32_dpp v115, v19, v51, vcc quad_perm:[1,0,3,2] row_mask:0xf bank_mask:0xf
    v_cvt_pk_bf16_f32 v20, v20, v21
    v_cvt_pk_bf16_f32 v21, v22, v23
    v_cvt_pk_bf16_f32 v22, v52, v53
    v_cvt_pk_bf16_f32 v23, v54, v55
    v_cvt_pk_bf16_f32 v52, v84, v85
    v_cvt_pk_bf16_f32 v53, v86, v87
    v_cvt_pk_bf16_f32 v54, v116, v117
    v_cvt_pk_bf16_f32 v55, v118, v119
    v_cndmask_b32_dpp v116, v20, v52, vcc quad_perm:[1,0,3,2] row_mask:0xf bank_mask:0xf
    v_cndmask_b32_dpp v117, v21, v53, vcc quad_perm:[1,0,3,2] row_mask:0xf bank_mask:0xf
    v_cndmask_b32_dpp v118, v22, v54, vcc quad_perm:[1,0,3,2] row_mask:0xf bank_mask:0xf
    v_cndmask_b32_dpp v119, v23, v55, vcc quad_perm:[1,0,3,2] row_mask:0xf bank_mask:0xf
    s_not_b64 vcc, vcc
    v_cndmask_b32_dpp v84, v52, v20, vcc quad_perm:[1,0,3,2] row_mask:0xf bank_mask:0xf
    v_cndmask_b32_dpp v85, v53, v21, vcc quad_perm:[1,0,3,2] row_mask:0xf bank_mask:0xf
    v_cndmask_b32_dpp v86, v54, v22, vcc quad_perm:[1,0,3,2] row_mask:0xf bank_mask:0xf
    v_cndmask_b32_dpp v87, v55, v23, vcc quad_perm:[1,0,3,2] row_mask:0xf bank_mask:0xf
    s_barrier
    buffer_store_dwordx4 v[80:83], v252, s[16:19], s49 offen offset:0 nt
    buffer_store_dwordx4 v[112:115], v253, s[16:19], s49 offen offset:0 nt
    buffer_store_dwordx4 v[116:119], v253, s[16:19], s49 offen offset:1024 nt
    buffer_store_dwordx4 v[84:87], v252, s[16:19], s49 offen offset:1024 nt
    v_cvt_pk_bf16_f32 v24, v24, v25
    v_cvt_pk_bf16_f32 v25, v26, v27
    v_cvt_pk_bf16_f32 v26, v56, v57
    v_cvt_pk_bf16_f32 v27, v58, v59
    v_cvt_pk_bf16_f32 v56, v88, v89
    v_cvt_pk_bf16_f32 v57, v90, v91
    v_cvt_pk_bf16_f32 v58, v120, v121
    v_cvt_pk_bf16_f32 v59, v122, v123
    v_cndmask_b32_dpp v88, v56, v24, vcc quad_perm:[1,0,3,2] row_mask:0xf bank_mask:0xf
    v_cndmask_b32_dpp v89, v57, v25, vcc quad_perm:[1,0,3,2] row_mask:0xf bank_mask:0xf
    v_cndmask_b32_dpp v90, v58, v26, vcc quad_perm:[1,0,3,2] row_mask:0xf bank_mask:0xf
    v_cndmask_b32_dpp v91, v59, v27, vcc quad_perm:[1,0,3,2] row_mask:0xf bank_mask:0xf
    s_not_b64 vcc, vcc
    v_cndmask_b32_dpp v120, v24, v56, vcc quad_perm:[1,0,3,2] row_mask:0xf bank_mask:0xf
    v_cndmask_b32_dpp v121, v25, v57, vcc quad_perm:[1,0,3,2] row_mask:0xf bank_mask:0xf
    v_cndmask_b32_dpp v122, v26, v58, vcc quad_perm:[1,0,3,2] row_mask:0xf bank_mask:0xf
    v_cndmask_b32_dpp v123, v27, v59, vcc quad_perm:[1,0,3,2] row_mask:0xf bank_mask:0xf
    v_cvt_pk_bf16_f32 v28, v28, v29
    v_cvt_pk_bf16_f32 v29, v30, v31
    v_cvt_pk_bf16_f32 v30, v60, v61
    v_cvt_pk_bf16_f32 v31, v62, v63
    v_cvt_pk_bf16_f32 v60, v92, v93
    v_cvt_pk_bf16_f32 v61, v94, v95
    v_cvt_pk_bf16_f32 v62, v124, v125
    v_cvt_pk_bf16_f32 v63, v126, v127
    v_cndmask_b32_dpp v124, v28, v60, vcc quad_perm:[1,0,3,2] row_mask:0xf bank_mask:0xf
    v_cndmask_b32_dpp v125, v29, v61, vcc quad_perm:[1,0,3,2] row_mask:0xf bank_mask:0xf
    v_cndmask_b32_dpp v126, v30, v62, vcc quad_perm:[1,0,3,2] row_mask:0xf bank_mask:0xf
    v_cndmask_b32_dpp v127, v31, v63, vcc quad_perm:[1,0,3,2] row_mask:0xf bank_mask:0xf
    s_not_b64 vcc, vcc
    v_cndmask_b32_dpp v92, v60, v28, vcc quad_perm:[1,0,3,2] row_mask:0xf bank_mask:0xf
    v_cndmask_b32_dpp v93, v61, v29, vcc quad_perm:[1,0,3,2] row_mask:0xf bank_mask:0xf
    v_cndmask_b32_dpp v94, v62, v30, vcc quad_perm:[1,0,3,2] row_mask:0xf bank_mask:0xf
    v_cndmask_b32_dpp v95, v63, v31, vcc quad_perm:[1,0,3,2] row_mask:0xf bank_mask:0xf
    s_barrier
    buffer_store_dwordx4 v[88:91], v252, s[16:19], s49 offen offset:2048 nt
    buffer_store_dwordx4 v[120:123], v253, s[16:19], s49 offen offset:2048 nt
    buffer_store_dwordx4 v[124:127], v253, s[16:19], s49 offen offset:3072 nt
    buffer_store_dwordx4 v[92:95], v252, s[16:19], s49 offen offset:3072 nt
    s_branch L_fin
L_roleB:
    s_barrier
    s_movk_i32 s46, 256
    s_add_u32 m0, s49, 32768
    s_nop 0
    buffer_load_dwordx4 v16, s[4:7], s46 offen nt lds
    s_add_u32 m0, s49, 33792
    s_nop 0
    buffer_load_dwordx4 v17, s[4:7], s46 offen nt lds
    s_add_u32 m0, s49, 34816
    s_nop 0
    buffer_load_dwordx4 v18, s[4:7], s46 offen nt lds
    s_add_u32 m0, s49, 35840
    s_nop 0
    buffer_load_dwordx4 v19, s[4:7], s46 offen nt lds
    s_and_b32 s57, s54, 0xfc
    s_lshl_b32 s47, s53, 10
    v_lshlrev_b32 v21, 4, v0
    v_mov_b32 v52, -1
    v_mov_b32 v53, -1
    v_mov_b32 v54, -1
    v_mov_b32 v55, -1
    buffer_store_dwordx4 v[52:55], v21, s[24:27], s47 offen sc0 sc1
    s_waitcnt vmcnt(5)
    s_barrier
    ds_read_b64_tr_b16 v[28:29], v26 offset:0
    ds_read_b64_tr_b16 v[30:31], v26 offset:2048
    ds_read_b64_tr_b16 v[32:33], v26 offset:4096
    ds_read_b64_tr_b16 v[34:35], v26 offset:6144
    ds_read_b64_tr_b16 v[36:37], v27 offset:8192
    ds_read_b64_tr_b16 v[38:39], v27 offset:10240
    v_lshl_or_b32 v48, v49, 16, v48
    s_waitcnt lgkmcnt(0)
    buffer_store_dword v48, v41, s[12:15], 0 offen sc0 sc1
    buffer_store_dwordx4 v[28:31], v45, s[12:15], s42 offen sc0 sc1
    buffer_store_dwordx4 v[32:35], v46, s[12:15], s42 offen sc0 sc1
    buffer_store_dwordx4 v[36:39], v47, s[12:15], s97 offen sc0 sc1
    s_barrier
    s_movk_i32 s46, 384
    s_add_u32 m0, s49, 49152
    s_nop 0
    buffer_load_dwordx4 v16, s[4:7], s46 offen nt lds
    s_add_u32 m0, s49, 50176
    s_nop 0
    buffer_load_dwordx4 v17, s[4:7], s46 offen nt lds
    s_add_u32 m0, s49, 51200
    s_nop 0
    buffer_load_dwordx4 v18, s[4:7], s46 offen nt lds
    s_add_u32 m0, s49, 52224
    s_nop 0
    buffer_load_dwordx4 v19, s[4:7], s46 offen nt lds
    s_waitcnt vmcnt(9)
    s_waitcnt vmcnt(4)
    s_barrier
L_ann:
    s_cmp_lg_u32 s53, 0
    s_cbranch_scc1 L_noann
    s_and_b32 s47, s54, 3
    s_lshl_b32 s47, 1, s47
    s_atomic_or s47, s[28:29], s57
L_noann:
    s_barrier
    s_movk_i32 s46, 512
    s_add_u32 m0, s49, 65536
    s_nop 0
    buffer_load_dwordx4 v16, s[4:7], s46 offen nt lds
    s_add_u32 m0, s49, 66560
    s_nop 0
    buffer_load_dwordx4 v17, s[4:7], s46 offen nt lds
    s_add_u32 m0, s49, 67584
    s_nop 0
    buffer_load_dwordx4 v18, s[4:7], s46 offen nt lds
    s_add_u32 m0, s49, 68608
    s_nop 0
    buffer_load_dwordx4 v19, s[4:7], s46 offen nt lds
    s_waitcnt vmcnt(4)
    s_barrier
    s_barrier
    s_movk_i32 s46, 640
    s_add_u32 m0, s49, 81920
    s_nop 0
    buffer_load_dwordx4 v16, s[4:7], s46 offen nt lds
    s_add_u32 m0, s49, 82944
    s_nop 0
    buffer_load_dwordx4 v17, s[4:7], s46 offen nt lds
    s_add_u32 m0, s49, 83968
    s_nop 0
    buffer_load_dwordx4 v18, s[4:7], s46 offen nt lds
    s_add_u32 m0, s49, 84992
    s_nop 0
    buffer_load_dwordx4 v19, s[4:7], s46 offen nt lds
    s_waitcnt vmcnt(4)
    s_barrier
    s_barrier
    s_movk_i32 s46, 768
    s_add_u32 m0, s49, 98304
    s_nop 0
    buffer_load_dwordx4 v16, s[4:7], s46 offen nt lds
    s_add_u32 m0, s49, 99328
    s_nop 0
    buffer_load_dwordx4 v17, s[4:7], s46 offen nt lds
    s_add_u32 m0, s49, 100352
    s_nop 0
    buffer_load_dwordx4 v18, s[4:7], s46 offen nt lds
    s_add_u32 m0, s49, 101376
    s_nop 0
    buffer_load_dwordx4 v19, s[4:7], s46 offen nt lds
    s_waitcnt vmcnt(4)
    s_barrier
    s_barrier
    v_mov_b32 v24, 15
    v_and_b32 v23, 15, v0
    v_add_u32 v23, 1, v23
    v_lshrrev_b32 v23, 4, v23
    v_lshrrev_b32 v23, v23, v24
    s_lshl_b32 s48, s53, 20
    v_lshl_add_u32 v21, v0, 2, s48
    buffer_load_dword v22, v21, s[28:31], 0 offen sc0 sc1
    s_movk_i32 s46, 896
    s_add_u32 m0, s49, 114688
    s_nop 0
    buffer_load_dwordx4 v16, s[4:7], s46 offen nt lds
    s_add_u32 m0, s49, 115712
    s_nop 0
    buffer_load_dwordx4 v17, s[4:7], s46 offen nt lds
    s_add_u32 m0, s49, 116736
    s_nop 0
    buffer_load_dwordx4 v18, s[4:7], s46 offen nt lds
    s_add_u32 m0, s49, 117760
    s_nop 0
    buffer_load_dwordx4 v19, s[4:7], s46 offen nt lds
    s_waitcnt vmcnt(5)
    s_barrier
    s_mov_b32 s48, 4000000
    s_waitcnt vmcnt(4)
    s_cmp_lg_u32 s53, 0
    s_cbranch_scc1 L_rdy_ok
L_rdy:
    v_cmp_lt_u32 vcc, v22, v23
    s_sub_u32 s48, s48, 1
    s_cbranch_scc1 L_rdy_ok
    s_cbranch_vccz L_rdy_ok
    buffer_load_dword v22, v21, s[28:31], 0 offen sc0 sc1
    s_waitcnt vmcnt(0)
    s_branch L_rdy
L_rdy_ok:
    s_waitcnt vmcnt(0)
    s_barrier
    s_mov_b32 s46, 0
    s_mov_b32 s47, 4096
    buffer_load_dwordx4 v[160:163], v250, s[60:63], s46 offen offset:0 sc1
    buffer_load_dwordx4 v[164:167], v250, s[60:63], s46 offen offset:1024 sc1
    buffer_load_dwordx4 v[168:171], v250, s[60:63], s46 offen offset:2048 sc1
    buffer_load_dwordx4 v[172:175], v250, s[60:63], s46 offen offset:3072 sc1
    buffer_load_dwordx4 v[176:179], v250, s[60:63], s47 offen offset:0 sc1
    buffer_load_dwordx4 v[180:183], v250, s[60:63], s47 offen offset:1024 sc1
    buffer_load_dwordx4 v[184:187], v250, s[60:63], s47 offen offset:2048 sc1
    buffer_load_dwordx4 v[188:191], v250, s[60:63], s47 offen offset:3072 sc1
    s_mov_b32 s46, 8192
    s_mov_b32 s47, 12288
    s_waitcnt lgkmcnt(0)
    ds_read_b128 v[224:227], v248 offset:0
    ds_read_b128 v[228:231], v249 offset:0
    ds_read_b128 v[232:235], v248 offset:2048
    ds_read_b128 v[236:239], v249 offset:2048
    s_barrier
    s_setprio 1
    s_waitcnt vmcnt(7) lgkmcnt(3)
    v_mfma_f32_16x16x32_bf16 v[0:3], v[160:163], v[224:227], 0
    ds_read_b128 v[240:243], v248 offset:4096
    s_waitcnt vmcnt(6) lgkmcnt(3)
    v_mfma_f32_16x16x32_bf16 v[0:3], v[164:167], v[228:231], v[0:3]
    ds_read_b128 v[244:247], v249 offset:4096
    s_waitcnt vmcnt(5)
    v_mfma_f32_16x16x32_bf16 v[32:35], v[168:171], v[224:227], 0
    buffer_load_dwordx4 v[192:195], v250, s[60:63], s46 offen offset:0 sc1
    s_waitcnt vmcnt(5)
    v_mfma_f32_16x16x32_bf16 v[32:35], v[172:175], v[228:231], v[32:35]
    s_waitcnt vmcnt(1)
    v_mfma_f32_16x16x32_bf16 v[64:67], v[176:179], v[224:227], 0
    v_mfma_f32_16x16x32_bf16 v[64:67], v[180:183], v[228:231], v[64:67]
    buffer_load_dwordx4 v[196:199], v250, s[60:63], s46 offen offset:1024 sc1
    v_mfma_f32_16x16x32_bf16 v[96:99], v[184:187], v[224:227], 0
    v_mfma_f32_16x16x32_bf16 v[96:99], v[188:191], v[228:231], v[96:99]
    s_waitcnt lgkmcnt(2)
    v_mfma_f32_16x16x32_bf16 v[100:103], v[184:187], v[232:235], 0
    ds_read_b128 v[224:227], v248 offset:6144
    v_mfma_f32_16x16x32_bf16 v[100:103], v[188:191], v[236:239], v[100:103]
    ds_read_b128 v[228:231], v249 offset:6144
    v_mfma_f32_16x16x32_bf16 v[68:71], v[176:179], v[232:235], 0
    buffer_load_dwordx4 v[200:203], v250, s[60:63], s46 offen offset:2048 sc1
    v_mfma_f32_16x16x32_bf16 v[68:71], v[180:183], v[236:239], v[68:71]
    v_mfma_f32_16x16x32_bf16 v[36:39], v[168:171], v[232:235], 0
    v_mfma_f32_16x16x32_bf16 v[36:39], v[172:175], v[236:239], v[36:39]
    buffer_load_dwordx4 v[204:207], v250, s[60:63], s46 offen offset:3072 sc1
    v_mfma_f32_16x16x32_bf16 v[4:7], v[160:163], v[232:235], 0
    v_mfma_f32_16x16x32_bf16 v[4:7], v[164:167], v[236:239], v[4:7]
    s_waitcnt lgkmcnt(2)
    v_mfma_f32_16x16x32_bf16 v[8:11], v[160:163], v[240:243], 0
    ds_read_b128 v[232:235], v248 offset:8192
    v_mfma_f32_16x16x32_bf16 v[8:11], v[164:167], v[244:247], v[8:11]
    ds_read_b128 v[236:239], v249 offset:8192
    v_mfma_f32_16x16x32_bf16 v[40:43], v[168:171], v[240:243], 0
    buffer_load_dwordx4 v[208:211], v250, s[60:63], s47 offen offset:0 sc1
    v_mfma_f32_16x16x32_bf16 v[40:43], v[172:175], v[244:247], v[40:43]
    v_mfma_f32_16x16x32_bf16 v[72:75], v[176:179], v[240:243], 0
    v_mfma_f32_16x16x32_bf16 v[72:75], v[180:183], v[244:247], v[72:75]
    buffer_load_dwordx4 v[212:215], v250, s[60:63], s47 offen offset:1024 sc1
    v_mfma_f32_16x16x32_bf16 v[104:107], v[184:187], v[240:243], 0
    v_mfma_f32_16x16x32_bf16 v[104:107], v[188:191], v[244:247], v[104:107]
    s_waitcnt lgkmcnt(2)
    v_mfma_f32_16x16x32_bf16 v[108:111], v[184:187], v[224:227], 0
    ds_read_b128 v[240:243], v248 offset:10240
    v_mfma_f32_16x16x32_bf16 v[108:111], v[188:191], v[228:231], v[108:111]
    ds_read_b128 v[244:247], v249 offset:10240
    v_mfma_f32_16x16x32_bf16 v[76:79], v[176:179], v[224:227], 0
    buffer_load_dwordx4 v[216:219], v250, s[60:63], s47 offen offset:2048 sc1
    v_mfma_f32_16x16x32_bf16 v[76:79], v[180:183], v[228:231], v[76:79]
    v_mfma_f32_16x16x32_bf16 v[44:47], v[168:171], v[224:227], 0
    v_mfma_f32_16x16x32_bf16 v[44:47], v[172:175], v[228:231], v[44:47]
    buffer_load_dwordx4 v[220:223], v250, s[60:63], s47 offen offset:3072 sc1
    v_mfma_f32_16x16x32_bf16 v[12:15], v[160:163], v[224:227], 0
    v_mfma_f32_16x16x32_bf16 v[12:15], v[164:167], v[228:231], v[12:15]
    s_waitcnt lgkmcnt(2)
    v_mfma_f32_16x16x32_bf16 v[16:19], v[160:163], v[232:235], 0
    ds_read_b128 v[224:227], v248 offset:12288
    v_mfma_f32_16x16x32_bf16 v[16:19], v[164:167], v[236:239], v[16:19]
    ds_read_b128 v[228:231], v249 offset:12288
    v_mfma_f32_16x16x32_bf16 v[48:51], v[168:171], v[232:235], 0
    v_mfma_f32_16x16x32_bf16 v[48:51], v[172:175], v[236:239], v[48:51]
    v_mfma_f32_16x16x32_bf16 v[80:83], v[176:179], v[232:235], 0
    v_mfma_f32_16x16x32_bf16 v[80:83], v[180:183], v[236:239], v[80:83]
    v_mfma_f32_16x16x32_bf16 v[112:115], v[184:187], v[232:235], 0
    v_mfma_f32_16x16x32_bf16 v[112:115], v[188:191], v[236:239], v[112:115]
    s_waitcnt lgkmcnt(2)
    v_mfma_f32_16x16x32_bf16 v[116:119], v[184:187], v[240:243], 0
    ds_read_b128 v[232:235], v248 offset:14336
    v_mfma_f32_16x16x32_bf16 v[116:119], v[188:191], v[244:247], v[116:119]
    ds_read_b128 v[236:239], v249 offset:14336
    v_mfma_f32_16x16x32_bf16 v[84:87], v[176:179], v[240:243], 0
    v_mfma_f32_16x16x32_bf16 v[84:87], v[180:183], v[244:247], v[84:87]
    v_mfma_f32_16x16x32_bf16 v[52:55], v[168:171], v[240:243], 0
    v_mfma_f32_16x16x32_bf16 v[52:55], v[172:175], v[244:247], v[52:55]
    v_mfma_f32_16x16x32_bf16 v[20:23], v[160:163], v[240:243], 0
    v_mfma_f32_16x16x32_bf16 v[20:23], v[164:167], v[244:247], v[20:23]
    s_waitcnt lgkmcnt(2)
    v_mfma_f32_16x16x32_bf16 v[24:27], v[160:163], v[224:227], 0
    ds_read_b128 v[240:243], v248 offset:16384
    v_mfma_f32_16x16x32_bf16 v[24:27], v[164:167], v[228:231], v[24:27]
    ds_read_b128 v[244:247], v249 offset:16384
    v_mfma_f32_16x16x32_bf16 v[56:59], v[168:171], v[224:227], 0
    v_mfma_f32_16x16x32_bf16 v[56:59], v[172:175], v[228:231], v[56:59]
    v_mfma_f32_16x16x32_bf16 v[88:91], v[176:179], v[224:227], 0
    v_mfma_f32_16x16x32_bf16 v[88:91], v[180:183], v[228:231], v[88:91]
    v_mfma_f32_16x16x32_bf16 v[120:123], v[184:187], v[224:227], 0
    v_mfma_f32_16x16x32_bf16 v[120:123], v[188:191], v[228:231], v[120:123]
    s_waitcnt lgkmcnt(2)
    v_mfma_f32_16x16x32_bf16 v[124:127], v[184:187], v[232:235], 0
    ds_read_b128 v[224:227], v248 offset:18432
    v_mfma_f32_16x16x32_bf16 v[124:127], v[188:191], v[236:239], v[124:127]
    ds_read_b128 v[228:231], v249 offset:18432
    v_mfma_f32_16x16x32_bf16 v[92:95], v[176:179], v[232:235], 0
    v_mfma_f32_16x16x32_bf16 v[92:95], v[180:183], v[236:239], v[92:95]
    s_mov_b32 s46, 16384
    v_mfma_f32_16x16x32_bf16 v[60:63], v[168:171], v[232:235], 0
    s_mov_b32 s47, 20480
    v_mfma_f32_16x16x32_bf16 v[60:63], v[172:175], v[236:239], v[60:63]
    v_mfma_f32_16x16x32_bf16 v[28:31], v[160:163], v[232:235], 0
    v_mfma_f32_16x16x32_bf16 v[28:31], v[164:167], v[236:239], v[28:31]
    s_waitcnt vmcnt(4) lgkmcnt(2)
    v_mfma_f32_16x16x32_bf16 v[0:3], v[192:195], v[240:243], v[0:3]
    ds_read_b128 v[232:235], v248 offset:20480
    v_mfma_f32_16x16x32_bf16 v[0:3], v[196:199], v[244:247], v[0:3]
    ds_read_b128 v[236:239], v249 offset:20480
    v_mfma_f32_16x16x32_bf16 v[32:35], v[200:203], v[240:243], v[32:35]
    buffer_load_dwordx4 v[160:163], v250, s[60:63], s46 offen offset:0 sc1
    v_mfma_f32_16x16x32_bf16 v[32:35], v[204:207], v[244:247], v[32:35]
    s_waitcnt vmcnt(1)
    v_mfma_f32_16x16x32_bf16 v[64:67], v[208:211], v[240:243], v[64:67]
    v_mfma_f32_16x16x32_bf16 v[64:67], v[212:215], v[244:247], v[64:67]
    buffer_load_dwordx4 v[164:167], v250, s[60:63], s46 offen offset:1024 sc1
    v_mfma_f32_16x16x32_bf16 v[96:99], v[216:219], v[240:243], v[96:99]
    v_mfma_f32_16x16x32_bf16 v[96:99], v[220:223], v[244:247], v[96:99]
    s_waitcnt lgkmcnt(2)
    v_mfma_f32_16x16x32_bf16 v[100:103], v[216:219], v[224:227], v[100:103]
    ds_read_b128 v[240:243], v248 offset:22528
    v_mfma_f32_16x16x32_bf16 v[100:103], v[220:223], v[228:231], v[100:103]
    ds_read_b128 v[244:247], v249 offset:22528
    v_mfma_f32_16x16x32_bf16 v[68:71], v[208:211], v[224:227], v[68:71]
    buffer_load_dwordx4 v[168:171], v250, s[60:63], s46 offen offset:2048 sc1
    v_mfma_f32_16x16x32_bf16 v[68:71], v[212:215], v[228:231], v[68:71]
    v_mfma_f32_16x16x32_bf16 v[36:39], v[200:203], v[224:227], v[36:39]
    v_mfma_f32_16x16x32_bf16 v[36:39], v[204:207], v[228:231], v[36:39]
    buffer_load_dwordx4 v[172:175], v250, s[60:63], s46 offen offset:3072 sc1
    v_mfma_f32_16x16x32_bf16 v[4:7], v[192:195], v[224:227], v[4:7]
    v_mfma_f32_16x16x32_bf16 v[4:7], v[196:199], v[228:231], v[4:7]
    s_waitcnt lgkmcnt(2)
    v_mfma_f32_16x16x32_bf16 v[8:11], v[192:195], v[232:235], v[8:11]
    ds_read_b128 v[224:227], v248 offset:24576
    v_mfma_f32_16x16x32_bf16 v[8:11], v[196:199], v[236:239], v[8:11]
    ds_read_b128 v[228:231], v249 offset:24576
    v_mfma_f32_16x16x32_bf16 v[40:43], v[200:203], v[232:235], v[40:43]
    buffer_load_dwordx4 v[176:179], v250, s[60:63], s47 offen offset:0 sc1
    v_mfma_f32_16x16x32_bf16 v[40:43], v[204:207], v[236:239], v[40:43]
    v_mfma_f32_16x16x32_bf16 v[72:75], v[208:211], v[232:235], v[72:75]
    v_mfma_f32_16x16x32_bf16 v[72:75], v[212:215], v[236:239], v[72:75]
    buffer_load_dwordx4 v[180:183], v250, s[60:63], s47 offen offset:1024 sc1
    v_mfma_f32_16x16x32_bf16 v[104:107], v[216:219], v[232:235], v[104:107]
    v_mfma_f32_16x16x32_bf16 v[104:107], v[220:223], v[236:239], v[104:107]
    s_waitcnt lgkmcnt(2)
    v_mfma_f32_16x16x32_bf16 v[108:111], v[216:219], v[240:243], v[108:111]
    ds_read_b128 v[232:235], v248 offset:26624
    v_mfma_f32_16x16x32_bf16 v[108:111], v[220:223], v[244:247], v[108:111]
    ds_read_b128 v[236:239], v249 offset:26624
    v_mfma_f32_16x16x32_bf16 v[76:79], v[208:211], v[240:243], v[76:79]
    buffer_load_dwordx4 v[184:187], v250, s[60:63], s47 offen offset:2048 sc1
    v_mfma_f32_16x16x32_bf16 v[76:79], v[212:215], v[244:247], v[76:79]
    v_mfma_f32_16x16x32_bf16 v[44:47], v[200:203], v[240:243], v[44:47]
    v_mfma_f32_16x16x32_bf16 v[44:47], v[204:207], v[244:247], v[44:47]
    buffer_load_dwordx4 v[188:191], v250, s[60:63], s47 offen offset:3072 sc1
    v_mfma_f32_16x16x32_bf16 v[12:15], v[192:195], v[240:243], v[12:15]
    v_mfma_f32_16x16x32_bf16 v[12:15], v[196:199], v[244:247], v[12:15]
    s_waitcnt lgkmcnt(2)
    v_mfma_f32_16x16x32_bf16 v[16:19], v[192:195], v[224:227], v[16:19]
    ds_read_b128 v[240:243], v248 offset:28672
    v_mfma_f32_16x16x32_bf16 v[16:19], v[196:199], v[228:231], v[16:19]
    ds_read_b128 v[244:247], v249 offset:28672
    v_mfma_f32_16x16x32_bf16 v[48:51], v[200:203], v[224:227], v[48:51]
    v_mfma_f32_16x16x32_bf16 v[48:51], v[204:207], v[228:231], v[48:51]
    v_mfma_f32_16x16x32_bf16 v[80:83], v[208:211], v[224:227], v[80:83]
    v_mfma_f32_16x16x32_bf16 v[80:83], v[212:215], v[228:231], v[80:83]
    v_mfma_f32_16x16x32_bf16 v[112:115], v[216:219], v[224:227], v[112:115]
    v_mfma_f32_16x16x32_bf16 v[112:115], v[220:223], v[228:231], v[112:115]
    s_waitcnt lgkmcnt(2)
    v_mfma_f32_16x16x32_bf16 v[116:119], v[216:219], v[232:235], v[116:119]
    ds_read_b128 v[224:227], v248 offset:30720
    v_mfma_f32_16x16x32_bf16 v[116:119], v[220:223], v[236:239], v[116:119]
    ds_read_b128 v[228:231], v249 offset:30720
    v_mfma_f32_16x16x32_bf16 v[84:87], v[208:211], v[232:235], v[84:87]
    v_mfma_f32_16x16x32_bf16 v[84:87], v[212:215], v[236:239], v[84:87]
    v_mfma_f32_16x16x32_bf16 v[52:55], v[200:203], v[232:235], v[52:55]
    v_mfma_f32_16x16x32_bf16 v[52:55], v[204:207], v[236:239], v[52:55]
    v_mfma_f32_16x16x32_bf16 v[20:23], v[192:195], v[232:235], v[20:23]
    v_mfma_f32_16x16x32_bf16 v[20:23], v[196:199], v[236:239], v[20:23]
    s_waitcnt lgkmcnt(2)
    v_mfma_f32_16x16x32_bf16 v[24:27], v[192:195], v[240:243], v[24:27]
    ds_read_b128 v[232:235], v248 offset:32768
    v_mfma_f32_16x16x32_bf16 v[24:27], v[196:199], v[244:247], v[24:27]
    ds_read_b128 v[236:239], v249 offset:32768
    v_mfma_f32_16x16x32_bf16 v[56:59], v[200:203], v[240:243], v[56:59]
    v_mfma_f32_16x16x32_bf16 v[56:59], v[204:207], v[244:247], v[56:59]
    v_mfma_f32_16x16x32_bf16 v[88:91], v[208:211], v[240:243], v[88:91]
    v_mfma_f32_16x16x32_bf16 v[88:91], v[212:215], v[244:247], v[88:91]
    v_mfma_f32_16x16x32_bf16 v[120:123], v[216:219], v[240:243], v[120:123]
    v_mfma_f32_16x16x32_bf16 v[120:123], v[220:223], v[244:247], v[120:123]
    s_waitcnt lgkmcnt(2)
    v_mfma_f32_16x16x32_bf16 v[124:127], v[216:219], v[224:227], v[124:127]
    ds_read_b128 v[240:243], v248 offset:34816
    v_mfma_f32_16x16x32_bf16 v[124:127], v[220:223], v[228:231], v[124:127]
    ds_read_b128 v[244:247], v249 offset:34816
    v_mfma_f32_16x16x32_bf16 v[92:95], v[208:211], v[224:227], v[92:95]
    v_mfma_f32_16x16x32_bf16 v[92:95], v[212:215], v[228:231], v[92:95]
    s_mov_b32 s46, 24576
    v_mfma_f32_16x16x32_bf16 v[60:63], v[200:203], v[224:227], v[60:63]
    s_mov_b32 s47, 28672
    v_mfma_f32_16x16x32_bf16 v[60:63], v[204:207], v[228:231], v[60:63]
    v_mfma_f32_16x16x32_bf16 v[28:31], v[192:195], v[224:227], v[28:31]
    v_mfma_f32_16x16x32_bf16 v[28:31], v[196:199], v[228:231], v[28:31]
    s_waitcnt vmcnt(4) lgkmcnt(2)
    v_mfma_f32_16x16x32_bf16 v[0:3], v[160:163], v[232:235], v[0:3]
    ds_read_b128 v[224:227], v248 offset:36864
    v_mfma_f32_16x16x32_bf16 v[0:3], v[164:167], v[236:239], v[0:3]
    ds_read_b128 v[228:231], v249 offset:36864
    v_mfma_f32_16x16x32_bf16 v[32:35], v[168:171], v[232:235], v[32:35]
    buffer_load_dwordx4 v[192:195], v250, s[60:63], s46 offen offset:0 sc1
    v_mfma_f32_16x16x32_bf16 v[32:35], v[172:175], v[236:239], v[32:35]
    s_waitcnt vmcnt(1)
    v_mfma_f32_16x16x32_bf16 v[64:67], v[176:179], v[232:235], v[64:67]
    v_mfma_f32_16x16x32_bf16 v[64:67], v[180:183], v[236:239], v[64:67]
    buffer_load_dwordx4 v[196:199], v250, s[60:63], s46 offen offset:1024 sc1
    v_mfma_f32_16x16x32_bf16 v[96:99], v[184:187], v[232:235], v[96:99]
    v_mfma_f32_16x16x32_bf16 v[96:99], v[188:191], v[236:239], v[96:99]
    s_waitcnt lgkmcnt(2)
    v_mfma_f32_16x16x32_bf16 v[100:103], v[184:187], v[240:243], v[100:103]
    ds_read_b128 v[232:235], v248 offset:38912
    v_mfma_f32_16x16x32_bf16 v[100:103], v[188:191], v[244:247], v[100:103]
    ds_read_b128 v[236:239], v249 offset:38912
    v_mfma_f32_16x16x32_bf16 v[68:71], v[176:179], v[240:243], v[68:71]
    buffer_load_dwordx4 v[200:203], v250, s[60:63], s46 offen offset:2048 sc1
    v_mfma_f32_16x16x32_bf16 v[68:71], v[180:183], v[244:247], v[68:71]
    v_mfma_f32_16x16x32_bf16 v[36:39], v[168:171], v[240:243], v[36:39]
    v_mfma_f32_16x16x32_bf16 v[36:39], v[172:175], v[244:247], v[36:39]
    buffer_load_dwordx4 v[204:207], v250, s[60:63], s46 offen offset:3072 sc1
    v_mfma_f32_16x16x32_bf16 v[4:7], v[160:163], v[240:243], v[4:7]
    v_mfma_f32_16x16x32_bf16 v[4:7], v[164:167], v[244:247], v[4:7]
    s_waitcnt lgkmcnt(2)
    v_mfma_f32_16x16x32_bf16 v[8:11], v[160:163], v[224:227], v[8:11]
    ds_read_b128 v[240:243], v248 offset:40960
    v_mfma_f32_16x16x32_bf16 v[8:11], v[164:167], v[228:231], v[8:11]
    ds_read_b128 v[244:247], v249 offset:40960
    v_mfma_f32_16x16x32_bf16 v[40:43], v[168:171], v[224:227], v[40:43]
    buffer_load_dwordx4 v[208:211], v250, s[60:63], s47 offen offset:0 sc1
    v_mfma_f32_16x16x32_bf16 v[40:43], v[172:175], v[228:231], v[40:43]
    v_mfma_f32_16x16x32_bf16 v[72:75], v[176:179], v[224:227], v[72:75]
    v_mfma_f32_16x16x32_bf16 v[72:75], v[180:183], v[228:231], v[72:75]
    buffer_load_dwordx4 v[212:215], v250, s[60:63], s47 offen offset:1024 sc1
    v_mfma_f32_16x16x32_bf16 v[104:107], v[184:187], v[224:227], v[104:107]
    v_mfma_f32_16x16x32_bf16 v[104:107], v[188:191], v[228:231], v[104:107]
    s_waitcnt lgkmcnt(2)
    v_mfma_f32_16x16x32_bf16 v[108:111], v[184:187], v[232:235], v[108:111]
    ds_read_b128 v[224:227], v248 offset:43008
    v_mfma_f32_16x16x32_bf16 v[108:111], v[188:191], v[236:239], v[108:111]
    ds_read_b128 v[228:231], v249 offset:43008
    v_mfma_f32_16x16x32_bf16 v[76:79], v[176:179], v[232:235], v[76:79]
    buffer_load_dwordx4 v[216:219], v250, s[60:63], s47 offen offset:2048 sc1
    v_mfma_f32_16x16x32_bf16 v[76:79], v[180:183], v[236:239], v[76:79]
    v_mfma_f32_16x16x32_bf16 v[44:47], v[168:171], v[232:235], v[44:47]
    v_mfma_f32_16x16x32_bf16 v[44:47], v[172:175], v[236:239], v[44:47]
    buffer_load_dwordx4 v[220:223], v250, s[60:63], s47 offen offset:3072 sc1
    v_mfma_f32_16x16x32_bf16 v[12:15], v[160:163], v[232:235], v[12:15]
    v_mfma_f32_16x16x32_bf16 v[12:15], v[164:167], v[236:239], v[12:15]
    s_waitcnt lgkmcnt(2)
    v_mfma_f32_16x16x32_bf16 v[16:19], v[160:163], v[240:243], v[16:19]
    ds_read_b128 v[232:235], v248 offset:45056
    v_mfma_f32_16x16x32_bf16 v[16:19], v[164:167], v[244:247], v[16:19]
    ds_read_b128 v[236:239], v249 offset:45056
    v_mfma_f32_16x16x32_bf16 v[48:51], v[168:171], v[240:243], v[48:51]
    v_mfma_f32_16x16x32_bf16 v[48:51], v[172:175], v[244:247], v[48:51]
    v_mfma_f32_16x16x32_bf16 v[80:83], v[176:179], v[240:243], v[80:83]
    v_mfma_f32_16x16x32_bf16 v[80:83], v[180:183], v[244:247], v[80:83]
    v_mfma_f32_16x16x32_bf16 v[112:115], v[184:187], v[240:243], v[112:115]
    v_mfma_f32_16x16x32_bf16 v[112:115], v[188:191], v[244:247], v[112:115]
    s_waitcnt lgkmcnt(2)
    v_mfma_f32_16x16x32_bf16 v[116:119], v[184:187], v[224:227], v[116:119]
    ds_read_b128 v[240:243], v248 offset:47104
    v_mfma_f32_16x16x32_bf16 v[116:119], v[188:191], v[228:231], v[116:119]
    ds_read_b128 v[244:247], v249 offset:47104
    v_mfma_f32_16x16x32_bf16 v[84:87], v[176:179], v[224:227], v[84:87]
    v_mfma_f32_16x16x32_bf16 v[84:87], v[180:183], v[228:231], v[84:87]
    v_mfma_f32_16x16x32_bf16 v[52:55], v[168:171], v[224:227], v[52:55]
    v_mfma_f32_16x16x32_bf16 v[52:55], v[172:175], v[228:231], v[52:55]
    v_mfma_f32_16x16x32_bf16 v[20:23], v[160:163], v[224:227], v[20:23]
    v_mfma_f32_16x16x32_bf16 v[20:23], v[164:167], v[228:231], v[20:23]
    s_waitcnt lgkmcnt(2)
    v_mfma_f32_16x16x32_bf16 v[24:27], v[160:163], v[232:235], v[24:27]
    ds_read_b128 v[224:227], v248 offset:49152
    v_mfma_f32_16x16x32_bf16 v[24:27], v[164:167], v[236:239], v[24:27]
    ds_read_b128 v[228:231], v249 offset:49152
    v_mfma_f32_16x16x32_bf16 v[56:59], v[168:171], v[232:235], v[56:59]
    v_mfma_f32_16x16x32_bf16 v[56:59], v[172:175], v[236:239], v[56:59]
    v_mfma_f32_16x16x32_bf16 v[88:91], v[176:179], v[232:235], v[88:91]
    v_mfma_f32_16x16x32_bf16 v[88:91], v[180:183], v[236:239], v[88:91]
    v_mfma_f32_16x16x32_bf16 v[120:123], v[184:187], v[232:235], v[120:123]
    v_mfma_f32_16x16x32_bf16 v[120:123], v[188:191], v[236:239], v[120:123]
    s_waitcnt lgkmcnt(2)
    v_mfma_f32_16x16x32_bf16 v[124:127], v[184:187], v[240:243], v[124:127]
    ds_read_b128 v[232:235], v248 offset:51200
    v_mfma_f32_16x16x32_bf16 v[124:127], v[188:191], v[244:247], v[124:127]
    ds_read_b128 v[236:239], v249 offset:51200
    v_mfma_f32_16x16x32_bf16 v[92:95], v[176:179], v[240:243], v[92:95]
    v_mfma_f32_16x16x32_bf16 v[92:95], v[180:183], v[244:247], v[92:95]
    s_mov_b32 s46, 32768
    v_mfma_f32_16x16x32_bf16 v[60:63], v[168:171], v[240:243], v[60:63]
    s_mov_b32 s47, 36864
    v_mfma_f32_16x16x32_bf16 v[60:63], v[172:175], v[244:247], v[60:63]
    v_mfma_f32_16x16x32_bf16 v[28:31], v[160:163], v[240:243], v[28:31]
    v_mfma_f32_16x16x32_bf16 v[28:31], v[164:167], v[244:247], v[28:31]
    s_waitcnt vmcnt(4) lgkmcnt(2)
    v_mfma_f32_16x16x32_bf16 v[0:3], v[192:195], v[224:227], v[0:3]
    ds_read_b128 v[240:243], v248 offset:53248
    v_mfma_f32_16x16x32_bf16 v[0:3], v[196:199], v[228:231], v[0:3]
    ds_read_b128 v[244:247], v249 offset:53248
    v_mfma_f32_16x16x32_bf16 v[32:35], v[200:203], v[224:227], v[32:35]
    buffer_load_dwordx4 v[160:163], v250, s[60:63], s46 offen offset:0 sc1
    v_mfma_f32_16x16x32_bf16 v[32:35], v[204:207], v[228:231], v[32:35]
    s_waitcnt vmcnt(1)
    v_mfma_f32_16x16x32_bf16 v[64:67], v[208:211], v[224:227], v[64:67]
    v_mfma_f32_16x16x32_bf16 v[64:67], v[212:215], v[228:231], v[64:67]
    buffer_load_dwordx4 v[164:167], v250, s[60:63], s46 offen offset:1024 sc1
    v_mfma_f32_16x16x32_bf16 v[96:99], v[216:219], v[224:227], v[96:99]
    v_mfma_f32_16x16x32_bf16 v[96:99], v[220:223], v[228:231], v[96:99]
    s_waitcnt lgkmcnt(2)
    v_mfma_f32_16x16x32_bf16 v[100:103], v[216:219], v[232:235], v[100:103]
    ds_read_b128 v[224:227], v248 offset:55296
    v_mfma_f32_16x16x32_bf16 v[100:103], v[220:223], v[236:239], v[100:103]
    ds_read_b128 v[228:231], v249 offset:55296
    v_mfma_f32_16x16x32_bf16 v[68:71], v[208:211], v[232:235], v[68:71]
    buffer_load_dwordx4 v[168:171], v250, s[60:63], s46 offen offset:2048 sc1
    v_mfma_f32_16x16x32_bf16 v[68:71], v[212:215], v[236:239], v[68:71]
    v_mfma_f32_16x16x32_bf16 v[36:39], v[200:203], v[232:235], v[36:39]
    v_mfma_f32_16x16x32_bf16 v[36:39], v[204:207], v[236:239], v[36:39]
    buffer_load_dwordx4 v[172:175], v250, s[60:63], s46 offen offset:3072 sc1
    v_mfma_f32_16x16x32_bf16 v[4:7], v[192:195], v[232:235], v[4:7]
    v_mfma_f32_16x16x32_bf16 v[4:7], v[196:199], v[236:239], v[4:7]
    s_waitcnt lgkmcnt(2)
    v_mfma_f32_16x16x32_bf16 v[8:11], v[192:195], v[240:243], v[8:11]
    ds_read_b128 v[232:235], v248 offset:57344
    v_mfma_f32_16x16x32_bf16 v[8:11], v[196:199], v[244:247], v[8:11]
    ds_read_b128 v[236:239], v249 offset:57344
    v_mfma_f32_16x16x32_bf16 v[40:43], v[200:203], v[240:243], v[40:43]
    buffer_load_dwordx4 v[176:179], v250, s[60:63], s47 offen offset:0 sc1
    v_mfma_f32_16x16x32_bf16 v[40:43], v[204:207], v[244:247], v[40:43]
    v_mfma_f32_16x16x32_bf16 v[72:75], v[208:211], v[240:243], v[72:75]
    v_mfma_f32_16x16x32_bf16 v[72:75], v[212:215], v[244:247], v[72:75]
    buffer_load_dwordx4 v[180:183], v250, s[60:63], s47 offen offset:1024 sc1
    v_mfma_f32_16x16x32_bf16 v[104:107], v[216:219], v[240:243], v[104:107]
    v_mfma_f32_16x16x32_bf16 v[104:107], v[220:223], v[244:247], v[104:107]
    s_waitcnt lgkmcnt(2)
    v_mfma_f32_16x16x32_bf16 v[108:111], v[216:219], v[224:227], v[108:111]
    ds_read_b128 v[240:243], v248 offset:59392
    v_mfma_f32_16x16x32_bf16 v[108:111], v[220:223], v[228:231], v[108:111]
    ds_read_b128 v[244:247], v249 offset:59392
    v_mfma_f32_16x16x32_bf16 v[76:79], v[208:211], v[224:227], v[76:79]
    buffer_load_dwordx4 v[184:187], v250, s[60:63], s47 offen offset:2048 sc1
    v_mfma_f32_16x16x32_bf16 v[76:79], v[212:215], v[228:231], v[76:79]
    v_mfma_f32_16x16x32_bf16 v[44:47], v[200:203], v[224:227], v[44:47]
    v_mfma_f32_16x16x32_bf16 v[44:47], v[204:207], v[228:231], v[44:47]
    buffer_load_dwordx4 v[188:191], v250, s[60:63], s47 offen offset:3072 sc1
    v_mfma_f32_16x16x32_bf16 v[12:15], v[192:195], v[224:227], v[12:15]
    v_mfma_f32_16x16x32_bf16 v[12:15], v[196:199], v[228:231], v[12:15]
    s_waitcnt lgkmcnt(2)
    v_mfma_f32_16x16x32_bf16 v[16:19], v[192:195], v[232:235], v[16:19]
    ds_read_b128 v[224:227], v248 offset:61440
    v_mfma_f32_16x16x32_bf16 v[16:19], v[196:199], v[236:239], v[16:19]
    ds_read_b128 v[228:231], v249 offset:61440
    v_mfma_f32_16x16x32_bf16 v[48:51], v[200:203], v[232:235], v[48:51]
    v_mfma_f32_16x16x32_bf16 v[48:51], v[204:207], v[236:239], v[48:51]
    v_mfma_f32_16x16x32_bf16 v[80:83], v[208:211], v[232:235], v[80:83]
    s_setprio 2
    v_mfma_f32_16x16x32_bf16 v[80:83], v[212:215], v[236:239], v[80:83]
    v_mfma_f32_16x16x32_bf16 v[112:115], v[216:219], v[232:235], v[112:115]
    v_mfma_f32_16x16x32_bf16 v[112:115], v[220:223], v[236:239], v[112:115]
    s_waitcnt lgkmcnt(2)
    v_mfma_f32_16x16x32_bf16 v[116:119], v[216:219], v[240:243], v[116:119]
    ds_read_b128 v[232:235], v248 offset:63488
    v_mfma_f32_16x16x32_bf16 v[116:119], v[220:223], v[244:247], v[116:119]
    ds_read_b128 v[236:239], v249 offset:63488
    v_mfma_f32_16x16x32_bf16 v[84:87], v[208:211], v[240:243], v[84:87]
    v_mfma_f32_16x16x32_bf16 v[84:87], v[212:215], v[244:247], v[84:87]
    v_add_u32 v248, 0x10000, v248
    v_mfma_f32_16x16x32_bf16 v[52:55], v[200:203], v[240:243], v[52:55]
    v_add_u32 v249, 0x10000, v249
    v_mfma_f32_16x16x32_bf16 v[52:55], v[204:207], v[244:247], v[52:55]
    v_mfma_f32_16x16x32_bf16 v[20:23], v[192:195], v[240:243], v[20:23]
    v_mfma_f32_16x16x32_bf16 v[20:23], v[196:199], v[244:247], v[20:23]
    s_waitcnt lgkmcnt(2)
    v_mfma_f32_16x16x32_bf16 v[24:27], v[192:195], v[224:227], v[24:27]
    ds_read_b128 v[240:243], v248 offset:0
    v_mfma_f32_16x16x32_bf16 v[24:27], v[196:199], v[228:231], v[24:27]
    ds_read_b128 v[244:247], v249 offset:0
    v_mfma_f32_16x16x32_bf16 v[56:59], v[200:203], v[224:227], v[56:59]
    v_mfma_f32_16x16x32_bf16 v[56:59], v[204:207], v[228:231], v[56:59]
    v_mfma_f32_16x16x32_bf16 v[88:91], v[208:211], v[224:227], v[88:91]
    v_mfma_f32_16x16x32_bf16 v[88:91], v[212:215], v[228:231], v[88:91]
    v_mfma_f32_16x16x32_bf16 v[120:123], v[216:219], v[224:227], v[120:123]
    v_mfma_f32_16x16x32_bf16 v[120:123], v[220:223], v[228:231], v[120:123]
    s_waitcnt lgkmcnt(2)
    v_mfma_f32_16x16x32_bf16 v[124:127], v[216:219], v[232:235], v[124:127]
    ds_read_b128 v[224:227], v248 offset:2048
    v_mfma_f32_16x16x32_bf16 v[124:127], v[220:223], v[236:239], v[124:127]
    ds_read_b128 v[228:231], v249 offset:2048
    v_mfma_f32_16x16x32_bf16 v[92:95], v[208:211], v[232:235], v[92:95]
    v_mfma_f32_16x16x32_bf16 v[92:95], v[212:215], v[236:239], v[92:95]
    s_mov_b32 s46, 40960
    v_mfma_f32_16x16x32_bf16 v[60:63], v[200:203], v[232:235], v[60:63]
    s_mov_b32 s47, 45056
    v_mfma_f32_16x16x32_bf16 v[60:63], v[204:207], v[236:239], v[60:63]
    v_mfma_f32_16x16x32_bf16 v[28:31], v[192:195], v[232:235], v[28:31]
    v_mfma_f32_16x16x32_bf16 v[28:31], v[196:199], v[236:239], v[28:31]
    s_waitcnt vmcnt(4) lgkmcnt(2)
    v_mfma_f32_16x16x32_bf16 v[0:3], v[160:163], v[240:243], v[0:3]
    ds_read_b128 v[232:235], v248 offset:4096
    v_mfma_f32_16x16x32_bf16 v[0:3], v[164:167], v[244:247], v[0:3]
    ds_read_b128 v[236:239], v249 offset:4096
    v_mfma_f32_16x16x32_bf16 v[32:35], v[168:171], v[240:243], v[32:35]
    buffer_load_dwordx4 v[192:195], v250, s[60:63], s46 offen offset:0 sc1
    v_mfma_f32_16x16x32_bf16 v[32:35], v[172:175], v[244:247], v[32:35]
    s_waitcnt vmcnt(1)
    v_mfma_f32_16x16x32_bf16 v[64:67], v[176:179], v[240:243], v[64:67]
    v_mfma_f32_16x16x32_bf16 v[64:67], v[180:183], v[244:247], v[64:67]
    buffer_load_dwordx4 v[196:199], v250, s[60:63], s46 offen offset:1024 sc1
    v_mfma_f32_16x16x32_bf16 v[96:99], v[184:187], v[240:243], v[96:99]
    v_mfma_f32_16x16x32_bf16 v[96:99], v[188:191], v[244:247], v[96:99]
    s_waitcnt lgkmcnt(2)
    v_mfma_f32_16x16x32_bf16 v[100:103], v[184:187], v[224:227], v[100:103]
    ds_read_b128 v[240:243], v248 offset:6144
    v_mfma_f32_16x16x32_bf16 v[100:103], v[188:191], v[228:231], v[100:103]
    ds_read_b128 v[244:247], v249 offset:6144
    v_mfma_f32_16x16x32_bf16 v[68:71], v[176:179], v[224:227], v[68:71]
    buffer_load_dwordx4 v[200:203], v250, s[60:63], s46 offen offset:2048 sc1
    v_mfma_f32_16x16x32_bf16 v[68:71], v[180:183], v[228:231], v[68:71]
    v_mfma_f32_16x16x32_bf16 v[36:39], v[168:171], v[224:227], v[36:39]
    v_mfma_f32_16x16x32_bf16 v[36:39], v[172:175], v[228:231], v[36:39]
    buffer_load_dwordx4 v[204:207], v250, s[60:63], s46 offen offset:3072 sc1
    v_mfma_f32_16x16x32_bf16 v[4:7], v[160:163], v[224:227], v[4:7]
    v_mfma_f32_16x16x32_bf16 v[4:7], v[164:167], v[228:231], v[4:7]
    s_waitcnt lgkmcnt(2)
    v_mfma_f32_16x16x32_bf16 v[8:11], v[160:163], v[232:235], v[8:11]
    ds_read_b128 v[224:227], v248 offset:8192
    v_mfma_f32_16x16x32_bf16 v[8:11], v[164:167], v[236:239], v[8:11]
    ds_read_b128 v[228:231], v249 offset:8192
    v_mfma_f32_16x16x32_bf16 v[40:43], v[168:171], v[232:235], v[40:43]
    buffer_load_dwordx4 v[208:211], v250, s[60:63], s47 offen offset:0 sc1
    v_mfma_f32_16x16x32_bf16 v[40:43], v[172:175], v[236:239], v[40:43]
    v_mfma_f32_16x16x32_bf16 v[72:75], v[176:179], v[232:235], v[72:75]
    v_mfma_f32_16x16x32_bf16 v[72:75], v[180:183], v[236:239], v[72:75]
    buffer_load_dwordx4 v[212:215], v250, s[60:63], s47 offen offset:1024 sc1
    v_mfma_f32_16x16x32_bf16 v[104:107], v[184:187], v[232:235], v[104:107]
    v_mfma_f32_16x16x32_bf16 v[104:107], v[188:191], v[236:239], v[104:107]
    s_waitcnt lgkmcnt(2)
    v_mfma_f32_16x16x32_bf16 v[108:111], v[184:187], v[240:243], v[108:111]
    ds_read_b128 v[232:235], v248 offset:10240
    v_mfma_f32_16x16x32_bf16 v[108:111], v[188:191], v[244:247], v[108:111]
    ds_read_b128 v[236:239], v249 offset:10240
    v_mfma_f32_16x16x32_bf16 v[76:79], v[176:179], v[240:243], v[76:79]
    buffer_load_dwordx4 v[216:219], v250, s[60:63], s47 offen offset:2048 sc1
    v_mfma_f32_16x16x32_bf16 v[76:79], v[180:183], v[244:247], v[76:79]
    v_mfma_f32_16x16x32_bf16 v[44:47], v[168:171], v[240:243], v[44:47]
    v_mfma_f32_16x16x32_bf16 v[44:47], v[172:175], v[244:247], v[44:47]
    buffer_load_dwordx4 v[220:223], v250, s[60:63], s47 offen offset:3072 sc1
    v_mfma_f32_16x16x32_bf16 v[12:15], v[160:163], v[240:243], v[12:15]
    v_mfma_f32_16x16x32_bf16 v[12:15], v[164:167], v[244:247], v[12:15]
    s_waitcnt lgkmcnt(2)
    v_mfma_f32_16x16x32_bf16 v[16:19], v[160:163], v[224:227], v[16:19]
    ds_read_b128 v[240:243], v248 offset:12288
    v_mfma_f32_16x16x32_bf16 v[16:19], v[164:167], v[228:231], v[16:19]
    ds_read_b128 v[244:247], v249 offset:12288
    v_mfma_f32_16x16x32_bf16 v[48:51], v[168:171], v[224:227], v[48:51]
    v_mfma_f32_16x16x32_bf16 v[48:51], v[172:175], v[228:231], v[48:51]
    v_mfma_f32_16x16x32_bf16 v[80:83], v[176:179], v[224:227], v[80:83]
    v_mfma_f32_16x16x32_bf16 v[80:83], v[180:183], v[228:231], v[80:83]
    v_mfma_f32_16x16x32_bf16 v[112:115], v[184:187], v[224:227], v[112:115]
    v_mfma_f32_16x16x32_bf16 v[112:115], v[188:191], v[228:231], v[112:115]
    s_waitcnt lgkmcnt(2)
    v_mfma_f32_16x16x32_bf16 v[116:119], v[184:187], v[232:235], v[116:119]
    ds_read_b128 v[224:227], v248 offset:14336
    v_mfma_f32_16x16x32_bf16 v[116:119], v[188:191], v[236:239], v[116:119]
    ds_read_b128 v[228:231], v249 offset:14336
    v_mfma_f32_16x16x32_bf16 v[84:87], v[176:179], v[232:235], v[84:87]
    v_mfma_f32_16x16x32_bf16 v[84:87], v[180:183], v[236:239], v[84:87]
    v_mfma_f32_16x16x32_bf16 v[52:55], v[168:171], v[232:235], v[52:55]
    v_mfma_f32_16x16x32_bf16 v[52:55], v[172:175], v[236:239], v[52:55]
    v_mfma_f32_16x16x32_bf16 v[20:23], v[160:163], v[232:235], v[20:23]
    v_mfma_f32_16x16x32_bf16 v[20:23], v[164:167], v[236:239], v[20:23]
    s_waitcnt lgkmcnt(2)
    v_mfma_f32_16x16x32_bf16 v[24:27], v[160:163], v[240:243], v[24:27]
    ds_read_b128 v[232:235], v248 offset:16384
    v_mfma_f32_16x16x32_bf16 v[24:27], v[164:167], v[244:247], v[24:27]
    ds_read_b128 v[236:239], v249 offset:16384
    v_mfma_f32_16x16x32_bf16 v[56:59], v[168:171], v[240:243], v[56:59]
    v_mfma_f32_16x16x32_bf16 v[56:59], v[172:175], v[244:247], v[56:59]
    v_mfma_f32_16x16x32_bf16 v[88:91], v[176:179], v[240:243], v[88:91]
    v_mfma_f32_16x16x32_bf16 v[88:91], v[180:183], v[244:247], v[88:91]
    v_mfma_f32_16x16x32_bf16 v[120:123], v[184:187], v[240:243], v[120:123]
    v_mfma_f32_16x16x32_bf16 v[120:123], v[188:191], v[244:247], v[120:123]
    s_waitcnt lgkmcnt(2)
    v_mfma_f32_16x16x32_bf16 v[124:127], v[184:187], v[224:227], v[124:127]
    ds_read_b128 v[240:243], v248 offset:18432
    v_mfma_f32_16x16x32_bf16 v[124:127], v[188:191], v[228:231], v[124:127]
    ds_read_b128 v[244:247], v249 offset:18432
    v_mfma_f32_16x16x32_bf16 v[92:95], v[176:179], v[224:227], v[92:95]
    v_mfma_f32_16x16x32_bf16 v[92:95], v[180:183], v[228:231], v[92:95]
    s_mov_b32 s46, 49152
    v_mfma_f32_16x16x32_bf16 v[60:63], v[168:171], v[224:227], v[60:63]
    s_mov_b32 s47, 53248
    v_mfma_f32_16x16x32_bf16 v[60:63], v[172:175], v[228:231], v[60:63]
    v_mfma_f32_16x16x32_bf16 v[28:31], v[160:163], v[224:227], v[28:31]
    v_mfma_f32_16x16x32_bf16 v[28:31], v[164:167], v[228:231], v[28:31]
    s_waitcnt vmcnt(4) lgkmcnt(2)
    v_mfma_f32_16x16x32_bf16 v[0:3], v[192:195], v[232:235], v[0:3]
    ds_read_b128 v[224:227], v248 offset:20480
    v_mfma_f32_16x16x32_bf16 v[0:3], v[196:199], v[236:239], v[0:3]
    ds_read_b128 v[228:231], v249 offset:20480
    v_mfma_f32_16x16x32_bf16 v[32:35], v[200:203], v[232:235], v[32:35]
    buffer_load_dwordx4 v[160:163], v250, s[60:63], s46 offen offset:0 sc1
    v_mfma_f32_16x16x32_bf16 v[32:35], v[204:207], v[236:239], v[32:35]
    s_waitcnt vmcnt(1)
    v_mfma_f32_16x16x32_bf16 v[64:67], v[208:211], v[232:235], v[64:67]
    v_mfma_f32_16x16x32_bf16 v[64:67], v[212:215], v[236:239], v[64:67]
    buffer_load_dwordx4 v[164:167], v250, s[60:63], s46 offen offset:1024 sc1
    v_mfma_f32_16x16x32_bf16 v[96:99], v[216:219], v[232:235], v[96:99]
    v_mfma_f32_16x16x32_bf16 v[96:99], v[220:223], v[236:239], v[96:99]
    s_waitcnt lgkmcnt(2)
    v_mfma_f32_16x16x32_bf16 v[100:103], v[216:219], v[240:243], v[100:103]
    ds_read_b128 v[232:235], v248 offset:22528
    v_mfma_f32_16x16x32_bf16 v[100:103], v[220:223], v[244:247], v[100:103]
    ds_read_b128 v[236:239], v249 offset:22528
    v_mfma_f32_16x16x32_bf16 v[68:71], v[208:211], v[240:243], v[68:71]
    buffer_load_dwordx4 v[168:171], v250, s[60:63], s46 offen offset:2048 sc1
    v_mfma_f32_16x16x32_bf16 v[68:71], v[212:215], v[244:247], v[68:71]
    v_mfma_f32_16x16x32_bf16 v[36:39], v[200:203], v[240:243], v[36:39]
    v_mfma_f32_16x16x32_bf16 v[36:39], v[204:207], v[244:247], v[36:39]
    buffer_load_dwordx4 v[172:175], v250, s[60:63], s46 offen offset:3072 sc1
    v_mfma_f32_16x16x32_bf16 v[4:7], v[192:195], v[240:243], v[4:7]
    v_mfma_f32_16x16x32_bf16 v[4:7], v[196:199], v[244:247], v[4:7]
    s_waitcnt lgkmcnt(2)
    v_mfma_f32_16x16x32_bf16 v[8:11], v[192:195], v[224:227], v[8:11]
    ds_read_b128 v[240:243], v248 offset:24576
    v_mfma_f32_16x16x32_bf16 v[8:11], v[196:199], v[228:231], v[8:11]
    ds_read_b128 v[244:247], v249 offset:24576
    v_mfma_f32_16x16x32_bf16 v[40:43], v[200:203], v[224:227], v[40:43]
    buffer_load_dwordx4 v[176:179], v250, s[60:63], s47 offen offset:0 sc1
    v_mfma_f32_16x16x32_bf16 v[40:43], v[204:207], v[228:231], v[40:43]
    v_mfma_f32_16x16x32_bf16 v[72:75], v[208:211], v[224:227], v[72:75]
    v_mfma_f32_16x16x32_bf16 v[72:75], v[212:215], v[228:231], v[72:75]
    buffer_load_dwordx4 v[180:183], v250, s[60:63], s47 offen offset:1024 sc1
    v_mfma_f32_16x16x32_bf16 v[104:107], v[216:219], v[224:227], v[104:107]
    v_mfma_f32_16x16x32_bf16 v[104:107], v[220:223], v[228:231], v[104:107]
    s_waitcnt lgkmcnt(2)
    v_mfma_f32_16x16x32_bf16 v[108:111], v[216:219], v[232:235], v[108:111]
    ds_read_b128 v[224:227], v248 offset:26624
    v_mfma_f32_16x16x32_bf16 v[108:111], v[220:223], v[236:239], v[108:111]
    ds_read_b128 v[228:231], v249 offset:26624
    v_mfma_f32_16x16x32_bf16 v[76:79], v[208:211], v[232:235], v[76:79]
    buffer_load_dwordx4 v[184:187], v250, s[60:63], s47 offen offset:2048 sc1
    v_mfma_f32_16x16x32_bf16 v[76:79], v[212:215], v[236:239], v[76:79]
    v_mfma_f32_16x16x32_bf16 v[44:47], v[200:203], v[232:235], v[44:47]
    v_mfma_f32_16x16x32_bf16 v[44:47], v[204:207], v[236:239], v[44:47]
    buffer_load_dwordx4 v[188:191], v250, s[60:63], s47 offen offset:3072 sc1
    v_mfma_f32_16x16x32_bf16 v[12:15], v[192:195], v[232:235], v[12:15]
    v_mfma_f32_16x16x32_bf16 v[12:15], v[196:199], v[236:239], v[12:15]
    s_waitcnt lgkmcnt(2)
    v_mfma_f32_16x16x32_bf16 v[16:19], v[192:195], v[240:243], v[16:19]
    ds_read_b128 v[232:235], v248 offset:28672
    v_mfma_f32_16x16x32_bf16 v[16:19], v[196:199], v[244:247], v[16:19]
    ds_read_b128 v[236:239], v249 offset:28672
    v_mfma_f32_16x16x32_bf16 v[48:51], v[200:203], v[240:243], v[48:51]
    v_mfma_f32_16x16x32_bf16 v[48:51], v[204:207], v[244:247], v[48:51]
    v_mfma_f32_16x16x32_bf16 v[80:83], v[208:211], v[240:243], v[80:83]
    v_mfma_f32_16x16x32_bf16 v[80:83], v[212:215], v[244:247], v[80:83]
    v_mfma_f32_16x16x32_bf16 v[112:115], v[216:219], v[240:243], v[112:115]
    v_mfma_f32_16x16x32_bf16 v[112:115], v[220:223], v[244:247], v[112:115]
    s_waitcnt lgkmcnt(2)
    v_mfma_f32_16x16x32_bf16 v[116:119], v[216:219], v[224:227], v[116:119]
    ds_read_b128 v[240:243], v248 offset:30720
    v_mfma_f32_16x16x32_bf16 v[116:119], v[220:223], v[228:231], v[116:119]
    ds_read_b128 v[244:247], v249 offset:30720
    v_mfma_f32_16x16x32_bf16 v[84:87], v[208:211], v[224:227], v[84:87]
    v_mfma_f32_16x16x32_bf16 v[84:87], v[212:215], v[228:231], v[84:87]
    v_mfma_f32_16x16x32_bf16 v[52:55], v[200:203], v[224:227], v[52:55]
    v_mfma_f32_16x16x32_bf16 v[52:55], v[204:207], v[228:231], v[52:55]
    v_mfma_f32_16x16x32_bf16 v[20:23], v[192:195], v[224:227], v[20:23]
    v_mfma_f32_16x16x32_bf16 v[20:23], v[196:199], v[228:231], v[20:23]
    s_waitcnt lgkmcnt(2)
    v_mfma_f32_16x16x32_bf16 v[24:27], v[192:195], v[232:235], v[24:27]
    ds_read_b128 v[224:227], v248 offset:32768
    v_mfma_f32_16x16x32_bf16 v[24:27], v[196:199], v[236:239], v[24:27]
    ds_read_b128 v[228:231], v249 offset:32768
    v_mfma_f32_16x16x32_bf16 v[56:59], v[200:203], v[232:235], v[56:59]
    v_mfma_f32_16x16x32_bf16 v[56:59], v[204:207], v[236:239], v[56:59]
    v_mfma_f32_16x16x32_bf16 v[88:91], v[208:211], v[232:235], v[88:91]
    v_mfma_f32_16x16x32_bf16 v[88:91], v[212:215], v[236:239], v[88:91]
    v_mfma_f32_16x16x32_bf16 v[120:123], v[216:219], v[232:235], v[120:123]
    v_mfma_f32_16x16x32_bf16 v[120:123], v[220:223], v[236:239], v[120:123]
    s_waitcnt lgkmcnt(2)
    v_mfma_f32_16x16x32_bf16 v[124:127], v[216:219], v[240:243], v[124:127]
    ds_read_b128 v[232:235], v248 offset:34816
    v_mfma_f32_16x16x32_bf16 v[124:127], v[220:223], v[244:247], v[124:127]
    ds_read_b128 v[236:239], v249 offset:34816
    v_mfma_f32_16x16x32_bf16 v[92:95], v[208:211], v[240:243], v[92:95]
    v_mfma_f32_16x16x32_bf16 v[92:95], v[212:215], v[244:247], v[92:95]
    s_mov_b32 s46, 57344
    v_mfma_f32_16x16x32_bf16 v[60:63], v[200:203], v[240:243], v[60:63]
    s_mov_b32 s47, 61440
    v_mfma_f32_16x16x32_bf16 v[60:63], v[204:207], v[244:247], v[60:63]
    v_mfma_f32_16x16x32_bf16 v[28:31], v[192:195], v[240:243], v[28:31]
    v_mfma_f32_16x16x32_bf16 v[28:31], v[196:199], v[244:247], v[28:31]
    s_waitcnt vmcnt(4) lgkmcnt(2)
    v_mfma_f32_16x16x32_bf16 v[0:3], v[160:163], v[224:227], v[0:3]
    ds_read_b128 v[240:243], v248 offset:36864
    v_mfma_f32_16x16x32_bf16 v[0:3], v[164:167], v[228:231], v[0:3]
    ds_read_b128 v[244:247], v249 offset:36864
    v_mfma_f32_16x16x32_bf16 v[32:35], v[168:171], v[224:227], v[32:35]
    buffer_load_dwordx4 v[192:195], v250, s[60:63], s46 offen offset:0 sc1
    v_mfma_f32_16x16x32_bf16 v[32:35], v[172:175], v[228:231], v[32:35]
    s_waitcnt vmcnt(1)
    v_mfma_f32_16x16x32_bf16 v[64:67], v[176:179], v[224:227], v[64:67]
    v_mfma_f32_16x16x32_bf16 v[64:67], v[180:183], v[228:231], v[64:67]
    buffer_load_dwordx4 v[196:199], v250, s[60:63], s46 offen offset:1024 sc1
    v_mfma_f32_16x16x32_bf16 v[96:99], v[184:187], v[224:227], v[96:99]
    v_mfma_f32_16x16x32_bf16 v[96:99], v[188:191], v[228:231], v[96:99]
    s_waitcnt lgkmcnt(2)
    v_mfma_f32_16x16x32_bf16 v[100:103], v[184:187], v[232:235], v[100:103]
    ds_read_b128 v[224:227], v248 offset:38912
    v_mfma_f32_16x16x32_bf16 v[100:103], v[188:191], v[236:239], v[100:103]
    ds_read_b128 v[228:231], v249 offset:38912
    v_mfma_f32_16x16x32_bf16 v[68:71], v[176:179], v[232:235], v[68:71]
    buffer_load_dwordx4 v[200:203], v250, s[60:63], s46 offen offset:2048 sc1
    v_mfma_f32_16x16x32_bf16 v[68:71], v[180:183], v[236:239], v[68:71]
    v_mfma_f32_16x16x32_bf16 v[36:39], v[168:171], v[232:235], v[36:39]
    v_mfma_f32_16x16x32_bf16 v[36:39], v[172:175], v[236:239], v[36:39]
    buffer_load_dwordx4 v[204:207], v250, s[60:63], s46 offen offset:3072 sc1
    v_mfma_f32_16x16x32_bf16 v[4:7], v[160:163], v[232:235], v[4:7]
    v_mfma_f32_16x16x32_bf16 v[4:7], v[164:167], v[236:239], v[4:7]
    s_waitcnt lgkmcnt(2)
    v_mfma_f32_16x16x32_bf16 v[8:11], v[160:163], v[240:243], v[8:11]
    ds_read_b128 v[232:235], v248 offset:40960
    v_mfma_f32_16x16x32_bf16 v[8:11], v[164:167], v[244:247], v[8:11]
    ds_read_b128 v[236:239], v249 offset:40960
    v_mfma_f32_16x16x32_bf16 v[40:43], v[168:171], v[240:243], v[40:43]
    buffer_load_dwordx4 v[208:211], v250, s[60:63], s47 offen offset:0 sc1
    v_mfma_f32_16x16x32_bf16 v[40:43], v[172:175], v[244:247], v[40:43]
    v_mfma_f32_16x16x32_bf16 v[72:75], v[176:179], v[240:243], v[72:75]
    v_mfma_f32_16x16x32_bf16 v[72:75], v[180:183], v[244:247], v[72:75]
    buffer_load_dwordx4 v[212:215], v250, s[60:63], s47 offen offset:1024 sc1
    v_mfma_f32_16x16x32_bf16 v[104:107], v[184:187], v[240:243], v[104:107]
    v_mfma_f32_16x16x32_bf16 v[104:107], v[188:191], v[244:247], v[104:107]
    s_waitcnt lgkmcnt(2)
    v_mfma_f32_16x16x32_bf16 v[108:111], v[184:187], v[224:227], v[108:111]
    ds_read_b128 v[240:243], v248 offset:43008
    v_mfma_f32_16x16x32_bf16 v[108:111], v[188:191], v[228:231], v[108:111]
    ds_read_b128 v[244:247], v249 offset:43008
    v_mfma_f32_16x16x32_bf16 v[76:79], v[176:179], v[224:227], v[76:79]
    buffer_load_dwordx4 v[216:219], v250, s[60:63], s47 offen offset:2048 sc1
    v_mfma_f32_16x16x32_bf16 v[76:79], v[180:183], v[228:231], v[76:79]
    v_mfma_f32_16x16x32_bf16 v[44:47], v[168:171], v[224:227], v[44:47]
    v_mfma_f32_16x16x32_bf16 v[44:47], v[172:175], v[228:231], v[44:47]
    buffer_load_dwordx4 v[220:223], v250, s[60:63], s47 offen offset:3072 sc1
    v_mfma_f32_16x16x32_bf16 v[12:15], v[160:163], v[224:227], v[12:15]
    v_mfma_f32_16x16x32_bf16 v[12:15], v[164:167], v[228:231], v[12:15]
    s_waitcnt lgkmcnt(2)
    v_mfma_f32_16x16x32_bf16 v[16:19], v[160:163], v[232:235], v[16:19]
    ds_read_b128 v[224:227], v248 offset:45056
    v_mfma_f32_16x16x32_bf16 v[16:19], v[164:167], v[236:239], v[16:19]
    ds_read_b128 v[228:231], v249 offset:45056
    v_mfma_f32_16x16x32_bf16 v[48:51], v[168:171], v[232:235], v[48:51]
    v_mfma_f32_16x16x32_bf16 v[48:51], v[172:175], v[236:239], v[48:51]
    v_mfma_f32_16x16x32_bf16 v[80:83], v[176:179], v[232:235], v[80:83]
    v_mfma_f32_16x16x32_bf16 v[80:83], v[180:183], v[236:239], v[80:83]
    v_mfma_f32_16x16x32_bf16 v[112:115], v[184:187], v[232:235], v[112:115]
    v_mfma_f32_16x16x32_bf16 v[112:115], v[188:191], v[236:239], v[112:115]
    s_waitcnt lgkmcnt(2)
    v_mfma_f32_16x16x32_bf16 v[116:119], v[184:187], v[240:243], v[116:119]
    ds_read_b128 v[232:235], v248 offset:47104
    v_mfma_f32_16x16x32_bf16 v[116:119], v[188:191], v[244:247], v[116:119]
    ds_read_b128 v[236:239], v249 offset:47104
    v_mfma_f32_16x16x32_bf16 v[84:87], v[176:179], v[240:243], v[84:87]
    v_mfma_f32_16x16x32_bf16 v[84:87], v[180:183], v[244:247], v[84:87]
    v_mfma_f32_16x16x32_bf16 v[52:55], v[168:171], v[240:243], v[52:55]
    v_mfma_f32_16x16x32_bf16 v[52:55], v[172:175], v[244:247], v[52:55]
    v_mfma_f32_16x16x32_bf16 v[20:23], v[160:163], v[240:243], v[20:23]
    v_mfma_f32_16x16x32_bf16 v[20:23], v[164:167], v[244:247], v[20:23]
    s_waitcnt lgkmcnt(2)
    v_mfma_f32_16x16x32_bf16 v[24:27], v[160:163], v[224:227], v[24:27]
    ds_read_b128 v[240:243], v248 offset:49152
    v_mfma_f32_16x16x32_bf16 v[24:27], v[164:167], v[228:231], v[24:27]
    ds_read_b128 v[244:247], v249 offset:49152
    v_mfma_f32_16x16x32_bf16 v[56:59], v[168:171], v[224:227], v[56:59]
    v_mfma_f32_16x16x32_bf16 v[56:59], v[172:175], v[228:231], v[56:59]
    v_mfma_f32_16x16x32_bf16 v[88:91], v[176:179], v[224:227], v[88:91]
    v_mfma_f32_16x16x32_bf16 v[88:91], v[180:183], v[228:231], v[88:91]
    v_mfma_f32_16x16x32_bf16 v[120:123], v[184:187], v[224:227], v[120:123]
    v_mfma_f32_16x16x32_bf16 v[120:123], v[188:191], v[228:231], v[120:123]
    s_waitcnt lgkmcnt(2)
    v_mfma_f32_16x16x32_bf16 v[124:127], v[184:187], v[232:235], v[124:127]
    ds_read_b128 v[224:227], v248 offset:51200
    v_mfma_f32_16x16x32_bf16 v[124:127], v[188:191], v[236:239], v[124:127]
    ds_read_b128 v[228:231], v249 offset:51200
    v_mfma_f32_16x16x32_bf16 v[92:95], v[176:179], v[232:235], v[92:95]
    v_mfma_f32_16x16x32_bf16 v[92:95], v[180:183], v[236:239], v[92:95]
    v_mfma_f32_16x16x32_bf16 v[60:63], v[168:171], v[232:235], v[60:63]
    v_mfma_f32_16x16x32_bf16 v[60:63], v[172:175], v[236:239], v[60:63]
    v_mfma_f32_16x16x32_bf16 v[28:31], v[160:163], v[232:235], v[28:31]
    v_mfma_f32_16x16x32_bf16 v[28:31], v[164:167], v[236:239], v[28:31]
    s_waitcnt vmcnt(4) lgkmcnt(2)
    v_mfma_f32_16x16x32_bf16 v[0:3], v[192:195], v[240:243], v[0:3]
    ds_read_b128 v[232:235], v248 offset:53248
    v_mfma_f32_16x16x32_bf16 v[0:3], v[196:199], v[244:247], v[0:3]
    ds_read_b128 v[236:239], v249 offset:53248
    v_mfma_f32_16x16x32_bf16 v[32:35], v[200:203], v[240:243], v[32:35]
    v_mfma_f32_16x16x32_bf16 v[32:35], v[204:207], v[244:247], v[32:35]
    s_waitcnt vmcnt(0)
    v_mfma_f32_16x16x32_bf16 v[64:67], v[208:211], v[240:243], v[64:67]
    v_mfma_f32_16x16x32_bf16 v[64:67], v[212:215], v[244:247], v[64:67]
    v_mfma_f32_16x16x32_bf16 v[96:99], v[216:219], v[240:243], v[96:99]
    v_mfma_f32_16x16x32_bf16 v[96:99], v[220:223], v[244:247], v[96:99]
    s_waitcnt lgkmcnt(2)
    v_mfma_f32_16x16x32_bf16 v[100:103], v[216:219], v[224:227], v[100:103]
    ds_read_b128 v[240:243], v248 offset:55296
    v_mfma_f32_16x16x32_bf16 v[100:103], v[220:223], v[228:231], v[100:103]
    ds_read_b128 v[244:247], v249 offset:55296
    v_mfma_f32_16x16x32_bf16 v[68:71], v[208:211], v[224:227], v[68:71]
    v_mfma_f32_16x16x32_bf16 v[68:71], v[212:215], v[228:231], v[68:71]
    v_mfma_f32_16x16x32_bf16 v[36:39], v[200:203], v[224:227], v[36:39]
    v_mfma_f32_16x16x32_bf16 v[36:39], v[204:207], v[228:231], v[36:39]
    v_mfma_f32_16x16x32_bf16 v[4:7], v[192:195], v[224:227], v[4:7]
    v_mfma_f32_16x16x32_bf16 v[4:7], v[196:199], v[228:231], v[4:7]
    s_waitcnt lgkmcnt(2)
    v_mfma_f32_16x16x32_bf16 v[8:11], v[192:195], v[232:235], v[8:11]
    ds_read_b128 v[224:227], v248 offset:57344
    v_mfma_f32_16x16x32_bf16 v[8:11], v[196:199], v[236:239], v[8:11]
    ds_read_b128 v[228:231], v249 offset:57344
    v_mfma_f32_16x16x32_bf16 v[40:43], v[200:203], v[232:235], v[40:43]
    v_mfma_f32_16x16x32_bf16 v[40:43], v[204:207], v[236:239], v[40:43]
    v_mfma_f32_16x16x32_bf16 v[72:75], v[208:211], v[232:235], v[72:75]
    v_mfma_f32_16x16x32_bf16 v[72:75], v[212:215], v[236:239], v[72:75]
    v_mfma_f32_16x16x32_bf16 v[104:107], v[216:219], v[232:235], v[104:107]
    v_mfma_f32_16x16x32_bf16 v[104:107], v[220:223], v[236:239], v[104:107]
    s_waitcnt lgkmcnt(2)
    v_mfma_f32_16x16x32_bf16 v[108:111], v[216:219], v[240:243], v[108:111]
    ds_read_b128 v[232:235], v248 offset:59392
    v_mfma_f32_16x16x32_bf16 v[108:111], v[220:223], v[244:247], v[108:111]
    ds_read_b128 v[236:239], v249 offset:59392
    v_mfma_f32_16x16x32_bf16 v[76:79], v[208:211], v[240:243], v[76:79]
    v_mfma_f32_16x16x32_bf16 v[76:79], v[212:215], v[244:247], v[76:79]
    v_mfma_f32_16x16x32_bf16 v[44:47], v[200:203], v[240:243], v[44:47]
    v_mfma_f32_16x16x32_bf16 v[44:47], v[204:207], v[244:247], v[44:47]
    v_mfma_f32_16x16x32_bf16 v[12:15], v[192:195], v[240:243], v[12:15]
    v_mfma_f32_16x16x32_bf16 v[12:15], v[196:199], v[244:247], v[12:15]
    s_waitcnt lgkmcnt(2)
    v_mfma_f32_16x16x32_bf16 v[16:19], v[192:195], v[224:227], v[16:19]
    ds_read_b128 v[240:243], v248 offset:61440
    v_mfma_f32_16x16x32_bf16 v[16:19], v[196:199], v[228:231], v[16:19]
    ds_read_b128 v[244:247], v249 offset:61440
    v_mfma_f32_16x16x32_bf16 v[48:51], v[200:203], v[224:227], v[48:51]
    v_mfma_f32_16x16x32_bf16 v[48:51], v[204:207], v[228:231], v[48:51]
    v_mfma_f32_16x16x32_bf16 v[80:83], v[208:211], v[224:227], v[80:83]
    v_mfma_f32_16x16x32_bf16 v[80:83], v[212:215], v[228:231], v[80:83]
    v_mfma_f32_16x16x32_bf16 v[112:115], v[216:219], v[224:227], v[112:115]
    v_mfma_f32_16x16x32_bf16 v[112:115], v[220:223], v[228:231], v[112:115]
    s_waitcnt lgkmcnt(2)
    v_mfma_f32_16x16x32_bf16 v[116:119], v[216:219], v[232:235], v[116:119]
    ds_read_b128 v[224:227], v248 offset:63488
    v_mfma_f32_16x16x32_bf16 v[116:119], v[220:223], v[236:239], v[116:119]
    ds_read_b128 v[228:231], v249 offset:63488
    v_mfma_f32_16x16x32_bf16 v[84:87], v[208:211], v[232:235], v[84:87]
    v_mfma_f32_16x16x32_bf16 v[84:87], v[212:215], v[236:239], v[84:87]
    v_add_u32 v248, 0xffff0000, v248
    v_mfma_f32_16x16x32_bf16 v[52:55], v[200:203], v[232:235], v[52:55]
    v_add_u32 v249, 0xffff0000, v249
    v_mfma_f32_16x16x32_bf16 v[52:55], v[204:207], v[236:239], v[52:55]
    v_mfma_f32_16x16x32_bf16 v[20:23], v[192:195], v[232:235], v[20:23]
    v_mfma_f32_16x16x32_bf16 v[20:23], v[196:199], v[236:239], v[20:23]
    s_waitcnt lgkmcnt(2)
    v_mfma_f32_16x16x32_bf16 v[24:27], v[192:195], v[240:243], v[24:27]
    v_mfma_f32_16x16x32_bf16 v[24:27], v[196:199], v[244:247], v[24:27]
    v_mfma_f32_16x16x32_bf16 v[56:59], v[200:203], v[240:243], v[56:59]
    v_mfma_f32_16x16x32_bf16 v[56:59], v[204:207], v[244:247], v[56:59]
    v_mfma_f32_16x16x32_bf16 v[88:91], v[208:211], v[240:243], v[88:91]
    v_mfma_f32_16x16x32_bf16 v[88:91], v[212:215], v[244:247], v[88:91]
    v_mfma_f32_16x16x32_bf16 v[120:123], v[216:219], v[240:243], v[120:123]
    v_mfma_f32_16x16x32_bf16 v[120:123], v[220:223], v[244:247], v[120:123]
    s_waitcnt lgkmcnt(0)
    v_mfma_f32_16x16x32_bf16 v[124:127], v[216:219], v[224:227], v[124:127]
    v_mfma_f32_16x16x32_bf16 v[124:127], v[220:223], v[228:231], v[124:127]
    v_mfma_f32_16x16x32_bf16 v[92:95], v[208:211], v[224:227], v[92:95]
    v_mfma_f32_16x16x32_bf16 v[92:95], v[212:215], v[228:231], v[92:95]
    v_mfma_f32_16x16x32_bf16 v[60:63], v[200:203], v[224:227], v[60:63]
    v_mfma_f32_16x16x32_bf16 v[60:63], v[204:207], v[228:231], v[60:63]
    v_mfma_f32_16x16x32_bf16 v[28:31], v[192:195], v[224:227], v[28:31]
    v_mfma_f32_16x16x32_bf16 v[28:31], v[196:199], v[228:231], v[28:31]
    s_setprio 0
    s_movk_i32 s49, 8192
    s_nop 5
    v_mul_f32 v72, s50, v72
    v_mul_f32 v73, s50, v73
    v_mul_f32 v74, s50, v74
    v_mul_f32 v75, s50, v75
    v_mul_f32 v104, s50, v104
    v_mul_f32 v105, s50, v105
    v_mul_f32 v106, s50, v106
    v_mul_f32 v107, s50, v107
    v_exp_f32 v72, v72
    v_exp_f32 v73, v73
    v_exp_f32 v74, v74
    v_exp_f32 v75, v75
    v_exp_f32 v104, v104
    v_exp_f32 v105, v105
    v_exp_f32 v106, v106
    v_exp_f32 v107, v107
    v_fma_f32 v72, v72, s51, s51
    v_fma_f32 v73, v73, s51, s51
    v_fma_f32 v74, v74, s51, s51
    v_fma_f32 v75, v75, s51, s51
    v_fma_f32 v104, v104, s51, s51
    v_fma_f32 v105, v105, s51, s51
    v_fma_f32 v106, v106, s51, s51
    v_fma_f32 v107, v107, s51, s51
    buffer_load_dwordx4 v[192:195], v252, s[20:23], s49 offen offset:0 sc1
    v_rcp_f32 v72, v72
    v_rcp_f32 v73, v73
    v_rcp_f32 v74, v74
    v_rcp_f32 v75, v75
    v_rcp_f32 v104, v104
    v_rcp_f32 v105, v105
    v_rcp_f32 v106, v106
    v_rcp_f32 v107, v107
    buffer_load_dwordx4 v[196:199], v252, s[20:23], s49 offen offset:64 sc1
    v_mul_f32 v8, v8, v72
    v_mul_f32 v9, v9, v73
    v_mul_f32 v10, v10, v74
    v_mul_f32 v11, v11, v75
    v_mul_f32 v40, v40, v104
    v_mul_f32 v41, v41, v105
    v_mul_f32 v42, v42, v106
    v_mul_f32 v43, v43, v107
    buffer_load_dwordx4 v[200:203], v252, s[20:23], s49 offen offset:128 sc1
    v_mul_f32 v76, s50, v76
    v_mul_f32 v77, s50, v77
    v_mul_f32 v78, s50, v78
    v_mul_f32 v79, s50, v79
    v_mul_f32 v108, s50, v108
    v_mul_f32 v109, s50, v109
    v_mul_f32 v110, s50, v110
    v_mul_f32 v111, s50, v111
    buffer_load_dwordx4 v[204:207], v252, s[20:23], s49 offen offset:192 sc1
    v_exp_f32 v76, v76
    v_exp_f32 v77, v77
    v_exp_f32 v78, v78
    v_exp_f32 v79, v79
    v_exp_f32 v108, v108
    v_exp_f32 v109, v109
    v_exp_f32 v110, v110
    v_exp_f32 v111, v111
    buffer_load_dwordx4 v[208:211], v252, s[20:23], s49 offen offset:1024 sc1
    v_fma_f32 v76, v76, s51, s51
    v_fma_f32 v77, v77, s51, s51
    v_fma_f32 v78, v78, s51, s51
    v_fma_f32 v79, v79, s51, s51
    v_fma_f32 v108, v108, s51, s51
    v_fma_f32 v109, v109, s51, s51
    v_fma_f32 v110, v110, s51, s51
    v_fma_f32 v111, v111, s51, s51
    buffer_load_dwordx4 v[212:215], v252, s[20:23], s49 offen offset:1088 sc1
    v_rcp_f32 v76, v76
    v_rcp_f32 v77, v77
    v_rcp_f32 v78, v78
    v_rcp_f32 v79, v79
    v_rcp_f32 v108, v108
    v_rcp_f32 v109, v109
    v_rcp_f32 v110, v110
    v_rcp_f32 v111, v111
    buffer_load_dwordx4 v[216:219], v252, s[20:23], s49 offen offset:1152 sc1
    v_mul_f32 v12, v12, v76
    v_mul_f32 v13, v13, v77
    v_mul_f32 v14, v14, v78
    v_mul_f32 v15, v15, v79
    v_mul_f32 v44, v44, v108
    v_mul_f32 v45, v45, v109
    v_mul_f32 v46, v46, v110
    v_mul_f32 v47, v47, v111
    buffer_load_dwordx4 v[220:223], v252, s[20:23], s49 offen offset:1216 sc1
    v_mul_f32 v64, s50, v64
    v_mul_f32 v65, s50, v65
    v_mul_f32 v66, s50, v66
    v_mul_f32 v67, s50, v67
    v_mul_f32 v96, s50, v96
    v_mul_f32 v97, s50, v97
    v_mul_f32 v98, s50, v98
    v_mul_f32 v99, s50, v99
    v_exp_f32 v64, v64
    v_exp_f32 v65, v65
    v_exp_f32 v66, v66
    v_exp_f32 v67, v67
    v_exp_f32 v96, v96
    v_exp_f32 v97, v97
    v_exp_f32 v98, v98
    v_exp_f32 v99, v99
    v_fma_f32 v64, v64, s51, s51
    v_fma_f32 v65, v65, s51, s51
    v_fma_f32 v66, v66, s51, s51
    v_fma_f32 v67, v67, s51, s51
    v_fma_f32 v96, v96, s51, s51
    v_fma_f32 v97, v97, s51, s51
    v_fma_f32 v98, v98, s51, s51
    v_fma_f32 v99, v99, s51, s51
    v_rcp_f32 v64, v64
    v_rcp_f32 v65, v65
    v_rcp_f32 v66, v66
    v_rcp_f32 v67, v67
    v_rcp_f32 v96, v96
    v_rcp_f32 v97, v97
    v_rcp_f32 v98, v98
    v_rcp_f32 v99, v99
    v_mul_f32 v0, v0, v64
    v_mul_f32 v1, v1, v65
    v_mul_f32 v2, v2, v66
    v_mul_f32 v3, v3, v67
    v_mul_f32 v32, v32, v96
    v_mul_f32 v33, v33, v97
    v_mul_f32 v34, v34, v98
    v_mul_f32 v35, v35, v99
    v_mul_f32 v68, s50, v68
    v_mul_f32 v69, s50, v69
    v_mul_f32 v70, s50, v70
    v_mul_f32 v71, s50, v71
    v_mul_f32 v100, s50, v100
    v_mul_f32 v101, s50, v101
    v_mul_f32 v102, s50, v102
    v_mul_f32 v103, s50, v103
    v_exp_f32 v68, v68
    v_exp_f32 v69, v69
    v_exp_f32 v70, v70
    v_exp_f32 v71, v71
    v_exp_f32 v100, v100
    v_exp_f32 v101, v101
    v_exp_f32 v102, v102
    v_exp_f32 v103, v103
    v_fma_f32 v68, v68, s51, s51
    v_fma_f32 v69, v69, s51, s51
    v_fma_f32 v70, v70, s51, s51
    v_fma_f32 v71, v71, s51, s51
    v_fma_f32 v100, v100, s51, s51
    v_fma_f32 v101, v101, s51, s51
    v_fma_f32 v102, v102, s51, s51
    v_fma_f32 v103, v103, s51, s51
    v_rcp_f32 v68, v68
    v_rcp_f32 v69, v69
    v_rcp_f32 v70, v70
    v_rcp_f32 v71, v71
    v_rcp_f32 v100, v100
    v_rcp_f32 v101, v101
    v_rcp_f32 v102, v102
    v_rcp_f32 v103, v103
    v_mul_f32 v4, v4, v68
    v_mul_f32 v5, v5, v69
    v_mul_f32 v6, v6, v70
    v_mul_f32 v7, v7, v71
    v_mul_f32 v36, v36, v100
    v_mul_f32 v37, v37, v101
    v_mul_f32 v38, v38, v102
    v_mul_f32 v39, v39, v103
    v_cvt_pk_bf16_f32 v161, v8, v12
    v_cvt_pk_bf16_f32 v167, v9, v13
    v_cvt_pk_bf16_f32 v173, v10, v14
    v_cvt_pk_bf16_f32 v179, v11, v15
    v_cvt_pk_bf16_f32 v185, v40, v44
    v_cvt_pk_bf16_f32 v225, v41, v45
    v_cvt_pk_bf16_f32 v231, v42, v46
    v_cvt_pk_bf16_f32 v237, v43, v47
    v_cvt_pk_bf16_f32 v160, v0, v4
    v_cvt_pk_bf16_f32 v166, v1, v5
    v_cvt_pk_bf16_f32 v172, v2, v6
    v_cvt_pk_bf16_f32 v178, v3, v7
    v_cvt_pk_bf16_f32 v184, v32, v36
    v_cvt_pk_bf16_f32 v224, v33, v37
    v_cvt_pk_bf16_f32 v230, v34, v38
    v_cvt_pk_bf16_f32 v236, v35, v39
    v_min_u32 v72, -2, v161
    v_min_u32 v73, -2, v167
    v_min_u32 v74, -2, v173
    v_min_u32 v75, -2, v179
    v_min_u32 v104, -2, v185
    v_min_u32 v105, -2, v225
    v_min_u32 v106, -2, v231
    v_min_u32 v107, -2, v237
    s_cmp_lg_u32 s34, 4096
    s_cbranch_scc1 L_exp21
    v_min_u32_dpp v72, v160, v253 row_shr:1 row_mask:0xf bank_mask:0xf
    v_min_u32_dpp v73, v166, v253 row_shr:1 row_mask:0xf bank_mask:0xf
    v_min_u32_dpp v74, v172, v253 row_shr:1 row_mask:0xf bank_mask:0xf
    v_min_u32_dpp v75, v178, v253 row_shr:1 row_mask:0xf bank_mask:0xf
    v_min_u32_dpp v104, v184, v253 row_shr:1 row_mask:0xf bank_mask:0xf
    v_min_u32_dpp v105, v224, v253 row_shr:1 row_mask:0xf bank_mask:0xf
    v_min_u32_dpp v106, v230, v253 row_shr:1 row_mask:0xf bank_mask:0xf
    v_min_u32_dpp v107, v236, v253 row_shr:1 row_mask:0xf bank_mask:0xf
L_exp21:
    v_mul_f32 v80, s50, v80
    v_mul_f32 v81, s50, v81
    v_mul_f32 v82, s50, v82
    v_mul_f32 v83, s50, v83
    v_mul_f32 v112, s50, v112
    v_mul_f32 v113, s50, v113
    v_mul_f32 v114, s50, v114
    v_mul_f32 v115, s50, v115
    v_exp_f32 v80, v80
    v_exp_f32 v81, v81
    v_exp_f32 v82, v82
    v_exp_f32 v83, v83
    v_exp_f32 v112, v112
    v_exp_f32 v113, v113
    v_exp_f32 v114, v114
    v_exp_f32 v115, v115
    v_fma_f32 v80, v80, s51, s51
    v_fma_f32 v81, v81, s51, s51
    v_fma_f32 v82, v82, s51, s51
    v_fma_f32 v83, v83, s51, s51
    v_fma_f32 v112, v112, s51, s51
    v_fma_f32 v113, v113, s51, s51
    v_fma_f32 v114, v114, s51, s51
    v_fma_f32 v115, v115, s51, s51
    v_rcp_f32 v80, v80
    v_rcp_f32 v81, v81
    v_rcp_f32 v82, v82
    v_rcp_f32 v83, v83
    v_rcp_f32 v112, v112
    v_rcp_f32 v113, v113
    v_rcp_f32 v114, v114
    v_rcp_f32 v115, v115
    v_mul_f32 v16, v16, v80
    v_mul_f32 v17, v17, v81
    v_mul_f32 v18, v18, v82
    v_mul_f32 v19, v19, v83
    v_mul_f32 v48, v48, v112
    v_mul_f32 v49, v49, v113
    v_mul_f32 v50, v50, v114
    v_mul_f32 v51, v51, v115
    buffer_store_dwordx4 v[72:75], v254, s[32:35], s38 offen offset:512 sc0 sc1
    buffer_store_dwordx4 v[104:107], v254, s[32:35], s38 offen offset:576 sc0 sc1
    v_mul_f32 v84, s50, v84
    v_mul_f32 v85, s50, v85
    v_mul_f32 v86, s50, v86
    v_mul_f32 v87, s50, v87
    v_mul_f32 v116, s50, v116
    v_mul_f32 v117, s50, v117
    v_mul_f32 v118, s50, v118
    v_mul_f32 v119, s50, v119
    v_exp_f32 v84, v84
    v_exp_f32 v85, v85
    v_exp_f32 v86, v86
    v_exp_f32 v87, v87
    v_exp_f32 v116, v116
    v_exp_f32 v117, v117
    v_exp_f32 v118, v118
    v_exp_f32 v119, v119
    v_fma_f32 v84, v84, s51, s51
    v_fma_f32 v85, v85, s51, s51
    v_fma_f32 v86, v86, s51, s51
    v_fma_f32 v87, v87, s51, s51
    v_fma_f32 v116, v116, s51, s51
    v_fma_f32 v117, v117, s51, s51
    v_fma_f32 v118, v118, s51, s51
    v_fma_f32 v119, v119, s51, s51
    v_rcp_f32 v84, v84
    v_rcp_f32 v85, v85
    v_rcp_f32 v86, v86
    v_rcp_f32 v87, v87
    v_rcp_f32 v116, v116
    v_rcp_f32 v117, v117
    v_rcp_f32 v118, v118
    v_rcp_f32 v119, v119
    v_mul_f32 v20, v20, v84
    v_mul_f32 v21, v21, v85
    v_mul_f32 v22, v22, v86
    v_mul_f32 v23, v23, v87
    v_mul_f32 v52, v52, v116
    v_mul_f32 v53, v53, v117
    v_mul_f32 v54, v54, v118
    v_mul_f32 v55, v55, v119
    v_mul_f32 v88, s50, v88
    v_mul_f32 v89, s50, v89
    v_mul_f32 v90, s50, v90
    v_mul_f32 v91, s50, v91
    v_mul_f32 v120, s50, v120
    v_mul_f32 v121, s50, v121
    v_mul_f32 v122, s50, v122
    v_mul_f32 v123, s50, v123
    v_exp_f32 v88, v88
    v_exp_f32 v89, v89
    v_exp_f32 v90, v90
    v_exp_f32 v91, v91
    v_exp_f32 v120, v120
    v_exp_f32 v121, v121
    v_exp_f32 v122, v122
    v_exp_f32 v123, v123
    v_fma_f32 v88, v88, s51, s51
    v_fma_f32 v89, v89, s51, s51
    v_fma_f32 v90, v90, s51, s51
    v_fma_f32 v91, v91, s51, s51
    v_fma_f32 v120, v120, s51, s51
    v_fma_f32 v121, v121, s51, s51
    v_fma_f32 v122, v122, s51, s51
    v_fma_f32 v123, v123, s51, s51
    v_rcp_f32 v88, v88
    v_rcp_f32 v89, v89
    v_rcp_f32 v90, v90
    v_rcp_f32 v91, v91
    v_rcp_f32 v120, v120
    v_rcp_f32 v121, v121
    v_rcp_f32 v122, v122
    v_rcp_f32 v123, v123
    v_mul_f32 v24, v24, v88
    v_mul_f32 v25, v25, v89
    v_mul_f32 v26, v26, v90
    v_mul_f32 v27, v27, v91
    v_mul_f32 v56, v56, v120
    v_mul_f32 v57, v57, v121
    v_mul_f32 v58, v58, v122
    v_mul_f32 v59, v59, v123
    v_mul_f32 v92, s50, v92
    v_mul_f32 v93, s50, v93
    v_mul_f32 v94, s50, v94
    v_mul_f32 v95, s50, v95
    v_mul_f32 v124, s50, v124
    v_mul_f32 v125, s50, v125
    v_mul_f32 v126, s50, v126
    v_mul_f32 v127, s50, v127
    v_exp_f32 v92, v92
    v_exp_f32 v93, v93
    v_exp_f32 v94, v94
    v_exp_f32 v95, v95
    v_exp_f32 v124, v124
    v_exp_f32 v125, v125
    v_exp_f32 v126, v126
    v_exp_f32 v127, v127
    v_fma_f32 v92, v92, s51, s51
    v_fma_f32 v93, v93, s51, s51
    v_fma_f32 v94, v94, s51, s51
    v_fma_f32 v95, v95, s51, s51
    v_fma_f32 v124, v124, s51, s51
    v_fma_f32 v125, v125, s51, s51
    v_fma_f32 v126, v126, s51, s51
    v_fma_f32 v127, v127, s51, s51
    v_rcp_f32 v92, v92
    v_rcp_f32 v93, v93
    v_rcp_f32 v94, v94
    v_rcp_f32 v95, v95
    v_rcp_f32 v124, v124
    v_rcp_f32 v125, v125
    v_rcp_f32 v126, v126
    v_rcp_f32 v127, v127
    v_mul_f32 v28, v28, v92
    v_mul_f32 v29, v29, v93
    v_mul_f32 v30, v30, v94
    v_mul_f32 v31, v31, v95
    v_mul_f32 v60, v60, v124
    v_mul_f32 v61, v61, v125
    v_mul_f32 v62, v62, v126
    v_mul_f32 v63, v63, v127
    v_cvt_pk_bf16_f32 v162, v16, v20
    v_cvt_pk_bf16_f32 v163, v24, v28
    v_cvt_pk_bf16_f32 v168, v17, v21
    v_cvt_pk_bf16_f32 v169, v25, v29
    s_waitcnt vmcnt(2)
    s_setprio 3
    v_mfma_f32_16x16x32_bf16 v[64:67], v[192:195], v[160:163], 0
    v_cvt_pk_bf16_f32 v174, v18, v22
    v_cvt_pk_bf16_f32 v175, v26, v30
    v_mfma_f32_16x16x32_bf16 v[72:75], v[196:199], v[166:169], 0
    v_cvt_pk_bf16_f32 v180, v19, v23
    v_cvt_pk_bf16_f32 v181, v27, v31
    v_mfma_f32_16x16x32_bf16 v[80:83], v[200:203], v[172:175], 0
    v_cvt_pk_bf16_f32 v186, v48, v52
    v_cvt_pk_bf16_f32 v187, v56, v60
    v_mfma_f32_16x16x32_bf16 v[88:91], v[204:207], v[178:181], 0
    v_cvt_pk_bf16_f32 v226, v49, v53
    v_cvt_pk_bf16_f32 v227, v57, v61
    v_mfma_f32_16x16x32_bf16 v[96:99], v[208:211], v[184:187], 0
    v_cvt_pk_bf16_f32 v232, v50, v54
    v_cvt_pk_bf16_f32 v233, v58, v62
    v_mfma_f32_16x16x32_bf16 v[104:107], v[212:215], v[224:227], 0
    v_cvt_pk_bf16_f32 v238, v51, v55
    v_cvt_pk_bf16_f32 v239, v59, v63
    s_nop 0
    v_mfma_f32_16x16x32_bf16 v[112:115], v[216:219], v[230:233], 0
    v_mfma_f32_16x16x32_bf16 v[120:123], v[220:223], v[236:239], 0
    s_setprio 0
    v_exp_f32 v32, v64
    v_exp_f32 v33, v72
    v_exp_f32 v34, v80
    v_exp_f32 v35, v88
    v_exp_f32 v36, v96
    v_exp_f32 v37, v104
    v_exp_f32 v38, v112
    v_exp_f32 v39, v120
    v_fma_f32 v32, v32, s50, s50
    v_fma_f32 v33, v33, s50, s50
    v_fma_f32 v34, v34, s50, s50
    v_fma_f32 v35, v35, s50, s50
    v_fma_f32 v36, v36, s50, s50
    v_fma_f32 v37, v37, s50, s50
    v_fma_f32 v38, v38, s50, s50
    v_fma_f32 v39, v39, s50, s50
    v_rcp_f32 v32, v32
    v_rcp_f32 v33, v33
    v_rcp_f32 v34, v34
    v_rcp_f32 v35, v35
    v_rcp_f32 v36, v36
    v_rcp_f32 v37, v37
    v_rcp_f32 v38, v38
    v_rcp_f32 v39, v39
    v_mul_f32 v64, v64, v32
    v_mul_f32 v72, v72, v33
    v_mul_f32 v80, v80, v34
    v_mul_f32 v88, v88, v35
    v_mul_f32 v96, v96, v36
    v_mul_f32 v104, v104, v37
    v_mul_f32 v112, v112, v38
    v_mul_f32 v120, v120, v39
    v_cvt_pk_bf16_f32 v0, v64, v72
    v_cvt_pk_bf16_f32 v1, v80, v88
    v_cvt_pk_bf16_f32 v2, v96, v104
    v_cvt_pk_bf16_f32 v3, v112, v120
    buffer_load_dwordx4 v[40:43], v251, s[24:27], s38 offen offset:512 sc0 sc1
    buffer_load_dwordx4 v[44:47], v251, s[24:27], s38 offen offset:576 sc0 sc1
    v_exp_f32 v32, v65
    v_exp_f32 v33, v73
    v_exp_f32 v34, v81
    v_exp_f32 v35, v89
    v_exp_f32 v36, v97
    v_exp_f32 v37, v105
    v_exp_f32 v38, v113
    v_exp_f32 v39, v121
    ds_write_b128 v250, v[0:3] offset:32768
    v_fma_f32 v32, v32, s50, s50
    v_fma_f32 v33, v33, s50, s50
    v_fma_f32 v34, v34, s50, s50
    v_fma_f32 v35, v35, s50, s50
    v_fma_f32 v36, v36, s50, s50
    v_fma_f32 v37, v37, s50, s50
    v_fma_f32 v38, v38, s50, s50
    v_fma_f32 v39, v39, s50, s50
    v_rcp_f32 v32, v32
    v_rcp_f32 v33, v33
    v_rcp_f32 v34, v34
    v_rcp_f32 v35, v35
    v_rcp_f32 v36, v36
    v_rcp_f32 v37, v37
    v_rcp_f32 v38, v38
    v_rcp_f32 v39, v39
    v_mul_f32 v65, v65, v32
    v_mul_f32 v73, v73, v33
    v_mul_f32 v81, v81, v34
    v_mul_f32 v89, v89, v35
    v_mul_f32 v97, v97, v36
    v_mul_f32 v105, v105, v37
    v_mul_f32 v113, v113, v38
    v_mul_f32 v121, v121, v39
    v_cvt_pk_bf16_f32 v4, v65, v73
    v_cvt_pk_bf16_f32 v5, v81, v89
    v_cvt_pk_bf16_f32 v6, v97, v105
    v_cvt_pk_bf16_f32 v7, v113, v121
    v_exp_f32 v32, v66
    v_exp_f32 v33, v74
    v_exp_f32 v34, v82
    v_exp_f32 v35, v90
    v_exp_f32 v36, v98
    v_exp_f32 v37, v106
    v_exp_f32 v38, v114
    v_exp_f32 v39, v122
    ds_write_b128 v250, v[4:7] offset:34816
    v_fma_f32 v32, v32, s50, s50
    v_fma_f32 v33, v33, s50, s50
    v_fma_f32 v34, v34, s50, s50
    v_fma_f32 v35, v35, s50, s50
    v_fma_f32 v36, v36, s50, s50
    v_fma_f32 v37, v37, s50, s50
    v_fma_f32 v38, v38, s50, s50
    v_fma_f32 v39, v39, s50, s50
    v_rcp_f32 v32, v32
    v_rcp_f32 v33, v33
    v_rcp_f32 v34, v34
    v_rcp_f32 v35, v35
    v_rcp_f32 v36, v36
    v_rcp_f32 v37, v37
    v_rcp_f32 v38, v38
    v_rcp_f32 v39, v39
    v_mul_f32 v66, v66, v32
    v_mul_f32 v74, v74, v33
    v_mul_f32 v82, v82, v34
    v_mul_f32 v90, v90, v35
    v_mul_f32 v98, v98, v36
    v_mul_f32 v106, v106, v37
    v_mul_f32 v114, v114, v38
    v_mul_f32 v122, v122, v39
    v_cvt_pk_bf16_f32 v8, v66, v74
    v_cvt_pk_bf16_f32 v9, v82, v90
    v_cvt_pk_bf16_f32 v10, v98, v106
    v_cvt_pk_bf16_f32 v11, v114, v122
    v_mov_b32_dpp v165, v161 row_shl:1 row_mask:0xf bank_mask:0xf bound_ctrl:1
    v_mov_b32_dpp v171, v167 row_shl:1 row_mask:0xf bank_mask:0xf bound_ctrl:1
    v_mov_b32_dpp v177, v173 row_shl:1 row_mask:0xf bank_mask:0xf bound_ctrl:1
    v_mov_b32_dpp v183, v179 row_shl:1 row_mask:0xf bank_mask:0xf bound_ctrl:1
    v_mov_b32_dpp v189, v185 row_shl:1 row_mask:0xf bank_mask:0xf bound_ctrl:1
    v_mov_b32_dpp v229, v225 row_shl:1 row_mask:0xf bank_mask:0xf bound_ctrl:1
    v_mov_b32_dpp v235, v231 row_shl:1 row_mask:0xf bank_mask:0xf bound_ctrl:1
    v_mov_b32_dpp v241, v237 row_shl:1 row_mask:0xf bank_mask:0xf bound_ctrl:1
    ds_write_b128 v250, v[8:11] offset:36864
    s_mov_b32 s48, 4000000
    s_waitcnt vmcnt(0)
L_poll1:
    v_max3_u32 v32, v40, v41, v42
    v_max3_u32 v33, v43, v44, v45
    v_max3_u32 v32, v32, v46, v47
    v_max_u32 v32, v32, v33
    v_cmp_eq_u32 vcc, -1, v32
    s_sub_u32 s48, s48, 1
    s_cbranch_scc1 L_poll1_ok
    s_cbranch_vccz L_poll1_ok
    buffer_load_dwordx4 v[40:43], v251, s[24:27], s38 offen offset:512 sc0 sc1
    buffer_load_dwordx4 v[44:47], v251, s[24:27], s38 offen offset:576 sc0 sc1
    s_waitcnt vmcnt(0)
    s_branch L_poll1
L_poll1_ok:
    s_mov_b32 vcc_lo, 2147516416
    s_mov_b32 vcc_hi, 2147516416
    s_cmp_lg_u32 s26, 4096
    s_cbranch_scc1 L_imp21
    v_mov_b32_dpp v165, v40 row_shr:15 row_mask:0xf bank_mask:0xf
    v_mov_b32_dpp v171, v41 row_shr:15 row_mask:0xf bank_mask:0xf
    v_mov_b32_dpp v177, v42 row_shr:15 row_mask:0xf bank_mask:0xf
    v_mov_b32_dpp v183, v43 row_shr:15 row_mask:0xf bank_mask:0xf
    v_mov_b32_dpp v189, v44 row_shr:15 row_mask:0xf bank_mask:0xf
    v_mov_b32_dpp v229, v45 row_shr:15 row_mask:0xf bank_mask:0xf
    v_mov_b32_dpp v235, v46 row_shr:15 row_mask:0xf bank_mask:0xf
    v_mov_b32_dpp v241, v47 row_shr:15 row_mask:0xf bank_mask:0xf
L_imp21:
    v_cndmask_b32_dpp v164, v160, v40, vcc row_shl:1 row_mask:0xf bank_mask:0xf bound_ctrl:1
    v_cndmask_b32_dpp v170, v166, v41, vcc row_shl:1 row_mask:0xf bank_mask:0xf bound_ctrl:1
    v_cndmask_b32_dpp v176, v172, v42, vcc row_shl:1 row_mask:0xf bank_mask:0xf bound_ctrl:1
    v_cndmask_b32_dpp v182, v178, v43, vcc row_shl:1 row_mask:0xf bank_mask:0xf bound_ctrl:1
    v_cndmask_b32_dpp v188, v184, v44, vcc row_shl:1 row_mask:0xf bank_mask:0xf bound_ctrl:1
    v_cndmask_b32_dpp v228, v224, v45, vcc row_shl:1 row_mask:0xf bank_mask:0xf bound_ctrl:1
    v_cndmask_b32_dpp v234, v230, v46, vcc row_shl:1 row_mask:0xf bank_mask:0xf bound_ctrl:1
    v_cndmask_b32_dpp v240, v236, v47, vcc row_shl:1 row_mask:0xf bank_mask:0xf bound_ctrl:1
    s_setprio 3
    v_mfma_f32_16x16x32_bf16 v[68:71], v[192:195], v[162:165], 0
    v_exp_f32 v32, v67
    v_mfma_f32_16x16x32_bf16 v[76:79], v[196:199], v[168:171], 0
    v_exp_f32 v33, v75
    v_mfma_f32_16x16x32_bf16 v[84:87], v[200:203], v[174:177], 0
    v_exp_f32 v34, v83
    v_mfma_f32_16x16x32_bf16 v[92:95], v[204:207], v[180:183], 0
    v_exp_f32 v35, v91
    v_mfma_f32_16x16x32_bf16 v[100:103], v[208:211], v[186:189], 0
    v_exp_f32 v36, v99
    v_mfma_f32_16x16x32_bf16 v[108:111], v[212:215], v[226:229], 0
    v_exp_f32 v37, v107
    v_mfma_f32_16x16x32_bf16 v[116:119], v[216:219], v[232:235], 0
    v_exp_f32 v38, v115
    v_mfma_f32_16x16x32_bf16 v[124:127], v[220:223], v[238:241], 0
    v_exp_f32 v39, v123
    s_setprio 0
    v_fma_f32 v32, v32, s50, s50
    v_fma_f32 v33, v33, s50, s50
    v_fma_f32 v34, v34, s50, s50
    v_fma_f32 v35, v35, s50, s50
    v_fma_f32 v36, v36, s50, s50
    v_fma_f32 v37, v37, s50, s50
    v_fma_f32 v38, v38, s50, s50
    v_fma_f32 v39, v39, s50, s50
    v_rcp_f32 v32, v32
    v_rcp_f32 v33, v33
    v_rcp_f32 v34, v34
    v_rcp_f32 v35, v35
    v_rcp_f32 v36, v36
    v_rcp_f32 v37, v37
    v_rcp_f32 v38, v38
    v_rcp_f32 v39, v39
    v_mul_f32 v67, v67, v32
    v_mul_f32 v75, v75, v33
    v_mul_f32 v83, v83, v34
    v_mul_f32 v91, v91, v35
    v_mul_f32 v99, v99, v36
    v_mul_f32 v107, v107, v37
    v_mul_f32 v115, v115, v38
    v_mul_f32 v123, v123, v39
    v_cvt_pk_bf16_f32 v12, v67, v75
    v_cvt_pk_bf16_f32 v13, v83, v91
    v_cvt_pk_bf16_f32 v14, v99, v107
    v_cvt_pk_bf16_f32 v15, v115, v123
    v_exp_f32 v32, v68
    v_exp_f32 v33, v76
    v_exp_f32 v34, v84
    v_exp_f32 v35, v92
    v_exp_f32 v36, v100
    v_exp_f32 v37, v108
    v_exp_f32 v38, v116
    v_exp_f32 v39, v124
    ds_write_b128 v250, v[12:15] offset:38912
    v_fma_f32 v32, v32, s50, s50
    v_fma_f32 v33, v33, s50, s50
    v_fma_f32 v34, v34, s50, s50
    v_fma_f32 v35, v35, s50, s50
    v_fma_f32 v36, v36, s50, s50
    v_fma_f32 v37, v37, s50, s50
    v_fma_f32 v38, v38, s50, s50
    v_fma_f32 v39, v39, s50, s50
    v_rcp_f32 v32, v32
    v_rcp_f32 v33, v33
    v_rcp_f32 v34, v34
    v_rcp_f32 v35, v35
    v_rcp_f32 v36, v36
    v_rcp_f32 v37, v37
    v_rcp_f32 v38, v38
    v_rcp_f32 v39, v39
    v_mul_f32 v68, v68, v32
    v_mul_f32 v76, v76, v33
    v_mul_f32 v84, v84, v34
    v_mul_f32 v92, v92, v35
    v_mul_f32 v100, v100, v36
    v_mul_f32 v108, v108, v37
    v_mul_f32 v116, v116, v38
    v_mul_f32 v124, v124, v39
    v_cvt_pk_bf16_f32 v16, v68, v76
    v_cvt_pk_bf16_f32 v17, v84, v92
    v_cvt_pk_bf16_f32 v18, v100, v108
    v_cvt_pk_bf16_f32 v19, v116, v124
    v_exp_f32 v32, v69
    v_exp_f32 v33, v77
    v_exp_f32 v34, v85
    v_exp_f32 v35, v93
    v_exp_f32 v36, v101
    v_exp_f32 v37, v109
    v_exp_f32 v38, v117
    v_exp_f32 v39, v125
    ds_write_b128 v250, v[16:19] offset:40960
    v_fma_f32 v32, v32, s50, s50
    v_fma_f32 v33, v33, s50, s50
    v_fma_f32 v34, v34, s50, s50
    v_fma_f32 v35, v35, s50, s50
    v_fma_f32 v36, v36, s50, s50
    v_fma_f32 v37, v37, s50, s50
    v_fma_f32 v38, v38, s50, s50
    v_fma_f32 v39, v39, s50, s50
    v_rcp_f32 v32, v32
    v_rcp_f32 v33, v33
    v_rcp_f32 v34, v34
    v_rcp_f32 v35, v35
    v_rcp_f32 v36, v36
    v_rcp_f32 v37, v37
    v_rcp_f32 v38, v38
    v_rcp_f32 v39, v39
    v_mul_f32 v69, v69, v32
    v_mul_f32 v77, v77, v33
    v_mul_f32 v85, v85, v34
    v_mul_f32 v93, v93, v35
    v_mul_f32 v101, v101, v36
    v_mul_f32 v109, v109, v37
    v_mul_f32 v117, v117, v38
    v_mul_f32 v125, v125, v39
    v_cvt_pk_bf16_f32 v20, v69, v77
    v_cvt_pk_bf16_f32 v21, v85, v93
    v_cvt_pk_bf16_f32 v22, v101, v109
    v_cvt_pk_bf16_f32 v23, v117, v125
    s_setprio 1
    v_exp_f32 v32, v70
    v_exp_f32 v33, v78
    s_mov_b32 s46, 524288
    v_exp_f32 v34, v86
    v_exp_f32 v35, v94
    s_mov_b32 s47, 528384
    v_exp_f32 v36, v102
    v_exp_f32 v37, v110
    buffer_load_dwordx4 v[160:163], v250, s[60:63], s46 offen offset:0 sc1
    v_exp_f32 v38, v118
    v_exp_f32 v39, v126
    ds_write_b128 v250, v[20:23] offset:43008
    v_fma_f32 v32, v32, s50, s50
    v_fma_f32 v33, v33, s50, s50
    v_fma_f32 v34, v34, s50, s50
    v_fma_f32 v35, v35, s50, s50
    buffer_load_dwordx4 v[164:167], v250, s[60:63], s46 offen offset:1024 sc1
    v_fma_f32 v36, v36, s50, s50
    v_fma_f32 v37, v37, s50, s50
    v_fma_f32 v38, v38, s50, s50
    v_fma_f32 v39, v39, s50, s50
    v_rcp_f32 v32, v32
    v_rcp_f32 v33, v33
    buffer_load_dwordx4 v[168:171], v250, s[60:63], s46 offen offset:2048 sc1
    v_rcp_f32 v34, v34
    v_rcp_f32 v35, v35
    v_rcp_f32 v36, v36
    v_rcp_f32 v37, v37
    v_rcp_f32 v38, v38
    v_rcp_f32 v39, v39
    buffer_load_dwordx4 v[172:175], v250, s[60:63], s46 offen offset:3072 sc1
    v_mul_f32 v70, v70, v32
    v_mul_f32 v78, v78, v33
    v_mul_f32 v86, v86, v34
    v_mul_f32 v94, v94, v35
    v_mul_f32 v102, v102, v36
    v_mul_f32 v110, v110, v37
    buffer_load_dwordx4 v[176:179], v250, s[60:63], s47 offen offset:0 sc1
    v_mul_f32 v118, v118, v38
    v_mul_f32 v126, v126, v39
    v_cvt_pk_bf16_f32 v24, v70, v78
    v_cvt_pk_bf16_f32 v25, v86, v94
    v_cvt_pk_bf16_f32 v26, v102, v110
    v_cvt_pk_bf16_f32 v27, v118, v126
    buffer_load_dwordx4 v[180:183], v250, s[60:63], s47 offen offset:1024 sc1
    v_exp_f32 v32, v71
    v_exp_f32 v33, v79
    v_exp_f32 v34, v87
    v_exp_f32 v35, v95
    v_exp_f32 v36, v103
    v_exp_f32 v37, v111
    buffer_load_dwordx4 v[184:187], v250, s[60:63], s47 offen offset:2048 sc1
    v_exp_f32 v38, v119
    v_exp_f32 v39, v127
    ds_write_b128 v250, v[24:27] offset:45056
    v_fma_f32 v32, v32, s50, s50
    v_fma_f32 v33, v33, s50, s50
    v_fma_f32 v34, v34, s50, s50
    v_fma_f32 v35, v35, s50, s50
    buffer_load_dwordx4 v[188:191], v250, s[60:63], s47 offen offset:3072 sc1
    v_fma_f32 v36, v36, s50, s50
    v_fma_f32 v37, v37, s50, s50
    v_fma_f32 v38, v38, s50, s50
    v_fma_f32 v39, v39, s50, s50
    v_rcp_f32 v32, v32
    v_rcp_f32 v33, v33
    s_mov_b32 s46, 532480
    v_rcp_f32 v34, v34
    v_rcp_f32 v35, v35
    s_mov_b32 s47, 536576
    v_rcp_f32 v36, v36
    v_rcp_f32 v37, v37
    ds_read_b128 v[224:227], v248 offset:0
    v_rcp_f32 v38, v38
    v_rcp_f32 v39, v39
    ds_read_b128 v[228:231], v249 offset:0
    v_mul_f32 v71, v71, v32
    v_mul_f32 v79, v79, v33
    ds_read_b128 v[232:235], v248 offset:2048
    v_mul_f32 v87, v87, v34
    v_mul_f32 v95, v95, v35
    ds_read_b128 v[236:239], v249 offset:2048
    v_mul_f32 v103, v103, v36
    v_mul_f32 v111, v111, v37
    v_mul_f32 v119, v119, v38
    v_mul_f32 v127, v127, v39
    v_cvt_pk_bf16_f32 v28, v71, v79
    v_cvt_pk_bf16_f32 v29, v87, v95
    v_cvt_pk_bf16_f32 v30, v103, v111
    v_cvt_pk_bf16_f32 v31, v119, v127
    ds_write_b128 v250, v[28:31] offset:47104
    s_waitcnt lgkmcnt(0)
    s_setprio 1
    s_waitcnt vmcnt(7)
    v_mfma_f32_16x16x32_bf16 v[0:3], v[160:163], v[224:227], 0
    ds_read_b128 v[240:243], v248 offset:4096
    s_waitcnt vmcnt(6)
    v_mfma_f32_16x16x32_bf16 v[0:3], v[164:167], v[228:231], v[0:3]
    ds_read_b128 v[244:247], v249 offset:4096
    s_waitcnt vmcnt(5)
    v_mfma_f32_16x16x32_bf16 v[32:35], v[168:171], v[224:227], 0
    buffer_load_dwordx4 v[192:195], v250, s[60:63], s46 offen offset:0 sc1
    s_waitcnt vmcnt(5)
    v_mfma_f32_16x16x32_bf16 v[32:35], v[172:175], v[228:231], v[32:35]
    s_waitcnt vmcnt(1)
    v_mfma_f32_16x16x32_bf16 v[64:67], v[176:179], v[224:227], 0
    v_mfma_f32_16x16x32_bf16 v[64:67], v[180:183], v[228:231], v[64:67]
    buffer_load_dwordx4 v[196:199], v250, s[60:63], s46 offen offset:1024 sc1
    v_mfma_f32_16x16x32_bf16 v[96:99], v[184:187], v[224:227], 0
    v_mfma_f32_16x16x32_bf16 v[96:99], v[188:191], v[228:231], v[96:99]
    v_mfma_f32_16x16x32_bf16 v[100:103], v[184:187], v[232:235], 0
    ds_read_b128 v[224:227], v248 offset:6144
    v_mfma_f32_16x16x32_bf16 v[100:103], v[188:191], v[236:239], v[100:103]
    ds_read_b128 v[228:231], v249 offset:6144
    v_mfma_f32_16x16x32_bf16 v[68:71], v[176:179], v[232:235], 0
    buffer_load_dwordx4 v[200:203], v250, s[60:63], s46 offen offset:2048 sc1
    v_mfma_f32_16x16x32_bf16 v[68:71], v[180:183], v[236:239], v[68:71]
    v_mfma_f32_16x16x32_bf16 v[36:39], v[168:171], v[232:235], 0
    v_mfma_f32_16x16x32_bf16 v[36:39], v[172:175], v[236:239], v[36:39]
    buffer_load_dwordx4 v[204:207], v250, s[60:63], s46 offen offset:3072 sc1
    v_mfma_f32_16x16x32_bf16 v[4:7], v[160:163], v[232:235], 0
    v_mfma_f32_16x16x32_bf16 v[4:7], v[164:167], v[236:239], v[4:7]
    s_waitcnt lgkmcnt(2)
    v_mfma_f32_16x16x32_bf16 v[8:11], v[160:163], v[240:243], 0
    ds_read_b128 v[232:235], v248 offset:8192
    v_mfma_f32_16x16x32_bf16 v[8:11], v[164:167], v[244:247], v[8:11]
    ds_read_b128 v[236:239], v249 offset:8192
    v_mfma_f32_16x16x32_bf16 v[40:43], v[168:171], v[240:243], 0
    buffer_load_dwordx4 v[208:211], v250, s[60:63], s47 offen offset:0 sc1
    v_mfma_f32_16x16x32_bf16 v[40:43], v[172:175], v[244:247], v[40:43]
    v_mfma_f32_16x16x32_bf16 v[72:75], v[176:179], v[240:243], 0
    v_mfma_f32_16x16x32_bf16 v[72:75], v[180:183], v[244:247], v[72:75]
    buffer_load_dwordx4 v[212:215], v250, s[60:63], s47 offen offset:1024 sc1
    v_mfma_f32_16x16x32_bf16 v[104:107], v[184:187], v[240:243], 0
    v_mfma_f32_16x16x32_bf16 v[104:107], v[188:191], v[244:247], v[104:107]
    s_waitcnt lgkmcnt(2)
    v_mfma_f32_16x16x32_bf16 v[108:111], v[184:187], v[224:227], 0
    ds_read_b128 v[240:243], v248 offset:10240
    v_mfma_f32_16x16x32_bf16 v[108:111], v[188:191], v[228:231], v[108:111]
    ds_read_b128 v[244:247], v249 offset:10240
    v_mfma_f32_16x16x32_bf16 v[76:79], v[176:179], v[224:227], 0
    buffer_load_dwordx4 v[216:219], v250, s[60:63], s47 offen offset:2048 sc1
    v_mfma_f32_16x16x32_bf16 v[76:79], v[180:183], v[228:231], v[76:79]
    v_mfma_f32_16x16x32_bf16 v[44:47], v[168:171], v[224:227], 0
    v_mfma_f32_16x16x32_bf16 v[44:47], v[172:175], v[228:231], v[44:47]
    buffer_load_dwordx4 v[220:223], v250, s[60:63], s47 offen offset:3072 sc1
    v_mfma_f32_16x16x32_bf16 v[12:15], v[160:163], v[224:227], 0
    v_mfma_f32_16x16x32_bf16 v[12:15], v[164:167], v[228:231], v[12:15]
    s_waitcnt lgkmcnt(2)
    v_mfma_f32_16x16x32_bf16 v[16:19], v[160:163], v[232:235], 0
    ds_read_b128 v[224:227], v248 offset:12288
    v_mfma_f32_16x16x32_bf16 v[16:19], v[164:167], v[236:239], v[16:19]
    ds_read_b128 v[228:231], v249 offset:12288
    v_mfma_f32_16x16x32_bf16 v[48:51], v[168:171], v[232:235], 0
    v_mfma_f32_16x16x32_bf16 v[48:51], v[172:175], v[236:239], v[48:51]
    v_mfma_f32_16x16x32_bf16 v[80:83], v[176:179], v[232:235], 0
    v_mfma_f32_16x16x32_bf16 v[80:83], v[180:183], v[236:239], v[80:83]
    v_mfma_f32_16x16x32_bf16 v[112:115], v[184:187], v[232:235], 0
    v_mfma_f32_16x16x32_bf16 v[112:115], v[188:191], v[236:239], v[112:115]
    s_waitcnt lgkmcnt(2)
    v_mfma_f32_16x16x32_bf16 v[116:119], v[184:187], v[240:243], 0
    ds_read_b128 v[232:235], v248 offset:14336
    v_mfma_f32_16x16x32_bf16 v[116:119], v[188:191], v[244:247], v[116:119]
    ds_read_b128 v[236:239], v249 offset:14336
    v_mfma_f32_16x16x32_bf16 v[84:87], v[176:179], v[240:243], 0
    v_mfma_f32_16x16x32_bf16 v[84:87], v[180:183], v[244:247], v[84:87]
    v_mfma_f32_16x16x32_bf16 v[52:55], v[168:171], v[240:243], 0
    v_mfma_f32_16x16x32_bf16 v[52:55], v[172:175], v[244:247], v[52:55]
    v_mfma_f32_16x16x32_bf16 v[20:23], v[160:163], v[240:243], 0
    v_mfma_f32_16x16x32_bf16 v[20:23], v[164:167], v[244:247], v[20:23]
    s_waitcnt lgkmcnt(2)
    v_mfma_f32_16x16x32_bf16 v[24:27], v[160:163], v[224:227], 0
    ds_read_b128 v[240:243], v248 offset:16384
    v_mfma_f32_16x16x32_bf16 v[24:27], v[164:167], v[228:231], v[24:27]
    ds_read_b128 v[244:247], v249 offset:16384
    v_mfma_f32_16x16x32_bf16 v[56:59], v[168:171], v[224:227], 0
    v_mfma_f32_16x16x32_bf16 v[56:59], v[172:175], v[228:231], v[56:59]
    v_mfma_f32_16x16x32_bf16 v[88:91], v[176:179], v[224:227], 0
    v_mfma_f32_16x16x32_bf16 v[88:91], v[180:183], v[228:231], v[88:91]
    v_mfma_f32_16x16x32_bf16 v[120:123], v[184:187], v[224:227], 0
    v_mfma_f32_16x16x32_bf16 v[120:123], v[188:191], v[228:231], v[120:123]
    s_waitcnt lgkmcnt(2)
    v_mfma_f32_16x16x32_bf16 v[124:127], v[184:187], v[232:235], 0
    ds_read_b128 v[224:227], v248 offset:18432
    v_mfma_f32_16x16x32_bf16 v[124:127], v[188:191], v[236:239], v[124:127]
    ds_read_b128 v[228:231], v249 offset:18432
    v_mfma_f32_16x16x32_bf16 v[92:95], v[176:179], v[232:235], 0
    v_mfma_f32_16x16x32_bf16 v[92:95], v[180:183], v[236:239], v[92:95]
    s_mov_b32 s46, 540672
    v_mfma_f32_16x16x32_bf16 v[60:63], v[168:171], v[232:235], 0
    s_mov_b32 s47, 544768
    v_mfma_f32_16x16x32_bf16 v[60:63], v[172:175], v[236:239], v[60:63]
    v_mfma_f32_16x16x32_bf16 v[28:31], v[160:163], v[232:235], 0
    v_mfma_f32_16x16x32_bf16 v[28:31], v[164:167], v[236:239], v[28:31]
    s_waitcnt vmcnt(4) lgkmcnt(2)
    v_mfma_f32_16x16x32_bf16 v[0:3], v[192:195], v[240:243], v[0:3]
    ds_read_b128 v[232:235], v248 offset:20480
    v_mfma_f32_16x16x32_bf16 v[0:3], v[196:199], v[244:247], v[0:3]
    ds_read_b128 v[236:239], v249 offset:20480
    v_mfma_f32_16x16x32_bf16 v[32:35], v[200:203], v[240:243], v[32:35]
    buffer_load_dwordx4 v[160:163], v250, s[60:63], s46 offen offset:0 sc1
    v_mfma_f32_16x16x32_bf16 v[32:35], v[204:207], v[244:247], v[32:35]
    s_waitcnt vmcnt(1)
    v_mfma_f32_16x16x32_bf16 v[64:67], v[208:211], v[240:243], v[64:67]
    v_mfma_f32_16x16x32_bf16 v[64:67], v[212:215], v[244:247], v[64:67]
    buffer_load_dwordx4 v[164:167], v250, s[60:63], s46 offen offset:1024 sc1
    v_mfma_f32_16x16x32_bf16 v[96:99], v[216:219], v[240:243], v[96:99]
    v_mfma_f32_16x16x32_bf16 v[96:99], v[220:223], v[244:247], v[96:99]
    s_waitcnt lgkmcnt(2)
    v_mfma_f32_16x16x32_bf16 v[100:103], v[216:219], v[224:227], v[100:103]
    ds_read_b128 v[240:243], v248 offset:22528
    v_mfma_f32_16x16x32_bf16 v[100:103], v[220:223], v[228:231], v[100:103]
    ds_read_b128 v[244:247], v249 offset:22528
    v_mfma_f32_16x16x32_bf16 v[68:71], v[208:211], v[224:227], v[68:71]
    buffer_load_dwordx4 v[168:171], v250, s[60:63], s46 offen offset:2048 sc1
    v_mfma_f32_16x16x32_bf16 v[68:71], v[212:215], v[228:231], v[68:71]
    v_mfma_f32_16x16x32_bf16 v[36:39], v[200:203], v[224:227], v[36:39]
    v_mfma_f32_16x16x32_bf16 v[36:39], v[204:207], v[228:231], v[36:39]
    buffer_load_dwordx4 v[172:175], v250, s[60:63], s46 offen offset:3072 sc1
    v_mfma_f32_16x16x32_bf16 v[4:7], v[192:195], v[224:227], v[4:7]
    v_mfma_f32_16x16x32_bf16 v[4:7], v[196:199], v[228:231], v[4:7]
    s_waitcnt lgkmcnt(2)
    v_mfma_f32_16x16x32_bf16 v[8:11], v[192:195], v[232:235], v[8:11]
    ds_read_b128 v[224:227], v248 offset:24576
    v_mfma_f32_16x16x32_bf16 v[8:11], v[196:199], v[236:239], v[8:11]
    ds_read_b128 v[228:231], v249 offset:24576
    v_mfma_f32_16x16x32_bf16 v[40:43], v[200:203], v[232:235], v[40:43]
    buffer_load_dwordx4 v[176:179], v250, s[60:63], s47 offen offset:0 sc1
    v_mfma_f32_16x16x32_bf16 v[40:43], v[204:207], v[236:239], v[40:43]
    v_mfma_f32_16x16x32_bf16 v[72:75], v[208:211], v[232:235], v[72:75]
    v_mfma_f32_16x16x32_bf16 v[72:75], v[212:215], v[236:239], v[72:75]
    buffer_load_dwordx4 v[180:183], v250, s[60:63], s47 offen offset:1024 sc1
    v_mfma_f32_16x16x32_bf16 v[104:107], v[216:219], v[232:235], v[104:107]
    v_mfma_f32_16x16x32_bf16 v[104:107], v[220:223], v[236:239], v[104:107]
    s_waitcnt lgkmcnt(2)
    v_mfma_f32_16x16x32_bf16 v[108:111], v[216:219], v[240:243], v[108:111]
    ds_read_b128 v[232:235], v248 offset:26624
    v_mfma_f32_16x16x32_bf16 v[108:111], v[220:223], v[244:247], v[108:111]
    ds_read_b128 v[236:239], v249 offset:26624
    v_mfma_f32_16x16x32_bf16 v[76:79], v[208:211], v[240:243], v[76:79]
    buffer_load_dwordx4 v[184:187], v250, s[60:63], s47 offen offset:2048 sc1
    v_mfma_f32_16x16x32_bf16 v[76:79], v[212:215], v[244:247], v[76:79]
    v_mfma_f32_16x16x32_bf16 v[44:47], v[200:203], v[240:243], v[44:47]
    v_mfma_f32_16x16x32_bf16 v[44:47], v[204:207], v[244:247], v[44:47]
    buffer_load_dwordx4 v[188:191], v250, s[60:63], s47 offen offset:3072 sc1
    v_mfma_f32_16x16x32_bf16 v[12:15], v[192:195], v[240:243], v[12:15]
    v_mfma_f32_16x16x32_bf16 v[12:15], v[196:199], v[244:247], v[12:15]
    s_waitcnt lgkmcnt(2)
    v_mfma_f32_16x16x32_bf16 v[16:19], v[192:195], v[224:227], v[16:19]
    ds_read_b128 v[240:243], v248 offset:28672
    v_mfma_f32_16x16x32_bf16 v[16:19], v[196:199], v[228:231], v[16:19]
    ds_read_b128 v[244:247], v249 offset:28672
    v_mfma_f32_16x16x32_bf16 v[48:51], v[200:203], v[224:227], v[48:51]
    v_mfma_f32_16x16x32_bf16 v[48:51], v[204:207], v[228:231], v[48:51]
    v_mfma_f32_16x16x32_bf16 v[80:83], v[208:211], v[224:227], v[80:83]
    v_mfma_f32_16x16x32_bf16 v[80:83], v[212:215], v[228:231], v[80:83]
    v_mfma_f32_16x16x32_bf16 v[112:115], v[216:219], v[224:227], v[112:115]
    v_mfma_f32_16x16x32_bf16 v[112:115], v[220:223], v[228:231], v[112:115]
    s_waitcnt lgkmcnt(2)
    v_mfma_f32_16x16x32_bf16 v[116:119], v[216:219], v[232:235], v[116:119]
    ds_read_b128 v[224:227], v248 offset:30720
    v_mfma_f32_16x16x32_bf16 v[116:119], v[220:223], v[236:239], v[116:119]
    ds_read_b128 v[228:231], v249 offset:30720
    v_mfma_f32_16x16x32_bf16 v[84:87], v[208:211], v[232:235], v[84:87]
    v_mfma_f32_16x16x32_bf16 v[84:87], v[212:215], v[236:239], v[84:87]
    v_mfma_f32_16x16x32_bf16 v[52:55], v[200:203], v[232:235], v[52:55]
    v_mfma_f32_16x16x32_bf16 v[52:55], v[204:207], v[236:239], v[52:55]
    v_mfma_f32_16x16x32_bf16 v[20:23], v[192:195], v[232:235], v[20:23]
    v_mfma_f32_16x16x32_bf16 v[20:23], v[196:199], v[236:239], v[20:23]
    s_waitcnt lgkmcnt(2)
    v_mfma_f32_16x16x32_bf16 v[24:27], v[192:195], v[240:243], v[24:27]
    ds_read_b128 v[232:235], v248 offset:32768
    v_mfma_f32_16x16x32_bf16 v[24:27], v[196:199], v[244:247], v[24:27]
    ds_read_b128 v[236:239], v249 offset:32768
    v_mfma_f32_16x16x32_bf16 v[56:59], v[200:203], v[240:243], v[56:59]
    v_mfma_f32_16x16x32_bf16 v[56:59], v[204:207], v[244:247], v[56:59]
    v_mfma_f32_16x16x32_bf16 v[88:91], v[208:211], v[240:243], v[88:91]
    v_mfma_f32_16x16x32_bf16 v[88:91], v[212:215], v[244:247], v[88:91]
    v_mfma_f32_16x16x32_bf16 v[120:123], v[216:219], v[240:243], v[120:123]
    v_mfma_f32_16x16x32_bf16 v[120:123], v[220:223], v[244:247], v[120:123]
    s_waitcnt lgkmcnt(2)
    v_mfma_f32_16x16x32_bf16 v[124:127], v[216:219], v[224:227], v[124:127]
    ds_read_b128 v[240:243], v248 offset:34816
    v_mfma_f32_16x16x32_bf16 v[124:127], v[220:223], v[228:231], v[124:127]
    ds_read_b128 v[244:247], v249 offset:34816
    v_mfma_f32_16x16x32_bf16 v[92:95], v[208:211], v[224:227], v[92:95]
    v_mfma_f32_16x16x32_bf16 v[92:95], v[212:215], v[228:231], v[92:95]
    s_mov_b32 s46, 548864
    v_mfma_f32_16x16x32_bf16 v[60:63], v[200:203], v[224:227], v[60:63]
    s_mov_b32 s47, 552960
    v_mfma_f32_16x16x32_bf16 v[60:63], v[204:207], v[228:231], v[60:63]
    v_mfma_f32_16x16x32_bf16 v[28:31], v[192:195], v[224:227], v[28:31]
    v_mfma_f32_16x16x32_bf16 v[28:31], v[196:199], v[228:231], v[28:31]
    s_waitcnt vmcnt(4) lgkmcnt(2)
    v_mfma_f32_16x16x32_bf16 v[0:3], v[160:163], v[232:235], v[0:3]
    ds_read_b128 v[224:227], v248 offset:36864
    v_mfma_f32_16x16x32_bf16 v[0:3], v[164:167], v[236:239], v[0:3]
    ds_read_b128 v[228:231], v249 offset:36864
    v_mfma_f32_16x16x32_bf16 v[32:35], v[168:171], v[232:235], v[32:35]
    buffer_load_dwordx4 v[192:195], v250, s[60:63], s46 offen offset:0 sc1
    v_mfma_f32_16x16x32_bf16 v[32:35], v[172:175], v[236:239], v[32:35]
    s_waitcnt vmcnt(1)
    v_mfma_f32_16x16x32_bf16 v[64:67], v[176:179], v[232:235], v[64:67]
    v_mfma_f32_16x16x32_bf16 v[64:67], v[180:183], v[236:239], v[64:67]
    buffer_load_dwordx4 v[196:199], v250, s[60:63], s46 offen offset:1024 sc1
    v_mfma_f32_16x16x32_bf16 v[96:99], v[184:187], v[232:235], v[96:99]
    v_mfma_f32_16x16x32_bf16 v[96:99], v[188:191], v[236:239], v[96:99]
    s_waitcnt lgkmcnt(2)
    v_mfma_f32_16x16x32_bf16 v[100:103], v[184:187], v[240:243], v[100:103]
    ds_read_b128 v[232:235], v248 offset:38912
    v_mfma_f32_16x16x32_bf16 v[100:103], v[188:191], v[244:247], v[100:103]
    ds_read_b128 v[236:239], v249 offset:38912
    v_mfma_f32_16x16x32_bf16 v[68:71], v[176:179], v[240:243], v[68:71]
    buffer_load_dwordx4 v[200:203], v250, s[60:63], s46 offen offset:2048 sc1
    v_mfma_f32_16x16x32_bf16 v[68:71], v[180:183], v[244:247], v[68:71]
    v_mfma_f32_16x16x32_bf16 v[36:39], v[168:171], v[240:243], v[36:39]
    v_mfma_f32_16x16x32_bf16 v[36:39], v[172:175], v[244:247], v[36:39]
    buffer_load_dwordx4 v[204:207], v250, s[60:63], s46 offen offset:3072 sc1
    v_mfma_f32_16x16x32_bf16 v[4:7], v[160:163], v[240:243], v[4:7]
    v_mfma_f32_16x16x32_bf16 v[4:7], v[164:167], v[244:247], v[4:7]
    s_waitcnt lgkmcnt(2)
    v_mfma_f32_16x16x32_bf16 v[8:11], v[160:163], v[224:227], v[8:11]
    ds_read_b128 v[240:243], v248 offset:40960
    v_mfma_f32_16x16x32_bf16 v[8:11], v[164:167], v[228:231], v[8:11]
    ds_read_b128 v[244:247], v249 offset:40960
    v_mfma_f32_16x16x32_bf16 v[40:43], v[168:171], v[224:227], v[40:43]
    buffer_load_dwordx4 v[208:211], v250, s[60:63], s47 offen offset:0 sc1
    v_mfma_f32_16x16x32_bf16 v[40:43], v[172:175], v[228:231], v[40:43]
    v_mfma_f32_16x16x32_bf16 v[72:75], v[176:179], v[224:227], v[72:75]
    v_mfma_f32_16x16x32_bf16 v[72:75], v[180:183], v[228:231], v[72:75]
    buffer_load_dwordx4 v[212:215], v250, s[60:63], s47 offen offset:1024 sc1
    v_mfma_f32_16x16x32_bf16 v[104:107], v[184:187], v[224:227], v[104:107]
    v_mfma_f32_16x16x32_bf16 v[104:107], v[188:191], v[228:231], v[104:107]
    s_waitcnt lgkmcnt(2)
    v_mfma_f32_16x16x32_bf16 v[108:111], v[184:187], v[232:235], v[108:111]
    ds_read_b128 v[224:227], v248 offset:43008
    v_mfma_f32_16x16x32_bf16 v[108:111], v[188:191], v[236:239], v[108:111]
    ds_read_b128 v[228:231], v249 offset:43008
    v_mfma_f32_16x16x32_bf16 v[76:79], v[176:179], v[232:235], v[76:79]
    buffer_load_dwordx4 v[216:219], v250, s[60:63], s47 offen offset:2048 sc1
    v_mfma_f32_16x16x32_bf16 v[76:79], v[180:183], v[236:239], v[76:79]
    v_mfma_f32_16x16x32_bf16 v[44:47], v[168:171], v[232:235], v[44:47]
    v_mfma_f32_16x16x32_bf16 v[44:47], v[172:175], v[236:239], v[44:47]
    buffer_load_dwordx4 v[220:223], v250, s[60:63], s47 offen offset:3072 sc1
    v_mfma_f32_16x16x32_bf16 v[12:15], v[160:163], v[232:235], v[12:15]
    v_mfma_f32_16x16x32_bf16 v[12:15], v[164:167], v[236:239], v[12:15]
    s_waitcnt lgkmcnt(2)
    v_mfma_f32_16x16x32_bf16 v[16:19], v[160:163], v[240:243], v[16:19]
    ds_read_b128 v[232:235], v248 offset:45056
    v_mfma_f32_16x16x32_bf16 v[16:19], v[164:167], v[244:247], v[16:19]
    ds_read_b128 v[236:239], v249 offset:45056
    v_mfma_f32_16x16x32_bf16 v[48:51], v[168:171], v[240:243], v[48:51]
    v_mfma_f32_16x16x32_bf16 v[48:51], v[172:175], v[244:247], v[48:51]
    v_mfma_f32_16x16x32_bf16 v[80:83], v[176:179], v[240:243], v[80:83]
    v_mfma_f32_16x16x32_bf16 v[80:83], v[180:183], v[244:247], v[80:83]
    v_mfma_f32_16x16x32_bf16 v[112:115], v[184:187], v[240:243], v[112:115]
    v_mfma_f32_16x16x32_bf16 v[112:115], v[188:191], v[244:247], v[112:115]
    s_waitcnt lgkmcnt(2)
    v_mfma_f32_16x16x32_bf16 v[116:119], v[184:187], v[224:227], v[116:119]
    ds_read_b128 v[240:243], v248 offset:47104
    v_mfma_f32_16x16x32_bf16 v[116:119], v[188:191], v[228:231], v[116:119]
    ds_read_b128 v[244:247], v249 offset:47104
    v_mfma_f32_16x16x32_bf16 v[84:87], v[176:179], v[224:227], v[84:87]
    v_mfma_f32_16x16x32_bf16 v[84:87], v[180:183], v[228:231], v[84:87]
    v_mfma_f32_16x16x32_bf16 v[52:55], v[168:171], v[224:227], v[52:55]
    v_mfma_f32_16x16x32_bf16 v[52:55], v[172:175], v[228:231], v[52:55]
    v_mfma_f32_16x16x32_bf16 v[20:23], v[160:163], v[224:227], v[20:23]
    v_mfma_f32_16x16x32_bf16 v[20:23], v[164:167], v[228:231], v[20:23]
    s_waitcnt lgkmcnt(2)
    v_mfma_f32_16x16x32_bf16 v[24:27], v[160:163], v[232:235], v[24:27]
    ds_read_b128 v[224:227], v248 offset:49152
    v_mfma_f32_16x16x32_bf16 v[24:27], v[164:167], v[236:239], v[24:27]
    ds_read_b128 v[228:231], v249 offset:49152
    v_mfma_f32_16x16x32_bf16 v[56:59], v[168:171], v[232:235], v[56:59]
    v_mfma_f32_16x16x32_bf16 v[56:59], v[172:175], v[236:239], v[56:59]
    v_mfma_f32_16x16x32_bf16 v[88:91], v[176:179], v[232:235], v[88:91]
    v_mfma_f32_16x16x32_bf16 v[88:91], v[180:183], v[236:239], v[88:91]
    v_mfma_f32_16x16x32_bf16 v[120:123], v[184:187], v[232:235], v[120:123]
    v_mfma_f32_16x16x32_bf16 v[120:123], v[188:191], v[236:239], v[120:123]
    s_waitcnt lgkmcnt(2)
    v_mfma_f32_16x16x32_bf16 v[124:127], v[184:187], v[240:243], v[124:127]
    ds_read_b128 v[232:235], v248 offset:51200
    v_mfma_f32_16x16x32_bf16 v[124:127], v[188:191], v[244:247], v[124:127]
    ds_read_b128 v[236:239], v249 offset:51200
    v_mfma_f32_16x16x32_bf16 v[92:95], v[176:179], v[240:243], v[92:95]
    v_mfma_f32_16x16x32_bf16 v[92:95], v[180:183], v[244:247], v[92:95]
    s_mov_b32 s46, 557056
    v_mfma_f32_16x16x32_bf16 v[60:63], v[168:171], v[240:243], v[60:63]
    s_mov_b32 s47, 561152
    v_mfma_f32_16x16x32_bf16 v[60:63], v[172:175], v[244:247], v[60:63]
    v_mfma_f32_16x16x32_bf16 v[28:31], v[160:163], v[240:243], v[28:31]
    v_mfma_f32_16x16x32_bf16 v[28:31], v[164:167], v[244:247], v[28:31]
    s_waitcnt vmcnt(4) lgkmcnt(2)
    v_mfma_f32_16x16x32_bf16 v[0:3], v[192:195], v[224:227], v[0:3]
    ds_read_b128 v[240:243], v248 offset:53248
    v_mfma_f32_16x16x32_bf16 v[0:3], v[196:199], v[228:231], v[0:3]
    ds_read_b128 v[244:247], v249 offset:53248
    v_mfma_f32_16x16x32_bf16 v[32:35], v[200:203], v[224:227], v[32:35]
    buffer_load_dwordx4 v[160:163], v250, s[60:63], s46 offen offset:0 sc1
    v_mfma_f32_16x16x32_bf16 v[32:35], v[204:207], v[228:231], v[32:35]
    s_waitcnt vmcnt(1)
    v_mfma_f32_16x16x32_bf16 v[64:67], v[208:211], v[224:227], v[64:67]
    v_mfma_f32_16x16x32_bf16 v[64:67], v[212:215], v[228:231], v[64:67]
    buffer_load_dwordx4 v[164:167], v250, s[60:63], s46 offen offset:1024 sc1
    v_mfma_f32_16x16x32_bf16 v[96:99], v[216:219], v[224:227], v[96:99]
    v_mfma_f32_16x16x32_bf16 v[96:99], v[220:223], v[228:231], v[96:99]
    s_waitcnt lgkmcnt(2)
    v_mfma_f32_16x16x32_bf16 v[100:103], v[216:219], v[232:235], v[100:103]
    ds_read_b128 v[224:227], v248 offset:55296
    v_mfma_f32_16x16x32_bf16 v[100:103], v[220:223], v[236:239], v[100:103]
    ds_read_b128 v[228:231], v249 offset:55296
    v_mfma_f32_16x16x32_bf16 v[68:71], v[208:211], v[232:235], v[68:71]
    buffer_load_dwordx4 v[168:171], v250, s[60:63], s46 offen offset:2048 sc1
    v_mfma_f32_16x16x32_bf16 v[68:71], v[212:215], v[236:239], v[68:71]
    v_mfma_f32_16x16x32_bf16 v[36:39], v[200:203], v[232:235], v[36:39]
    v_mfma_f32_16x16x32_bf16 v[36:39], v[204:207], v[236:239], v[36:39]
    buffer_load_dwordx4 v[172:175], v250, s[60:63], s46 offen offset:3072 sc1
    v_mfma_f32_16x16x32_bf16 v[4:7], v[192:195], v[232:235], v[4:7]
    v_mfma_f32_16x16x32_bf16 v[4:7], v[196:199], v[236:239], v[4:7]
    s_waitcnt lgkmcnt(2)
    v_mfma_f32_16x16x32_bf16 v[8:11], v[192:195], v[240:243], v[8:11]
    ds_read_b128 v[232:235], v248 offset:57344
    v_mfma_f32_16x16x32_bf16 v[8:11], v[196:199], v[244:247], v[8:11]
    ds_read_b128 v[236:239], v249 offset:57344
    v_mfma_f32_16x16x32_bf16 v[40:43], v[200:203], v[240:243], v[40:43]
    buffer_load_dwordx4 v[176:179], v250, s[60:63], s47 offen offset:0 sc1
    v_mfma_f32_16x16x32_bf16 v[40:43], v[204:207], v[244:247], v[40:43]
    v_mfma_f32_16x16x32_bf16 v[72:75], v[208:211], v[240:243], v[72:75]
    v_mfma_f32_16x16x32_bf16 v[72:75], v[212:215], v[244:247], v[72:75]
    buffer_load_dwordx4 v[180:183], v250, s[60:63], s47 offen offset:1024 sc1
    v_mfma_f32_16x16x32_bf16 v[104:107], v[216:219], v[240:243], v[104:107]
    v_mfma_f32_16x16x32_bf16 v[104:107], v[220:223], v[244:247], v[104:107]
    s_waitcnt lgkmcnt(2)
    v_mfma_f32_16x16x32_bf16 v[108:111], v[216:219], v[224:227], v[108:111]
    ds_read_b128 v[240:243], v248 offset:59392
    v_mfma_f32_16x16x32_bf16 v[108:111], v[220:223], v[228:231], v[108:111]
    ds_read_b128 v[244:247], v249 offset:59392
    v_mfma_f32_16x16x32_bf16 v[76:79], v[208:211], v[224:227], v[76:79]
    buffer_load_dwordx4 v[184:187], v250, s[60:63], s47 offen offset:2048 sc1
    v_mfma_f32_16x16x32_bf16 v[76:79], v[212:215], v[228:231], v[76:79]
    v_mfma_f32_16x16x32_bf16 v[44:47], v[200:203], v[224:227], v[44:47]
    v_mfma_f32_16x16x32_bf16 v[44:47], v[204:207], v[228:231], v[44:47]
    buffer_load_dwordx4 v[188:191], v250, s[60:63], s47 offen offset:3072 sc1
    v_mfma_f32_16x16x32_bf16 v[12:15], v[192:195], v[224:227], v[12:15]
    v_mfma_f32_16x16x32_bf16 v[12:15], v[196:199], v[228:231], v[12:15]
    s_waitcnt lgkmcnt(2)
    v_mfma_f32_16x16x32_bf16 v[16:19], v[192:195], v[232:235], v[16:19]
    ds_read_b128 v[224:227], v248 offset:61440
    v_mfma_f32_16x16x32_bf16 v[16:19], v[196:199], v[236:239], v[16:19]
    ds_read_b128 v[228:231], v249 offset:61440
    v_mfma_f32_16x16x32_bf16 v[48:51], v[200:203], v[232:235], v[48:51]
    v_mfma_f32_16x16x32_bf16 v[48:51], v[204:207], v[236:239], v[48:51]
    v_mfma_f32_16x16x32_bf16 v[80:83], v[208:211], v[232:235], v[80:83]
    s_setprio 2
    v_mfma_f32_16x16x32_bf16 v[80:83], v[212:215], v[236:239], v[80:83]
    v_mfma_f32_16x16x32_bf16 v[112:115], v[216:219], v[232:235], v[112:115]
    v_mfma_f32_16x16x32_bf16 v[112:115], v[220:223], v[236:239], v[112:115]
    s_waitcnt lgkmcnt(2)
    v_mfma_f32_16x16x32_bf16 v[116:119], v[216:219], v[240:243], v[116:119]
    ds_read_b128 v[232:235], v248 offset:63488
    v_mfma_f32_16x16x32_bf16 v[116:119], v[220:223], v[244:247], v[116:119]
    ds_read_b128 v[236:239], v249 offset:63488
    v_mfma_f32_16x16x32_bf16 v[84:87], v[208:211], v[240:243], v[84:87]
    v_mfma_f32_16x16x32_bf16 v[84:87], v[212:215], v[244:247], v[84:87]
    v_add_u32 v248, 0x10000, v248
    v_mfma_f32_16x16x32_bf16 v[52:55], v[200:203], v[240:243], v[52:55]
    v_add_u32 v249, 0x10000, v249
    v_mfma_f32_16x16x32_bf16 v[52:55], v[204:207], v[244:247], v[52:55]
    v_mfma_f32_16x16x32_bf16 v[20:23], v[192:195], v[240:243], v[20:23]
    v_mfma_f32_16x16x32_bf16 v[20:23], v[196:199], v[244:247], v[20:23]
    s_waitcnt lgkmcnt(2)
    v_mfma_f32_16x16x32_bf16 v[24:27], v[192:195], v[224:227], v[24:27]
    ds_read_b128 v[240:243], v248 offset:0
    v_mfma_f32_16x16x32_bf16 v[24:27], v[196:199], v[228:231], v[24:27]
    ds_read_b128 v[244:247], v249 offset:0
    v_mfma_f32_16x16x32_bf16 v[56:59], v[200:203], v[224:227], v[56:59]
    v_mfma_f32_16x16x32_bf16 v[56:59], v[204:207], v[228:231], v[56:59]
    v_mfma_f32_16x16x32_bf16 v[88:91], v[208:211], v[224:227], v[88:91]
    v_mfma_f32_16x16x32_bf16 v[88:91], v[212:215], v[228:231], v[88:91]
    v_mfma_f32_16x16x32_bf16 v[120:123], v[216:219], v[224:227], v[120:123]
    v_mfma_f32_16x16x32_bf16 v[120:123], v[220:223], v[228:231], v[120:123]
    s_waitcnt lgkmcnt(2)
    v_mfma_f32_16x16x32_bf16 v[124:127], v[216:219], v[232:235], v[124:127]
    ds_read_b128 v[224:227], v248 offset:2048
    v_mfma_f32_16x16x32_bf16 v[124:127], v[220:223], v[236:239], v[124:127]
    ds_read_b128 v[228:231], v249 offset:2048
    v_mfma_f32_16x16x32_bf16 v[92:95], v[208:211], v[232:235], v[92:95]
    v_mfma_f32_16x16x32_bf16 v[92:95], v[212:215], v[236:239], v[92:95]
    s_mov_b32 s46, 565248
    v_mfma_f32_16x16x32_bf16 v[60:63], v[200:203], v[232:235], v[60:63]
    s_mov_b32 s47, 569344
    v_mfma_f32_16x16x32_bf16 v[60:63], v[204:207], v[236:239], v[60:63]
    v_mfma_f32_16x16x32_bf16 v[28:31], v[192:195], v[232:235], v[28:31]
    v_mfma_f32_16x16x32_bf16 v[28:31], v[196:199], v[236:239], v[28:31]
    s_waitcnt vmcnt(4) lgkmcnt(2)
    v_mfma_f32_16x16x32_bf16 v[0:3], v[160:163], v[240:243], v[0:3]
    ds_read_b128 v[232:235], v248 offset:4096
    v_mfma_f32_16x16x32_bf16 v[0:3], v[164:167], v[244:247], v[0:3]
    ds_read_b128 v[236:239], v249 offset:4096
    v_mfma_f32_16x16x32_bf16 v[32:35], v[168:171], v[240:243], v[32:35]
    buffer_load_dwordx4 v[192:195], v250, s[60:63], s46 offen offset:0 sc1
    v_mfma_f32_16x16x32_bf16 v[32:35], v[172:175], v[244:247], v[32:35]
    s_waitcnt vmcnt(1)
    v_mfma_f32_16x16x32_bf16 v[64:67], v[176:179], v[240:243], v[64:67]
    v_mfma_f32_16x16x32_bf16 v[64:67], v[180:183], v[244:247], v[64:67]
    buffer_load_dwordx4 v[196:199], v250, s[60:63], s46 offen offset:1024 sc1
    v_mfma_f32_16x16x32_bf16 v[96:99], v[184:187], v[240:243], v[96:99]
    v_mfma_f32_16x16x32_bf16 v[96:99], v[188:191], v[244:247], v[96:99]
    s_waitcnt lgkmcnt(2)
    v_mfma_f32_16x16x32_bf16 v[100:103], v[184:187], v[224:227], v[100:103]
    ds_read_b128 v[240:243], v248 offset:6144
    v_mfma_f32_16x16x32_bf16 v[100:103], v[188:191], v[228:231], v[100:103]
    ds_read_b128 v[244:247], v249 offset:6144
    v_mfma_f32_16x16x32_bf16 v[68:71], v[176:179], v[224:227], v[68:71]
    buffer_load_dwordx4 v[200:203], v250, s[60:63], s46 offen offset:2048 sc1
    v_mfma_f32_16x16x32_bf16 v[68:71], v[180:183], v[228:231], v[68:71]
    v_mfma_f32_16x16x32_bf16 v[36:39], v[168:171], v[224:227], v[36:39]
    v_mfma_f32_16x16x32_bf16 v[36:39], v[172:175], v[228:231], v[36:39]
    buffer_load_dwordx4 v[204:207], v250, s[60:63], s46 offen offset:3072 sc1
    v_mfma_f32_16x16x32_bf16 v[4:7], v[160:163], v[224:227], v[4:7]
    v_mfma_f32_16x16x32_bf16 v[4:7], v[164:167], v[228:231], v[4:7]
    s_waitcnt lgkmcnt(2)
    v_mfma_f32_16x16x32_bf16 v[8:11], v[160:163], v[232:235], v[8:11]
    ds_read_b128 v[224:227], v248 offset:8192
    v_mfma_f32_16x16x32_bf16 v[8:11], v[164:167], v[236:239], v[8:11]
    ds_read_b128 v[228:231], v249 offset:8192
    v_mfma_f32_16x16x32_bf16 v[40:43], v[168:171], v[232:235], v[40:43]
    buffer_load_dwordx4 v[208:211], v250, s[60:63], s47 offen offset:0 sc1
    v_mfma_f32_16x16x32_bf16 v[40:43], v[172:175], v[236:239], v[40:43]
    v_mfma_f32_16x16x32_bf16 v[72:75], v[176:179], v[232:235], v[72:75]
    v_mfma_f32_16x16x32_bf16 v[72:75], v[180:183], v[236:239], v[72:75]
    buffer_load_dwordx4 v[212:215], v250, s[60:63], s47 offen offset:1024 sc1
    v_mfma_f32_16x16x32_bf16 v[104:107], v[184:187], v[232:235], v[104:107]
    v_mfma_f32_16x16x32_bf16 v[104:107], v[188:191], v[236:239], v[104:107]
    s_waitcnt lgkmcnt(2)
    v_mfma_f32_16x16x32_bf16 v[108:111], v[184:187], v[240:243], v[108:111]
    ds_read_b128 v[232:235], v248 offset:10240
    v_mfma_f32_16x16x32_bf16 v[108:111], v[188:191], v[244:247], v[108:111]
    ds_read_b128 v[236:239], v249 offset:10240
    v_mfma_f32_16x16x32_bf16 v[76:79], v[176:179], v[240:243], v[76:79]
    buffer_load_dwordx4 v[216:219], v250, s[60:63], s47 offen offset:2048 sc1
    v_mfma_f32_16x16x32_bf16 v[76:79], v[180:183], v[244:247], v[76:79]
    v_mfma_f32_16x16x32_bf16 v[44:47], v[168:171], v[240:243], v[44:47]
    v_mfma_f32_16x16x32_bf16 v[44:47], v[172:175], v[244:247], v[44:47]
    buffer_load_dwordx4 v[220:223], v250, s[60:63], s47 offen offset:3072 sc1
    v_mfma_f32_16x16x32_bf16 v[12:15], v[160:163], v[240:243], v[12:15]
    v_mfma_f32_16x16x32_bf16 v[12:15], v[164:167], v[244:247], v[12:15]
    s_waitcnt lgkmcnt(2)
    v_mfma_f32_16x16x32_bf16 v[16:19], v[160:163], v[224:227], v[16:19]
    ds_read_b128 v[240:243], v248 offset:12288
    v_mfma_f32_16x16x32_bf16 v[16:19], v[164:167], v[228:231], v[16:19]
    ds_read_b128 v[244:247], v249 offset:12288
    v_mfma_f32_16x16x32_bf16 v[48:51], v[168:171], v[224:227], v[48:51]
    v_mfma_f32_16x16x32_bf16 v[48:51], v[172:175], v[228:231], v[48:51]
    v_mfma_f32_16x16x32_bf16 v[80:83], v[176:179], v[224:227], v[80:83]
    v_mfma_f32_16x16x32_bf16 v[80:83], v[180:183], v[228:231], v[80:83]
    v_mfma_f32_16x16x32_bf16 v[112:115], v[184:187], v[224:227], v[112:115]
    v_mfma_f32_16x16x32_bf16 v[112:115], v[188:191], v[228:231], v[112:115]
    s_waitcnt lgkmcnt(2)
    v_mfma_f32_16x16x32_bf16 v[116:119], v[184:187], v[232:235], v[116:119]
    ds_read_b128 v[224:227], v248 offset:14336
    v_mfma_f32_16x16x32_bf16 v[116:119], v[188:191], v[236:239], v[116:119]
    ds_read_b128 v[228:231], v249 offset:14336
    v_mfma_f32_16x16x32_bf16 v[84:87], v[176:179], v[232:235], v[84:87]
    v_mfma_f32_16x16x32_bf16 v[84:87], v[180:183], v[236:239], v[84:87]
    v_mfma_f32_16x16x32_bf16 v[52:55], v[168:171], v[232:235], v[52:55]
    v_mfma_f32_16x16x32_bf16 v[52:55], v[172:175], v[236:239], v[52:55]
    v_mfma_f32_16x16x32_bf16 v[20:23], v[160:163], v[232:235], v[20:23]
    v_mfma_f32_16x16x32_bf16 v[20:23], v[164:167], v[236:239], v[20:23]
    s_waitcnt lgkmcnt(2)
    v_mfma_f32_16x16x32_bf16 v[24:27], v[160:163], v[240:243], v[24:27]
    ds_read_b128 v[232:235], v248 offset:16384
    v_mfma_f32_16x16x32_bf16 v[24:27], v[164:167], v[244:247], v[24:27]
    ds_read_b128 v[236:239], v249 offset:16384
    v_mfma_f32_16x16x32_bf16 v[56:59], v[168:171], v[240:243], v[56:59]
    v_mfma_f32_16x16x32_bf16 v[56:59], v[172:175], v[244:247], v[56:59]
    v_mfma_f32_16x16x32_bf16 v[88:91], v[176:179], v[240:243], v[88:91]
    v_mfma_f32_16x16x32_bf16 v[88:91], v[180:183], v[244:247], v[88:91]
    v_mfma_f32_16x16x32_bf16 v[120:123], v[184:187], v[240:243], v[120:123]
    v_mfma_f32_16x16x32_bf16 v[120:123], v[188:191], v[244:247], v[120:123]
    s_waitcnt lgkmcnt(2)
    v_mfma_f32_16x16x32_bf16 v[124:127], v[184:187], v[224:227], v[124:127]
    ds_read_b128 v[240:243], v248 offset:18432
    v_mfma_f32_16x16x32_bf16 v[124:127], v[188:191], v[228:231], v[124:127]
    ds_read_b128 v[244:247], v249 offset:18432
    v_mfma_f32_16x16x32_bf16 v[92:95], v[176:179], v[224:227], v[92:95]
    v_mfma_f32_16x16x32_bf16 v[92:95], v[180:183], v[228:231], v[92:95]
    s_mov_b32 s46, 573440
    v_mfma_f32_16x16x32_bf16 v[60:63], v[168:171], v[224:227], v[60:63]
    s_mov_b32 s47, 577536
    v_mfma_f32_16x16x32_bf16 v[60:63], v[172:175], v[228:231], v[60:63]
    v_mfma_f32_16x16x32_bf16 v[28:31], v[160:163], v[224:227], v[28:31]
    v_mfma_f32_16x16x32_bf16 v[28:31], v[164:167], v[228:231], v[28:31]
    s_waitcnt vmcnt(4) lgkmcnt(2)
    v_mfma_f32_16x16x32_bf16 v[0:3], v[192:195], v[232:235], v[0:3]
    ds_read_b128 v[224:227], v248 offset:20480
    v_mfma_f32_16x16x32_bf16 v[0:3], v[196:199], v[236:239], v[0:3]
    ds_read_b128 v[228:231], v249 offset:20480
    v_mfma_f32_16x16x32_bf16 v[32:35], v[200:203], v[232:235], v[32:35]
    buffer_load_dwordx4 v[160:163], v250, s[60:63], s46 offen offset:0 sc1
    v_mfma_f32_16x16x32_bf16 v[32:35], v[204:207], v[236:239], v[32:35]
    s_waitcnt vmcnt(1)
    v_mfma_f32_16x16x32_bf16 v[64:67], v[208:211], v[232:235], v[64:67]
    v_mfma_f32_16x16x32_bf16 v[64:67], v[212:215], v[236:239], v[64:67]
    buffer_load_dwordx4 v[164:167], v250, s[60:63], s46 offen offset:1024 sc1
    v_mfma_f32_16x16x32_bf16 v[96:99], v[216:219], v[232:235], v[96:99]
    v_mfma_f32_16x16x32_bf16 v[96:99], v[220:223], v[236:239], v[96:99]
    s_waitcnt lgkmcnt(2)
    v_mfma_f32_16x16x32_bf16 v[100:103], v[216:219], v[240:243], v[100:103]
    ds_read_b128 v[232:235], v248 offset:22528
    v_mfma_f32_16x16x32_bf16 v[100:103], v[220:223], v[244:247], v[100:103]
    ds_read_b128 v[236:239], v249 offset:22528
    v_mfma_f32_16x16x32_bf16 v[68:71], v[208:211], v[240:243], v[68:71]
    buffer_load_dwordx4 v[168:171], v250, s[60:63], s46 offen offset:2048 sc1
    v_mfma_f32_16x16x32_bf16 v[68:71], v[212:215], v[244:247], v[68:71]
    v_mfma_f32_16x16x32_bf16 v[36:39], v[200:203], v[240:243], v[36:39]
    v_mfma_f32_16x16x32_bf16 v[36:39], v[204:207], v[244:247], v[36:39]
    buffer_load_dwordx4 v[172:175], v250, s[60:63], s46 offen offset:3072 sc1
    v_mfma_f32_16x16x32_bf16 v[4:7], v[192:195], v[240:243], v[4:7]
    v_mfma_f32_16x16x32_bf16 v[4:7], v[196:199], v[244:247], v[4:7]
    s_waitcnt lgkmcnt(2)
    v_mfma_f32_16x16x32_bf16 v[8:11], v[192:195], v[224:227], v[8:11]
    ds_read_b128 v[240:243], v248 offset:24576
    v_mfma_f32_16x16x32_bf16 v[8:11], v[196:199], v[228:231], v[8:11]
    ds_read_b128 v[244:247], v249 offset:24576
    v_mfma_f32_16x16x32_bf16 v[40:43], v[200:203], v[224:227], v[40:43]
    buffer_load_dwordx4 v[176:179], v250, s[60:63], s47 offen offset:0 sc1
    v_mfma_f32_16x16x32_bf16 v[40:43], v[204:207], v[228:231], v[40:43]
    v_mfma_f32_16x16x32_bf16 v[72:75], v[208:211], v[224:227], v[72:75]
    v_mfma_f32_16x16x32_bf16 v[72:75], v[212:215], v[228:231], v[72:75]
    buffer_load_dwordx4 v[180:183], v250, s[60:63], s47 offen offset:1024 sc1
    v_mfma_f32_16x16x32_bf16 v[104:107], v[216:219], v[224:227], v[104:107]
    v_mfma_f32_16x16x32_bf16 v[104:107], v[220:223], v[228:231], v[104:107]
    s_waitcnt lgkmcnt(2)
    v_mfma_f32_16x16x32_bf16 v[108:111], v[216:219], v[232:235], v[108:111]
    ds_read_b128 v[224:227], v248 offset:26624
    v_mfma_f32_16x16x32_bf16 v[108:111], v[220:223], v[236:239], v[108:111]
    ds_read_b128 v[228:231], v249 offset:26624
    v_mfma_f32_16x16x32_bf16 v[76:79], v[208:211], v[232:235], v[76:79]
    buffer_load_dwordx4 v[184:187], v250, s[60:63], s47 offen offset:2048 sc1
    v_mfma_f32_16x16x32_bf16 v[76:79], v[212:215], v[236:239], v[76:79]
    v_mfma_f32_16x16x32_bf16 v[44:47], v[200:203], v[232:235], v[44:47]
    v_mfma_f32_16x16x32_bf16 v[44:47], v[204:207], v[236:239], v[44:47]
    buffer_load_dwordx4 v[188:191], v250, s[60:63], s47 offen offset:3072 sc1
    v_mfma_f32_16x16x32_bf16 v[12:15], v[192:195], v[232:235], v[12:15]
    v_mfma_f32_16x16x32_bf16 v[12:15], v[196:199], v[236:239], v[12:15]
    s_waitcnt lgkmcnt(2)
    v_mfma_f32_16x16x32_bf16 v[16:19], v[192:195], v[240:243], v[16:19]
    ds_read_b128 v[232:235], v248 offset:28672
    v_mfma_f32_16x16x32_bf16 v[16:19], v[196:199], v[244:247], v[16:19]
    ds_read_b128 v[236:239], v249 offset:28672
    v_mfma_f32_16x16x32_bf16 v[48:51], v[200:203], v[240:243], v[48:51]
    v_mfma_f32_16x16x32_bf16 v[48:51], v[204:207], v[244:247], v[48:51]
    v_mfma_f32_16x16x32_bf16 v[80:83], v[208:211], v[240:243], v[80:83]
    v_mfma_f32_16x16x32_bf16 v[80:83], v[212:215], v[244:247], v[80:83]
    v_mfma_f32_16x16x32_bf16 v[112:115], v[216:219], v[240:243], v[112:115]
    v_mfma_f32_16x16x32_bf16 v[112:115], v[220:223], v[244:247], v[112:115]
    s_waitcnt lgkmcnt(2)
    v_mfma_f32_16x16x32_bf16 v[116:119], v[216:219], v[224:227], v[116:119]
    ds_read_b128 v[240:243], v248 offset:30720
    v_mfma_f32_16x16x32_bf16 v[116:119], v[220:223], v[228:231], v[116:119]
    ds_read_b128 v[244:247], v249 offset:30720
    v_mfma_f32_16x16x32_bf16 v[84:87], v[208:211], v[224:227], v[84:87]
    v_mfma_f32_16x16x32_bf16 v[84:87], v[212:215], v[228:231], v[84:87]
    v_mfma_f32_16x16x32_bf16 v[52:55], v[200:203], v[224:227], v[52:55]
    v_mfma_f32_16x16x32_bf16 v[52:55], v[204:207], v[228:231], v[52:55]
    v_mfma_f32_16x16x32_bf16 v[20:23], v[192:195], v[224:227], v[20:23]
    v_mfma_f32_16x16x32_bf16 v[20:23], v[196:199], v[228:231], v[20:23]
    s_waitcnt lgkmcnt(2)
    v_mfma_f32_16x16x32_bf16 v[24:27], v[192:195], v[232:235], v[24:27]
    ds_read_b128 v[224:227], v248 offset:32768
    v_mfma_f32_16x16x32_bf16 v[24:27], v[196:199], v[236:239], v[24:27]
    ds_read_b128 v[228:231], v249 offset:32768
    v_mfma_f32_16x16x32_bf16 v[56:59], v[200:203], v[232:235], v[56:59]
    v_mfma_f32_16x16x32_bf16 v[56:59], v[204:207], v[236:239], v[56:59]
    v_mfma_f32_16x16x32_bf16 v[88:91], v[208:211], v[232:235], v[88:91]
    v_mfma_f32_16x16x32_bf16 v[88:91], v[212:215], v[236:239], v[88:91]
    v_mfma_f32_16x16x32_bf16 v[120:123], v[216:219], v[232:235], v[120:123]
    v_mfma_f32_16x16x32_bf16 v[120:123], v[220:223], v[236:239], v[120:123]
    s_waitcnt lgkmcnt(2)
    v_mfma_f32_16x16x32_bf16 v[124:127], v[216:219], v[240:243], v[124:127]
    ds_read_b128 v[232:235], v248 offset:34816
    v_mfma_f32_16x16x32_bf16 v[124:127], v[220:223], v[244:247], v[124:127]
    ds_read_b128 v[236:239], v249 offset:34816
    v_mfma_f32_16x16x32_bf16 v[92:95], v[208:211], v[240:243], v[92:95]
    v_mfma_f32_16x16x32_bf16 v[92:95], v[212:215], v[244:247], v[92:95]
    s_mov_b32 s46, 581632
    v_mfma_f32_16x16x32_bf16 v[60:63], v[200:203], v[240:243], v[60:63]
    s_mov_b32 s47, 585728
    v_mfma_f32_16x16x32_bf16 v[60:63], v[204:207], v[244:247], v[60:63]
    v_mfma_f32_16x16x32_bf16 v[28:31], v[192:195], v[240:243], v[28:31]
    v_mfma_f32_16x16x32_bf16 v[28:31], v[196:199], v[244:247], v[28:31]
    s_waitcnt vmcnt(4) lgkmcnt(2)
    v_mfma_f32_16x16x32_bf16 v[0:3], v[160:163], v[224:227], v[0:3]
    ds_read_b128 v[240:243], v248 offset:36864
    v_mfma_f32_16x16x32_bf16 v[0:3], v[164:167], v[228:231], v[0:3]
    ds_read_b128 v[244:247], v249 offset:36864
    v_mfma_f32_16x16x32_bf16 v[32:35], v[168:171], v[224:227], v[32:35]
    buffer_load_dwordx4 v[192:195], v250, s[60:63], s46 offen offset:0 sc1
    v_mfma_f32_16x16x32_bf16 v[32:35], v[172:175], v[228:231], v[32:35]
    s_waitcnt vmcnt(1)
    v_mfma_f32_16x16x32_bf16 v[64:67], v[176:179], v[224:227], v[64:67]
    v_mfma_f32_16x16x32_bf16 v[64:67], v[180:183], v[228:231], v[64:67]
    buffer_load_dwordx4 v[196:199], v250, s[60:63], s46 offen offset:1024 sc1
    v_mfma_f32_16x16x32_bf16 v[96:99], v[184:187], v[224:227], v[96:99]
    v_mfma_f32_16x16x32_bf16 v[96:99], v[188:191], v[228:231], v[96:99]
    s_waitcnt lgkmcnt(2)
    v_mfma_f32_16x16x32_bf16 v[100:103], v[184:187], v[232:235], v[100:103]
    ds_read_b128 v[224:227], v248 offset:38912
    v_mfma_f32_16x16x32_bf16 v[100:103], v[188:191], v[236:239], v[100:103]
    ds_read_b128 v[228:231], v249 offset:38912
    v_mfma_f32_16x16x32_bf16 v[68:71], v[176:179], v[232:235], v[68:71]
    buffer_load_dwordx4 v[200:203], v250, s[60:63], s46 offen offset:2048 sc1
    v_mfma_f32_16x16x32_bf16 v[68:71], v[180:183], v[236:239], v[68:71]
    v_mfma_f32_16x16x32_bf16 v[36:39], v[168:171], v[232:235], v[36:39]
    v_mfma_f32_16x16x32_bf16 v[36:39], v[172:175], v[236:239], v[36:39]
    buffer_load_dwordx4 v[204:207], v250, s[60:63], s46 offen offset:3072 sc1
    v_mfma_f32_16x16x32_bf16 v[4:7], v[160:163], v[232:235], v[4:7]
    v_mfma_f32_16x16x32_bf16 v[4:7], v[164:167], v[236:239], v[4:7]
    s_waitcnt lgkmcnt(2)
    v_mfma_f32_16x16x32_bf16 v[8:11], v[160:163], v[240:243], v[8:11]
    ds_read_b128 v[232:235], v248 offset:40960
    v_mfma_f32_16x16x32_bf16 v[8:11], v[164:167], v[244:247], v[8:11]
    ds_read_b128 v[236:239], v249 offset:40960
    v_mfma_f32_16x16x32_bf16 v[40:43], v[168:171], v[240:243], v[40:43]
    buffer_load_dwordx4 v[208:211], v250, s[60:63], s47 offen offset:0 sc1
    v_mfma_f32_16x16x32_bf16 v[40:43], v[172:175], v[244:247], v[40:43]
    v_mfma_f32_16x16x32_bf16 v[72:75], v[176:179], v[240:243], v[72:75]
    v_mfma_f32_16x16x32_bf16 v[72:75], v[180:183], v[244:247], v[72:75]
    buffer_load_dwordx4 v[212:215], v250, s[60:63], s47 offen offset:1024 sc1
    v_mfma_f32_16x16x32_bf16 v[104:107], v[184:187], v[240:243], v[104:107]
    v_mfma_f32_16x16x32_bf16 v[104:107], v[188:191], v[244:247], v[104:107]
    s_waitcnt lgkmcnt(2)
    v_mfma_f32_16x16x32_bf16 v[108:111], v[184:187], v[224:227], v[108:111]
    ds_read_b128 v[240:243], v248 offset:43008
    v_mfma_f32_16x16x32_bf16 v[108:111], v[188:191], v[228:231], v[108:111]
    ds_read_b128 v[244:247], v249 offset:43008
    v_mfma_f32_16x16x32_bf16 v[76:79], v[176:179], v[224:227], v[76:79]
    buffer_load_dwordx4 v[216:219], v250, s[60:63], s47 offen offset:2048 sc1
    v_mfma_f32_16x16x32_bf16 v[76:79], v[180:183], v[228:231], v[76:79]
    v_mfma_f32_16x16x32_bf16 v[44:47], v[168:171], v[224:227], v[44:47]
    v_mfma_f32_16x16x32_bf16 v[44:47], v[172:175], v[228:231], v[44:47]
    buffer_load_dwordx4 v[220:223], v250, s[60:63], s47 offen offset:3072 sc1
    v_mfma_f32_16x16x32_bf16 v[12:15], v[160:163], v[224:227], v[12:15]
    v_mfma_f32_16x16x32_bf16 v[12:15], v[164:167], v[228:231], v[12:15]
    s_waitcnt lgkmcnt(2)
    v_mfma_f32_16x16x32_bf16 v[16:19], v[160:163], v[232:235], v[16:19]
    ds_read_b128 v[224:227], v248 offset:45056
    v_mfma_f32_16x16x32_bf16 v[16:19], v[164:167], v[236:239], v[16:19]
    ds_read_b128 v[228:231], v249 offset:45056
    v_mfma_f32_16x16x32_bf16 v[48:51], v[168:171], v[232:235], v[48:51]
    v_mfma_f32_16x16x32_bf16 v[48:51], v[172:175], v[236:239], v[48:51]
    v_mfma_f32_16x16x32_bf16 v[80:83], v[176:179], v[232:235], v[80:83]
    v_mfma_f32_16x16x32_bf16 v[80:83], v[180:183], v[236:239], v[80:83]
    v_mfma_f32_16x16x32_bf16 v[112:115], v[184:187], v[232:235], v[112:115]
    v_mfma_f32_16x16x32_bf16 v[112:115], v[188:191], v[236:239], v[112:115]
    s_waitcnt lgkmcnt(2)
    v_mfma_f32_16x16x32_bf16 v[116:119], v[184:187], v[240:243], v[116:119]
    ds_read_b128 v[232:235], v248 offset:47104
    v_mfma_f32_16x16x32_bf16 v[116:119], v[188:191], v[244:247], v[116:119]
    ds_read_b128 v[236:239], v249 offset:47104
    v_mfma_f32_16x16x32_bf16 v[84:87], v[176:179], v[240:243], v[84:87]
    v_mfma_f32_16x16x32_bf16 v[84:87], v[180:183], v[244:247], v[84:87]
    v_mfma_f32_16x16x32_bf16 v[52:55], v[168:171], v[240:243], v[52:55]
    v_mfma_f32_16x16x32_bf16 v[52:55], v[172:175], v[244:247], v[52:55]
    v_mfma_f32_16x16x32_bf16 v[20:23], v[160:163], v[240:243], v[20:23]
    v_mfma_f32_16x16x32_bf16 v[20:23], v[164:167], v[244:247], v[20:23]
    s_waitcnt lgkmcnt(2)
    v_mfma_f32_16x16x32_bf16 v[24:27], v[160:163], v[224:227], v[24:27]
    ds_read_b128 v[240:243], v248 offset:49152
    v_mfma_f32_16x16x32_bf16 v[24:27], v[164:167], v[228:231], v[24:27]
    ds_read_b128 v[244:247], v249 offset:49152
    v_mfma_f32_16x16x32_bf16 v[56:59], v[168:171], v[224:227], v[56:59]
    v_mfma_f32_16x16x32_bf16 v[56:59], v[172:175], v[228:231], v[56:59]
    v_mfma_f32_16x16x32_bf16 v[88:91], v[176:179], v[224:227], v[88:91]
    v_mfma_f32_16x16x32_bf16 v[88:91], v[180:183], v[228:231], v[88:91]
    v_mfma_f32_16x16x32_bf16 v[120:123], v[184:187], v[224:227], v[120:123]
    v_mfma_f32_16x16x32_bf16 v[120:123], v[188:191], v[228:231], v[120:123]
    s_waitcnt lgkmcnt(2)
    v_mfma_f32_16x16x32_bf16 v[124:127], v[184:187], v[232:235], v[124:127]
    ds_read_b128 v[224:227], v248 offset:51200
    v_mfma_f32_16x16x32_bf16 v[124:127], v[188:191], v[236:239], v[124:127]
    ds_read_b128 v[228:231], v249 offset:51200
    v_mfma_f32_16x16x32_bf16 v[92:95], v[176:179], v[232:235], v[92:95]
    v_mfma_f32_16x16x32_bf16 v[92:95], v[180:183], v[236:239], v[92:95]
    v_mfma_f32_16x16x32_bf16 v[60:63], v[168:171], v[232:235], v[60:63]
    v_mfma_f32_16x16x32_bf16 v[60:63], v[172:175], v[236:239], v[60:63]
    v_mfma_f32_16x16x32_bf16 v[28:31], v[160:163], v[232:235], v[28:31]
    v_mfma_f32_16x16x32_bf16 v[28:31], v[164:167], v[236:239], v[28:31]
    s_waitcnt vmcnt(4) lgkmcnt(2)
    v_mfma_f32_16x16x32_bf16 v[0:3], v[192:195], v[240:243], v[0:3]
    ds_read_b128 v[232:235], v248 offset:53248
    v_mfma_f32_16x16x32_bf16 v[0:3], v[196:199], v[244:247], v[0:3]
    ds_read_b128 v[236:239], v249 offset:53248
    v_mfma_f32_16x16x32_bf16 v[32:35], v[200:203], v[240:243], v[32:35]
    v_mfma_f32_16x16x32_bf16 v[32:35], v[204:207], v[244:247], v[32:35]
    s_waitcnt vmcnt(0)
    v_mfma_f32_16x16x32_bf16 v[64:67], v[208:211], v[240:243], v[64:67]
    v_mfma_f32_16x16x32_bf16 v[64:67], v[212:215], v[244:247], v[64:67]
    v_mfma_f32_16x16x32_bf16 v[96:99], v[216:219], v[240:243], v[96:99]
    v_mfma_f32_16x16x32_bf16 v[96:99], v[220:223], v[244:247], v[96:99]
    s_waitcnt lgkmcnt(2)
    v_mfma_f32_16x16x32_bf16 v[100:103], v[216:219], v[224:227], v[100:103]
    ds_read_b128 v[240:243], v248 offset:55296
    v_mfma_f32_16x16x32_bf16 v[100:103], v[220:223], v[228:231], v[100:103]
    ds_read_b128 v[244:247], v249 offset:55296
    v_mfma_f32_16x16x32_bf16 v[68:71], v[208:211], v[224:227], v[68:71]
    v_mfma_f32_16x16x32_bf16 v[68:71], v[212:215], v[228:231], v[68:71]
    v_mfma_f32_16x16x32_bf16 v[36:39], v[200:203], v[224:227], v[36:39]
    v_mfma_f32_16x16x32_bf16 v[36:39], v[204:207], v[228:231], v[36:39]
    v_mfma_f32_16x16x32_bf16 v[4:7], v[192:195], v[224:227], v[4:7]
    v_mfma_f32_16x16x32_bf16 v[4:7], v[196:199], v[228:231], v[4:7]
    s_waitcnt lgkmcnt(2)
    v_mfma_f32_16x16x32_bf16 v[8:11], v[192:195], v[232:235], v[8:11]
    ds_read_b128 v[224:227], v248 offset:57344
    v_mfma_f32_16x16x32_bf16 v[8:11], v[196:199], v[236:239], v[8:11]
    ds_read_b128 v[228:231], v249 offset:57344
    v_mfma_f32_16x16x32_bf16 v[40:43], v[200:203], v[232:235], v[40:43]
    v_mfma_f32_16x16x32_bf16 v[40:43], v[204:207], v[236:239], v[40:43]
    v_mfma_f32_16x16x32_bf16 v[72:75], v[208:211], v[232:235], v[72:75]
    v_mfma_f32_16x16x32_bf16 v[72:75], v[212:215], v[236:239], v[72:75]
    v_mfma_f32_16x16x32_bf16 v[104:107], v[216:219], v[232:235], v[104:107]
    v_mfma_f32_16x16x32_bf16 v[104:107], v[220:223], v[236:239], v[104:107]
    s_waitcnt lgkmcnt(2)
    v_mfma_f32_16x16x32_bf16 v[108:111], v[216:219], v[240:243], v[108:111]
    ds_read_b128 v[232:235], v248 offset:59392
    v_mfma_f32_16x16x32_bf16 v[108:111], v[220:223], v[244:247], v[108:111]
    ds_read_b128 v[236:239], v249 offset:59392
    v_mfma_f32_16x16x32_bf16 v[76:79], v[208:211], v[240:243], v[76:79]
    v_mfma_f32_16x16x32_bf16 v[76:79], v[212:215], v[244:247], v[76:79]
    v_mfma_f32_16x16x32_bf16 v[44:47], v[200:203], v[240:243], v[44:47]
    v_mfma_f32_16x16x32_bf16 v[44:47], v[204:207], v[244:247], v[44:47]
    v_mfma_f32_16x16x32_bf16 v[12:15], v[192:195], v[240:243], v[12:15]
    s_barrier
    v_mfma_f32_16x16x32_bf16 v[12:15], v[196:199], v[244:247], v[12:15]
    s_waitcnt lgkmcnt(2)
    v_mfma_f32_16x16x32_bf16 v[16:19], v[192:195], v[224:227], v[16:19]
    ds_read_b128 v[240:243], v248 offset:61440
    v_mfma_f32_16x16x32_bf16 v[16:19], v[196:199], v[228:231], v[16:19]
    ds_read_b128 v[244:247], v249 offset:61440
    v_mfma_f32_16x16x32_bf16 v[48:51], v[200:203], v[224:227], v[48:51]
    v_mfma_f32_16x16x32_bf16 v[48:51], v[204:207], v[228:231], v[48:51]
    v_mfma_f32_16x16x32_bf16 v[80:83], v[208:211], v[224:227], v[80:83]
    v_mfma_f32_16x16x32_bf16 v[80:83], v[212:215], v[228:231], v[80:83]
    v_mfma_f32_16x16x32_bf16 v[112:115], v[216:219], v[224:227], v[112:115]
    v_mfma_f32_16x16x32_bf16 v[112:115], v[220:223], v[228:231], v[112:115]
    s_waitcnt lgkmcnt(2)
    v_mfma_f32_16x16x32_bf16 v[116:119], v[216:219], v[232:235], v[116:119]
    ds_read_b128 v[224:227], v248 offset:63488
    v_mfma_f32_16x16x32_bf16 v[116:119], v[220:223], v[236:239], v[116:119]
    ds_read_b128 v[228:231], v249 offset:63488
    v_mfma_f32_16x16x32_bf16 v[84:87], v[208:211], v[232:235], v[84:87]
    v_mfma_f32_16x16x32_bf16 v[84:87], v[212:215], v[236:239], v[84:87]
    v_mfma_f32_16x16x32_bf16 v[52:55], v[200:203], v[232:235], v[52:55]
    v_mfma_f32_16x16x32_bf16 v[52:55], v[204:207], v[236:239], v[52:55]
    v_mfma_f32_16x16x32_bf16 v[20:23], v[192:195], v[232:235], v[20:23]
    v_mfma_f32_16x16x32_bf16 v[20:23], v[196:199], v[236:239], v[20:23]
    s_waitcnt lgkmcnt(2)
    v_mfma_f32_16x16x32_bf16 v[24:27], v[192:195], v[240:243], v[24:27]
    v_mfma_f32_16x16x32_bf16 v[24:27], v[196:199], v[244:247], v[24:27]
    v_mfma_f32_16x16x32_bf16 v[56:59], v[200:203], v[240:243], v[56:59]
    v_mfma_f32_16x16x32_bf16 v[56:59], v[204:207], v[244:247], v[56:59]
    v_mfma_f32_16x16x32_bf16 v[88:91], v[208:211], v[240:243], v[88:91]
    v_mfma_f32_16x16x32_bf16 v[88:91], v[212:215], v[244:247], v[88:91]
    v_mfma_f32_16x16x32_bf16 v[120:123], v[216:219], v[240:243], v[120:123]
    v_mfma_f32_16x16x32_bf16 v[120:123], v[220:223], v[244:247], v[120:123]
    s_waitcnt lgkmcnt(0)
    v_mfma_f32_16x16x32_bf16 v[124:127], v[216:219], v[224:227], v[124:127]
    v_mfma_f32_16x16x32_bf16 v[124:127], v[220:223], v[228:231], v[124:127]
    v_mfma_f32_16x16x32_bf16 v[92:95], v[208:211], v[224:227], v[92:95]
    v_mfma_f32_16x16x32_bf16 v[92:95], v[212:215], v[228:231], v[92:95]
    v_mfma_f32_16x16x32_bf16 v[60:63], v[200:203], v[224:227], v[60:63]
    v_mfma_f32_16x16x32_bf16 v[60:63], v[204:207], v[228:231], v[60:63]
    v_mfma_f32_16x16x32_bf16 v[28:31], v[192:195], v[224:227], v[28:31]
    v_mfma_f32_16x16x32_bf16 v[28:31], v[196:199], v[228:231], v[28:31]
    s_setprio 0
    s_movk_i32 s49, 24576
    s_nop 5
    v_mul_f32 v72, s50, v72
    v_mul_f32 v73, s50, v73
    v_mul_f32 v74, s50, v74
    v_mul_f32 v75, s50, v75
    v_mul_f32 v104, s50, v104
    v_mul_f32 v105, s50, v105
    v_mul_f32 v106, s50, v106
    v_mul_f32 v107, s50, v107
    v_exp_f32 v72, v72
    v_exp_f32 v73, v73
    v_exp_f32 v74, v74
    v_exp_f32 v75, v75
    v_exp_f32 v104, v104
    v_exp_f32 v105, v105
    v_exp_f32 v106, v106
    v_exp_f32 v107, v107
    v_fma_f32 v72, v72, s51, s51
    v_fma_f32 v73, v73, s51, s51
    v_fma_f32 v74, v74, s51, s51
    v_fma_f32 v75, v75, s51, s51
    v_fma_f32 v104, v104, s51, s51
    v_fma_f32 v105, v105, s51, s51
    v_fma_f32 v106, v106, s51, s51
    v_fma_f32 v107, v107, s51, s51
    buffer_load_dwordx4 v[192:195], v252, s[20:23], s49 offen offset:0 sc1
    v_rcp_f32 v72, v72
    v_rcp_f32 v73, v73
    v_rcp_f32 v74, v74
    v_rcp_f32 v75, v75
    v_rcp_f32 v104, v104
    v_rcp_f32 v105, v105
    v_rcp_f32 v106, v106
    v_rcp_f32 v107, v107
    buffer_load_dwordx4 v[196:199], v252, s[20:23], s49 offen offset:64 sc1
    v_mul_f32 v8, v8, v72
    v_mul_f32 v9, v9, v73
    v_mul_f32 v10, v10, v74
    v_mul_f32 v11, v11, v75
    v_mul_f32 v40, v40, v104
    v_mul_f32 v41, v41, v105
    v_mul_f32 v42, v42, v106
    v_mul_f32 v43, v43, v107
    buffer_load_dwordx4 v[200:203], v252, s[20:23], s49 offen offset:128 sc1
    v_mul_f32 v76, s50, v76
    v_mul_f32 v77, s50, v77
    v_mul_f32 v78, s50, v78
    v_mul_f32 v79, s50, v79
    v_mul_f32 v108, s50, v108
    v_mul_f32 v109, s50, v109
    v_mul_f32 v110, s50, v110
    v_mul_f32 v111, s50, v111
    buffer_load_dwordx4 v[204:207], v252, s[20:23], s49 offen offset:192 sc1
    v_exp_f32 v76, v76
    v_exp_f32 v77, v77
    v_exp_f32 v78, v78
    v_exp_f32 v79, v79
    v_exp_f32 v108, v108
    v_exp_f32 v109, v109
    v_exp_f32 v110, v110
    v_exp_f32 v111, v111
    buffer_load_dwordx4 v[208:211], v252, s[20:23], s49 offen offset:1024 sc1
    v_fma_f32 v76, v76, s51, s51
    v_fma_f32 v77, v77, s51, s51
    v_fma_f32 v78, v78, s51, s51
    v_fma_f32 v79, v79, s51, s51
    v_fma_f32 v108, v108, s51, s51
    v_fma_f32 v109, v109, s51, s51
    v_fma_f32 v110, v110, s51, s51
    v_fma_f32 v111, v111, s51, s51
    buffer_load_dwordx4 v[212:215], v252, s[20:23], s49 offen offset:1088 sc1
    v_rcp_f32 v76, v76
    v_rcp_f32 v77, v77
    v_rcp_f32 v78, v78
    v_rcp_f32 v79, v79
    v_rcp_f32 v108, v108
    v_rcp_f32 v109, v109
    v_rcp_f32 v110, v110
    v_rcp_f32 v111, v111
    buffer_load_dwordx4 v[216:219], v252, s[20:23], s49 offen offset:1152 sc1
    v_mul_f32 v12, v12, v76
    v_mul_f32 v13, v13, v77
    v_mul_f32 v14, v14, v78
    v_mul_f32 v15, v15, v79
    v_mul_f32 v44, v44, v108
    v_mul_f32 v45, v45, v109
    v_mul_f32 v46, v46, v110
    v_mul_f32 v47, v47, v111
    buffer_load_dwordx4 v[220:223], v252, s[20:23], s49 offen offset:1216 sc1
    v_mul_f32 v64, s50, v64
    v_mul_f32 v65, s50, v65
    v_mul_f32 v66, s50, v66
    v_mul_f32 v67, s50, v67
    v_mul_f32 v96, s50, v96
    v_mul_f32 v97, s50, v97
    v_mul_f32 v98, s50, v98
    v_mul_f32 v99, s50, v99
    v_exp_f32 v64, v64
    v_exp_f32 v65, v65
    v_exp_f32 v66, v66
    v_exp_f32 v67, v67
    v_exp_f32 v96, v96
    v_exp_f32 v97, v97
    v_exp_f32 v98, v98
    v_exp_f32 v99, v99
    v_fma_f32 v64, v64, s51, s51
    v_fma_f32 v65, v65, s51, s51
    v_fma_f32 v66, v66, s51, s51
    v_fma_f32 v67, v67, s51, s51
    v_fma_f32 v96, v96, s51, s51
    v_fma_f32 v97, v97, s51, s51
    v_fma_f32 v98, v98, s51, s51
    v_fma_f32 v99, v99, s51, s51
    v_rcp_f32 v64, v64
    v_rcp_f32 v65, v65
    v_rcp_f32 v66, v66
    v_rcp_f32 v67, v67
    v_rcp_f32 v96, v96
    v_rcp_f32 v97, v97
    v_rcp_f32 v98, v98
    v_rcp_f32 v99, v99
    v_mul_f32 v0, v0, v64
    v_mul_f32 v1, v1, v65
    v_mul_f32 v2, v2, v66
    v_mul_f32 v3, v3, v67
    v_mul_f32 v32, v32, v96
    v_mul_f32 v33, v33, v97
    v_mul_f32 v34, v34, v98
    v_mul_f32 v35, v35, v99
    v_mul_f32 v68, s50, v68
    v_mul_f32 v69, s50, v69
    v_mul_f32 v70, s50, v70
    v_mul_f32 v71, s50, v71
    v_mul_f32 v100, s50, v100
    v_mul_f32 v101, s50, v101
    v_mul_f32 v102, s50, v102
    v_mul_f32 v103, s50, v103
    v_exp_f32 v68, v68
    v_exp_f32 v69, v69
    v_exp_f32 v70, v70
    v_exp_f32 v71, v71
    v_exp_f32 v100, v100
    v_exp_f32 v101, v101
    v_exp_f32 v102, v102
    v_exp_f32 v103, v103
    v_fma_f32 v68, v68, s51, s51
    v_fma_f32 v69, v69, s51, s51
    v_fma_f32 v70, v70, s51, s51
    v_fma_f32 v71, v71, s51, s51
    v_fma_f32 v100, v100, s51, s51
    v_fma_f32 v101, v101, s51, s51
    v_fma_f32 v102, v102, s51, s51
    v_fma_f32 v103, v103, s51, s51
    v_rcp_f32 v68, v68
    v_rcp_f32 v69, v69
    v_rcp_f32 v70, v70
    v_rcp_f32 v71, v71
    v_rcp_f32 v100, v100
    v_rcp_f32 v101, v101
    v_rcp_f32 v102, v102
    v_rcp_f32 v103, v103
    v_mul_f32 v4, v4, v68
    v_mul_f32 v5, v5, v69
    v_mul_f32 v6, v6, v70
    v_mul_f32 v7, v7, v71
    v_mul_f32 v36, v36, v100
    v_mul_f32 v37, v37, v101
    v_mul_f32 v38, v38, v102
    v_mul_f32 v39, v39, v103
    v_cvt_pk_bf16_f32 v161, v8, v12
    v_cvt_pk_bf16_f32 v167, v9, v13
    v_cvt_pk_bf16_f32 v173, v10, v14
    v_cvt_pk_bf16_f32 v179, v11, v15
    v_cvt_pk_bf16_f32 v185, v40, v44
    v_cvt_pk_bf16_f32 v225, v41, v45
    v_cvt_pk_bf16_f32 v231, v42, v46
    v_cvt_pk_bf16_f32 v237, v43, v47
    v_cvt_pk_bf16_f32 v160, v0, v4
    v_cvt_pk_bf16_f32 v166, v1, v5
    v_cvt_pk_bf16_f32 v172, v2, v6
    v_cvt_pk_bf16_f32 v178, v3, v7
    v_cvt_pk_bf16_f32 v184, v32, v36
    v_cvt_pk_bf16_f32 v224, v33, v37
    v_cvt_pk_bf16_f32 v230, v34, v38
    v_cvt_pk_bf16_f32 v236, v35, v39
    v_min_u32 v72, -2, v161
    v_min_u32 v73, -2, v167
    v_min_u32 v74, -2, v173
    v_min_u32 v75, -2, v179
    v_min_u32 v104, -2, v185
    v_min_u32 v105, -2, v225
    v_min_u32 v106, -2, v231
    v_min_u32 v107, -2, v237
    s_cmp_lg_u32 s34, 4096
    s_cbranch_scc1 L_exp23
    v_min_u32_dpp v72, v160, v253 row_shr:1 row_mask:0xf bank_mask:0xf
    v_min_u32_dpp v73, v166, v253 row_shr:1 row_mask:0xf bank_mask:0xf
    v_min_u32_dpp v74, v172, v253 row_shr:1 row_mask:0xf bank_mask:0xf
    v_min_u32_dpp v75, v178, v253 row_shr:1 row_mask:0xf bank_mask:0xf
    v_min_u32_dpp v104, v184, v253 row_shr:1 row_mask:0xf bank_mask:0xf
    v_min_u32_dpp v105, v224, v253 row_shr:1 row_mask:0xf bank_mask:0xf
    v_min_u32_dpp v106, v230, v253 row_shr:1 row_mask:0xf bank_mask:0xf
    v_min_u32_dpp v107, v236, v253 row_shr:1 row_mask:0xf bank_mask:0xf
L_exp23:
    v_mul_f32 v80, s50, v80
    v_mul_f32 v81, s50, v81
    v_mul_f32 v82, s50, v82
    v_mul_f32 v83, s50, v83
    v_mul_f32 v112, s50, v112
    v_mul_f32 v113, s50, v113
    v_mul_f32 v114, s50, v114
    v_mul_f32 v115, s50, v115
    v_exp_f32 v80, v80
    v_exp_f32 v81, v81
    v_exp_f32 v82, v82
    v_exp_f32 v83, v83
    v_exp_f32 v112, v112
    v_exp_f32 v113, v113
    v_exp_f32 v114, v114
    v_exp_f32 v115, v115
    v_fma_f32 v80, v80, s51, s51
    v_fma_f32 v81, v81, s51, s51
    v_fma_f32 v82, v82, s51, s51
    v_fma_f32 v83, v83, s51, s51
    v_fma_f32 v112, v112, s51, s51
    v_fma_f32 v113, v113, s51, s51
    v_fma_f32 v114, v114, s51, s51
    v_fma_f32 v115, v115, s51, s51
    v_rcp_f32 v80, v80
    v_rcp_f32 v81, v81
    v_rcp_f32 v82, v82
    v_rcp_f32 v83, v83
    v_rcp_f32 v112, v112
    v_rcp_f32 v113, v113
    v_rcp_f32 v114, v114
    v_rcp_f32 v115, v115
    v_mul_f32 v16, v16, v80
    v_mul_f32 v17, v17, v81
    v_mul_f32 v18, v18, v82
    v_mul_f32 v19, v19, v83
    v_mul_f32 v48, v48, v112
    v_mul_f32 v49, v49, v113
    v_mul_f32 v50, v50, v114
    v_mul_f32 v51, v51, v115
    buffer_store_dwordx4 v[72:75], v254, s[32:35], s38 offen offset:1536 sc0 sc1
    buffer_store_dwordx4 v[104:107], v254, s[32:35], s38 offen offset:1600 sc0 sc1
    s_barrier
    v_subrev_u32 v249, s39, v250
    v_add_u32 v248, 98304, v249
    v_add_u32 v249, 32768, v249
    v_mul_f32 v84, s50, v84
    v_mul_f32 v85, s50, v85
    v_mul_f32 v86, s50, v86
    v_mul_f32 v87, s50, v87
    v_mul_f32 v116, s50, v116
    v_mul_f32 v117, s50, v117
    v_mul_f32 v118, s50, v118
    v_mul_f32 v119, s50, v119
    v_exp_f32 v84, v84
    v_exp_f32 v85, v85
    v_exp_f32 v86, v86
    v_exp_f32 v87, v87
    v_exp_f32 v116, v116
    v_exp_f32 v117, v117
    v_exp_f32 v118, v118
    v_exp_f32 v119, v119
    v_fma_f32 v84, v84, s51, s51
    v_fma_f32 v85, v85, s51, s51
    v_fma_f32 v86, v86, s51, s51
    v_fma_f32 v87, v87, s51, s51
    v_fma_f32 v116, v116, s51, s51
    v_fma_f32 v117, v117, s51, s51
    v_fma_f32 v118, v118, s51, s51
    v_fma_f32 v119, v119, s51, s51
    v_rcp_f32 v84, v84
    v_rcp_f32 v85, v85
    v_rcp_f32 v86, v86
    v_rcp_f32 v87, v87
    v_rcp_f32 v116, v116
    v_rcp_f32 v117, v117
    v_rcp_f32 v118, v118
    v_rcp_f32 v119, v119
    v_mul_f32 v20, v20, v84
    v_mul_f32 v21, v21, v85
    v_mul_f32 v22, v22, v86
    v_mul_f32 v23, v23, v87
    v_mul_f32 v52, v52, v116
    v_mul_f32 v53, v53, v117
    v_mul_f32 v54, v54, v118
    v_mul_f32 v55, v55, v119
    v_mul_f32 v88, s50, v88
    v_mul_f32 v89, s50, v89
    v_mul_f32 v90, s50, v90
    v_mul_f32 v91, s50, v91
    v_mul_f32 v120, s50, v120
    v_mul_f32 v121, s50, v121
    v_mul_f32 v122, s50, v122
    v_mul_f32 v123, s50, v123
    v_exp_f32 v88, v88
    v_exp_f32 v89, v89
    v_exp_f32 v90, v90
    v_exp_f32 v91, v91
    v_exp_f32 v120, v120
    v_exp_f32 v121, v121
    v_exp_f32 v122, v122
    v_exp_f32 v123, v123
    v_fma_f32 v88, v88, s51, s51
    v_fma_f32 v89, v89, s51, s51
    v_fma_f32 v90, v90, s51, s51
    v_fma_f32 v91, v91, s51, s51
    v_fma_f32 v120, v120, s51, s51
    v_fma_f32 v121, v121, s51, s51
    v_fma_f32 v122, v122, s51, s51
    v_fma_f32 v123, v123, s51, s51
    v_rcp_f32 v88, v88
    v_rcp_f32 v89, v89
    v_rcp_f32 v90, v90
    v_rcp_f32 v91, v91
    v_rcp_f32 v120, v120
    v_rcp_f32 v121, v121
    v_rcp_f32 v122, v122
    v_rcp_f32 v123, v123
    v_mul_f32 v24, v24, v88
    v_mul_f32 v25, v25, v89
    v_mul_f32 v26, v26, v90
    v_mul_f32 v27, v27, v91
    v_mul_f32 v56, v56, v120
    v_mul_f32 v57, v57, v121
    v_mul_f32 v58, v58, v122
    v_mul_f32 v59, v59, v123
    v_mul_f32 v92, s50, v92
    v_mul_f32 v93, s50, v93
    v_mul_f32 v94, s50, v94
    v_mul_f32 v95, s50, v95
    v_mul_f32 v124, s50, v124
    v_mul_f32 v125, s50, v125
    v_mul_f32 v126, s50, v126
    v_mul_f32 v127, s50, v127
    v_exp_f32 v92, v92
    v_exp_f32 v93, v93
    v_exp_f32 v94, v94
    v_exp_f32 v95, v95
    v_exp_f32 v124, v124
    v_exp_f32 v125, v125
    v_exp_f32 v126, v126
    v_exp_f32 v127, v127
    v_fma_f32 v92, v92, s51, s51
    v_fma_f32 v93, v93, s51, s51
    v_fma_f32 v94, v94, s51, s51
    v_fma_f32 v95, v95, s51, s51
    v_fma_f32 v124, v124, s51, s51
    v_fma_f32 v125, v125, s51, s51
    v_fma_f32 v126, v126, s51, s51
    v_fma_f32 v127, v127, s51, s51
    v_rcp_f32 v92, v92
    v_rcp_f32 v93, v93
    v_rcp_f32 v94, v94
    v_rcp_f32 v95, v95
    v_rcp_f32 v124, v124
    v_rcp_f32 v125, v125
    v_rcp_f32 v126, v126
    v_rcp_f32 v127, v127
    v_mul_f32 v28, v28, v92
    v_mul_f32 v29, v29, v93
    v_mul_f32 v30, v30, v94
    v_mul_f32 v31, v31, v95
    v_mul_f32 v60, v60, v124
    v_mul_f32 v61, v61, v125
    v_mul_f32 v62, v62, v126
    v_mul_f32 v63, v63, v127
    v_cvt_pk_bf16_f32 v162, v16, v20
    v_cvt_pk_bf16_f32 v163, v24, v28
    v_cvt_pk_bf16_f32 v168, v17, v21
    v_cvt_pk_bf16_f32 v169, v25, v29
    s_waitcnt vmcnt(2)
    s_setprio 3
    v_mfma_f32_16x16x32_bf16 v[64:67], v[192:195], v[160:163], 0
    v_cvt_pk_bf16_f32 v174, v18, v22
    v_cvt_pk_bf16_f32 v175, v26, v30
    v_mfma_f32_16x16x32_bf16 v[72:75], v[196:199], v[166:169], 0
    v_cvt_pk_bf16_f32 v180, v19, v23
    v_cvt_pk_bf16_f32 v181, v27, v31
    v_mfma_f32_16x16x32_bf16 v[80:83], v[200:203], v[172:175], 0
    v_cvt_pk_bf16_f32 v186, v48, v52
    v_cvt_pk_bf16_f32 v187, v56, v60
    v_mfma_f32_16x16x32_bf16 v[88:91], v[204:207], v[178:181], 0
    v_cvt_pk_bf16_f32 v226, v49, v53
    v_cvt_pk_bf16_f32 v227, v57, v61
    v_mfma_f32_16x16x32_bf16 v[96:99], v[208:211], v[184:187], 0
    v_cvt_pk_bf16_f32 v232, v50, v54
    v_cvt_pk_bf16_f32 v233, v58, v62
    v_mfma_f32_16x16x32_bf16 v[104:107], v[212:215], v[224:227], 0
    v_cvt_pk_bf16_f32 v238, v51, v55
    v_cvt_pk_bf16_f32 v239, v59, v63
    s_nop 0
    v_mfma_f32_16x16x32_bf16 v[112:115], v[216:219], v[230:233], 0
    v_mfma_f32_16x16x32_bf16 v[120:123], v[220:223], v[236:239], 0
    s_setprio 0
    v_exp_f32 v32, v64
    v_exp_f32 v33, v72
    v_exp_f32 v34, v80
    v_exp_f32 v35, v88
    v_exp_f32 v36, v96
    v_exp_f32 v37, v104
    v_exp_f32 v38, v112
    v_exp_f32 v39, v120
    v_fma_f32 v32, v32, s50, s50
    v_fma_f32 v33, v33, s50, s50
    v_fma_f32 v34, v34, s50, s50
    v_fma_f32 v35, v35, s50, s50
    v_fma_f32 v36, v36, s50, s50
    v_fma_f32 v37, v37, s50, s50
    v_fma_f32 v38, v38, s50, s50
    v_fma_f32 v39, v39, s50, s50
    v_rcp_f32 v32, v32
    v_rcp_f32 v33, v33
    v_rcp_f32 v34, v34
    v_rcp_f32 v35, v35
    v_rcp_f32 v36, v36
    v_rcp_f32 v37, v37
    v_rcp_f32 v38, v38
    v_rcp_f32 v39, v39
    v_mul_f32 v64, v64, v32
    v_mul_f32 v72, v72, v33
    v_mul_f32 v80, v80, v34
    v_mul_f32 v88, v88, v35
    v_mul_f32 v96, v96, v36
    v_mul_f32 v104, v104, v37
    v_mul_f32 v112, v112, v38
    v_mul_f32 v120, v120, v39
    v_cvt_pk_bf16_f32 v0, v64, v72
    v_cvt_pk_bf16_f32 v1, v80, v88
    v_cvt_pk_bf16_f32 v2, v96, v104
    v_cvt_pk_bf16_f32 v3, v112, v120
    buffer_load_dwordx4 v[40:43], v251, s[24:27], s38 offen offset:1536 sc0 sc1
    buffer_load_dwordx4 v[44:47], v251, s[24:27], s38 offen offset:1600 sc0 sc1
    v_exp_f32 v32, v65
    v_exp_f32 v33, v73
    v_exp_f32 v34, v81
    v_exp_f32 v35, v89
    v_exp_f32 v36, v97
    v_exp_f32 v37, v105
    v_exp_f32 v38, v113
    v_exp_f32 v39, v121
    ds_write_b128 v250, v[0:3] offset:0
    v_fma_f32 v32, v32, s50, s50
    v_fma_f32 v33, v33, s50, s50
    v_fma_f32 v34, v34, s50, s50
    v_fma_f32 v35, v35, s50, s50
    v_fma_f32 v36, v36, s50, s50
    v_fma_f32 v37, v37, s50, s50
    v_fma_f32 v38, v38, s50, s50
    v_fma_f32 v39, v39, s50, s50
    v_rcp_f32 v32, v32
    v_rcp_f32 v33, v33
    v_rcp_f32 v34, v34
    v_rcp_f32 v35, v35
    v_rcp_f32 v36, v36
    v_rcp_f32 v37, v37
    v_rcp_f32 v38, v38
    v_rcp_f32 v39, v39
    v_mul_f32 v65, v65, v32
    v_mul_f32 v73, v73, v33
    v_mul_f32 v81, v81, v34
    v_mul_f32 v89, v89, v35
    v_mul_f32 v97, v97, v36
    v_mul_f32 v105, v105, v37
    v_mul_f32 v113, v113, v38
    v_mul_f32 v121, v121, v39
    v_cvt_pk_bf16_f32 v4, v65, v73
    v_cvt_pk_bf16_f32 v5, v81, v89
    v_cvt_pk_bf16_f32 v6, v97, v105
    v_cvt_pk_bf16_f32 v7, v113, v121
    v_exp_f32 v32, v66
    v_exp_f32 v33, v74
    v_exp_f32 v34, v82
    v_exp_f32 v35, v90
    v_exp_f32 v36, v98
    v_exp_f32 v37, v106
    v_exp_f32 v38, v114
    v_exp_f32 v39, v122
    ds_write_b128 v250, v[4:7] offset:2048
    v_fma_f32 v32, v32, s50, s50
    v_fma_f32 v33, v33, s50, s50
    v_fma_f32 v34, v34, s50, s50
    v_fma_f32 v35, v35, s50, s50
    v_fma_f32 v36, v36, s50, s50
    v_fma_f32 v37, v37, s50, s50
    v_fma_f32 v38, v38, s50, s50
    v_fma_f32 v39, v39, s50, s50
    v_rcp_f32 v32, v32
    v_rcp_f32 v33, v33
    v_rcp_f32 v34, v34
    v_rcp_f32 v35, v35
    v_rcp_f32 v36, v36
    v_rcp_f32 v37, v37
    v_rcp_f32 v38, v38
    v_rcp_f32 v39, v39
    v_mul_f32 v66, v66, v32
    v_mul_f32 v74, v74, v33
    v_mul_f32 v82, v82, v34
    v_mul_f32 v90, v90, v35
    v_mul_f32 v98, v98, v36
    v_mul_f32 v106, v106, v37
    v_mul_f32 v114, v114, v38
    v_mul_f32 v122, v122, v39
    v_cvt_pk_bf16_f32 v8, v66, v74
    v_cvt_pk_bf16_f32 v9, v82, v90
    v_cvt_pk_bf16_f32 v10, v98, v106
    v_cvt_pk_bf16_f32 v11, v114, v122
    v_mov_b32_dpp v165, v161 row_shl:1 row_mask:0xf bank_mask:0xf bound_ctrl:1
    v_mov_b32_dpp v171, v167 row_shl:1 row_mask:0xf bank_mask:0xf bound_ctrl:1
    v_mov_b32_dpp v177, v173 row_shl:1 row_mask:0xf bank_mask:0xf bound_ctrl:1
    v_mov_b32_dpp v183, v179 row_shl:1 row_mask:0xf bank_mask:0xf bound_ctrl:1
    v_mov_b32_dpp v189, v185 row_shl:1 row_mask:0xf bank_mask:0xf bound_ctrl:1
    v_mov_b32_dpp v229, v225 row_shl:1 row_mask:0xf bank_mask:0xf bound_ctrl:1
    v_mov_b32_dpp v235, v231 row_shl:1 row_mask:0xf bank_mask:0xf bound_ctrl:1
    v_mov_b32_dpp v241, v237 row_shl:1 row_mask:0xf bank_mask:0xf bound_ctrl:1
    ds_write_b128 v250, v[8:11] offset:4096
    s_mov_b32 s48, 4000000
    s_waitcnt vmcnt(0)
L_poll3:
    v_max3_u32 v32, v40, v41, v42
    v_max3_u32 v33, v43, v44, v45
    v_max3_u32 v32, v32, v46, v47
    v_max_u32 v32, v32, v33
    v_cmp_eq_u32 vcc, -1, v32
    s_sub_u32 s48, s48, 1
    s_cbranch_scc1 L_poll3_ok
    s_cbranch_vccz L_poll3_ok
    buffer_load_dwordx4 v[40:43], v251, s[24:27], s38 offen offset:1536 sc0 sc1
    buffer_load_dwordx4 v[44:47], v251, s[24:27], s38 offen offset:1600 sc0 sc1
    s_waitcnt vmcnt(0)
    s_branch L_poll3
L_poll3_ok:
    s_mov_b32 vcc_lo, 2147516416
    s_mov_b32 vcc_hi, 2147516416
    s_cmp_lg_u32 s26, 4096
    s_cbranch_scc1 L_imp23
    v_mov_b32_dpp v165, v40 row_shr:15 row_mask:0xf bank_mask:0xf
    v_mov_b32_dpp v171, v41 row_shr:15 row_mask:0xf bank_mask:0xf
    v_mov_b32_dpp v177, v42 row_shr:15 row_mask:0xf bank_mask:0xf
    v_mov_b32_dpp v183, v43 row_shr:15 row_mask:0xf bank_mask:0xf
    v_mov_b32_dpp v189, v44 row_shr:15 row_mask:0xf bank_mask:0xf
    v_mov_b32_dpp v229, v45 row_shr:15 row_mask:0xf bank_mask:0xf
    v_mov_b32_dpp v235, v46 row_shr:15 row_mask:0xf bank_mask:0xf
    v_mov_b32_dpp v241, v47 row_shr:15 row_mask:0xf bank_mask:0xf
L_imp23:
    v_cndmask_b32_dpp v164, v160, v40, vcc row_shl:1 row_mask:0xf bank_mask:0xf bound_ctrl:1
    v_cndmask_b32_dpp v170, v166, v41, vcc row_shl:1 row_mask:0xf bank_mask:0xf bound_ctrl:1
    v_cndmask_b32_dpp v176, v172, v42, vcc row_shl:1 row_mask:0xf bank_mask:0xf bound_ctrl:1
    v_cndmask_b32_dpp v182, v178, v43, vcc row_shl:1 row_mask:0xf bank_mask:0xf bound_ctrl:1
    v_cndmask_b32_dpp v188, v184, v44, vcc row_shl:1 row_mask:0xf bank_mask:0xf bound_ctrl:1
    v_cndmask_b32_dpp v228, v224, v45, vcc row_shl:1 row_mask:0xf bank_mask:0xf bound_ctrl:1
    v_cndmask_b32_dpp v234, v230, v46, vcc row_shl:1 row_mask:0xf bank_mask:0xf bound_ctrl:1
    v_cndmask_b32_dpp v240, v236, v47, vcc row_shl:1 row_mask:0xf bank_mask:0xf bound_ctrl:1
    s_setprio 3
    v_mfma_f32_16x16x32_bf16 v[68:71], v[192:195], v[162:165], 0
    v_exp_f32 v32, v67
    v_mfma_f32_16x16x32_bf16 v[76:79], v[196:199], v[168:171], 0
    v_exp_f32 v33, v75
    v_mfma_f32_16x16x32_bf16 v[84:87], v[200:203], v[174:177], 0
    v_exp_f32 v34, v83
    v_mfma_f32_16x16x32_bf16 v[92:95], v[204:207], v[180:183], 0
    v_exp_f32 v35, v91
    v_mfma_f32_16x16x32_bf16 v[100:103], v[208:211], v[186:189], 0
    v_exp_f32 v36, v99
    v_mfma_f32_16x16x32_bf16 v[108:111], v[212:215], v[226:229], 0
    v_exp_f32 v37, v107
    v_mfma_f32_16x16x32_bf16 v[116:119], v[216:219], v[232:235], 0
    v_exp_f32 v38, v115
    v_mfma_f32_16x16x32_bf16 v[124:127], v[220:223], v[238:241], 0
    v_exp_f32 v39, v123
    s_setprio 0
    v_fma_f32 v32, v32, s50, s50
    v_fma_f32 v33, v33, s50, s50
    v_fma_f32 v34, v34, s50, s50
    v_fma_f32 v35, v35, s50, s50
    v_fma_f32 v36, v36, s50, s50
    v_fma_f32 v37, v37, s50, s50
    v_fma_f32 v38, v38, s50, s50
    v_fma_f32 v39, v39, s50, s50
    v_rcp_f32 v32, v32
    v_rcp_f32 v33, v33
    v_rcp_f32 v34, v34
    v_rcp_f32 v35, v35
    v_rcp_f32 v36, v36
    v_rcp_f32 v37, v37
    v_rcp_f32 v38, v38
    v_rcp_f32 v39, v39
    v_mul_f32 v67, v67, v32
    v_mul_f32 v75, v75, v33
    v_mul_f32 v83, v83, v34
    v_mul_f32 v91, v91, v35
    v_mul_f32 v99, v99, v36
    v_mul_f32 v107, v107, v37
    v_mul_f32 v115, v115, v38
    v_mul_f32 v123, v123, v39
    v_cvt_pk_bf16_f32 v12, v67, v75
    v_cvt_pk_bf16_f32 v13, v83, v91
    v_cvt_pk_bf16_f32 v14, v99, v107
    v_cvt_pk_bf16_f32 v15, v115, v123
    v_exp_f32 v32, v68
    v_exp_f32 v33, v76
    v_exp_f32 v34, v84
    v_exp_f32 v35, v92
    v_exp_f32 v36, v100
    v_exp_f32 v37, v108
    v_exp_f32 v38, v116
    v_exp_f32 v39, v124
    ds_write_b128 v250, v[12:15] offset:6144
    v_fma_f32 v32, v32, s50, s50
    v_fma_f32 v33, v33, s50, s50
    v_fma_f32 v34, v34, s50, s50
    v_fma_f32 v35, v35, s50, s50
    v_fma_f32 v36, v36, s50, s50
    v_fma_f32 v37, v37, s50, s50
    v_fma_f32 v38, v38, s50, s50
    v_fma_f32 v39, v39, s50, s50
    v_rcp_f32 v32, v32
    v_rcp_f32 v33, v33
    v_rcp_f32 v34, v34
    v_rcp_f32 v35, v35
    v_rcp_f32 v36, v36
    v_rcp_f32 v37, v37
    v_rcp_f32 v38, v38
    v_rcp_f32 v39, v39
    v_mul_f32 v68, v68, v32
    v_mul_f32 v76, v76, v33
    v_mul_f32 v84, v84, v34
    v_mul_f32 v92, v92, v35
    v_mul_f32 v100, v100, v36
    v_mul_f32 v108, v108, v37
    v_mul_f32 v116, v116, v38
    v_mul_f32 v124, v124, v39
    v_cvt_pk_bf16_f32 v16, v68, v76
    v_cvt_pk_bf16_f32 v17, v84, v92
    v_cvt_pk_bf16_f32 v18, v100, v108
    v_cvt_pk_bf16_f32 v19, v116, v124
    v_exp_f32 v32, v69
    v_exp_f32 v33, v77
    v_exp_f32 v34, v85
    v_exp_f32 v35, v93
    v_exp_f32 v36, v101
    v_exp_f32 v37, v109
    v_exp_f32 v38, v117
    v_exp_f32 v39, v125
    ds_write_b128 v250, v[16:19] offset:8192
    v_fma_f32 v32, v32, s50, s50
    v_fma_f32 v33, v33, s50, s50
    v_fma_f32 v34, v34, s50, s50
    v_fma_f32 v35, v35, s50, s50
    v_fma_f32 v36, v36, s50, s50
    v_fma_f32 v37, v37, s50, s50
    v_fma_f32 v38, v38, s50, s50
    v_fma_f32 v39, v39, s50, s50
    v_rcp_f32 v32, v32
    v_rcp_f32 v33, v33
    v_rcp_f32 v34, v34
    v_rcp_f32 v35, v35
    v_rcp_f32 v36, v36
    v_rcp_f32 v37, v37
    v_rcp_f32 v38, v38
    v_rcp_f32 v39, v39
    v_mul_f32 v69, v69, v32
    v_mul_f32 v77, v77, v33
    v_mul_f32 v85, v85, v34
    v_mul_f32 v93, v93, v35
    v_mul_f32 v101, v101, v36
    v_mul_f32 v109, v109, v37
    v_mul_f32 v117, v117, v38
    v_mul_f32 v125, v125, v39
    s_waitcnt lgkmcnt(0)
    s_barrier
    v_cvt_pk_bf16_f32 v20, v69, v77
    v_cvt_pk_bf16_f32 v21, v85, v93
    v_cvt_pk_bf16_f32 v22, v101, v109
    v_cvt_pk_bf16_f32 v23, v117, v125
    s_setprio 1
    v_exp_f32 v32, v70
    v_exp_f32 v33, v78
    s_mov_b32 s46, 1064960
    v_exp_f32 v34, v86
    v_exp_f32 v35, v94
    s_mov_b32 s47, 1069056
    v_exp_f32 v36, v102
    v_exp_f32 v37, v110
    buffer_load_dwordx4 v[160:163], v250, s[60:63], s46 offen offset:0 sc1
    v_exp_f32 v38, v118
    v_exp_f32 v39, v126
    ds_write_b128 v250, v[20:23] offset:10240
    v_fma_f32 v32, v32, s50, s50
    v_fma_f32 v33, v33, s50, s50
    v_fma_f32 v34, v34, s50, s50
    v_fma_f32 v35, v35, s50, s50
    buffer_load_dwordx4 v[164:167], v250, s[60:63], s46 offen offset:1024 sc1
    v_fma_f32 v36, v36, s50, s50
    v_fma_f32 v37, v37, s50, s50
    v_fma_f32 v38, v38, s50, s50
    v_fma_f32 v39, v39, s50, s50
    v_rcp_f32 v32, v32
    v_rcp_f32 v33, v33
    buffer_load_dwordx4 v[168:171], v250, s[60:63], s46 offen offset:2048 sc1
    v_rcp_f32 v34, v34
    v_rcp_f32 v35, v35
    v_rcp_f32 v36, v36
    v_rcp_f32 v37, v37
    v_rcp_f32 v38, v38
    v_rcp_f32 v39, v39
    buffer_load_dwordx4 v[172:175], v250, s[60:63], s46 offen offset:3072 sc1
    v_mul_f32 v70, v70, v32
    v_mul_f32 v78, v78, v33
    v_mul_f32 v86, v86, v34
    v_mul_f32 v94, v94, v35
    v_mul_f32 v102, v102, v36
    v_mul_f32 v110, v110, v37
    buffer_load_dwordx4 v[176:179], v250, s[60:63], s47 offen offset:0 sc1
    v_mul_f32 v118, v118, v38
    v_mul_f32 v126, v126, v39
    v_cvt_pk_bf16_f32 v24, v70, v78
    v_cvt_pk_bf16_f32 v25, v86, v94
    v_cvt_pk_bf16_f32 v26, v102, v110
    v_cvt_pk_bf16_f32 v27, v118, v126
    buffer_load_dwordx4 v[180:183], v250, s[60:63], s47 offen offset:1024 sc1
    v_exp_f32 v32, v71
    v_exp_f32 v33, v79
    v_exp_f32 v34, v87
    v_exp_f32 v35, v95
    v_exp_f32 v36, v103
    v_exp_f32 v37, v111
    buffer_load_dwordx4 v[184:187], v250, s[60:63], s47 offen offset:2048 sc1
    v_exp_f32 v38, v119
    v_exp_f32 v39, v127
    ds_write_b128 v250, v[24:27] offset:12288
    v_fma_f32 v32, v32, s50, s50
    v_fma_f32 v33, v33, s50, s50
    v_fma_f32 v34, v34, s50, s50
    v_fma_f32 v35, v35, s50, s50
    buffer_load_dwordx4 v[188:191], v250, s[60:63], s47 offen offset:3072 sc1
    v_fma_f32 v36, v36, s50, s50
    v_fma_f32 v37, v37, s50, s50
    v_fma_f32 v38, v38, s50, s50
    v_fma_f32 v39, v39, s50, s50
    v_rcp_f32 v32, v32
    v_rcp_f32 v33, v33
    s_mov_b32 s46, 1073152
    v_rcp_f32 v34, v34
    v_rcp_f32 v35, v35
    s_mov_b32 s47, 1077248
    v_rcp_f32 v36, v36
    v_rcp_f32 v37, v37
    ds_read_b128 v[224:227], v248 offset:32768
    v_rcp_f32 v38, v38
    v_rcp_f32 v39, v39
    ds_read_b128 v[228:231], v248 offset:33792
    v_mul_f32 v71, v71, v32
    v_mul_f32 v79, v79, v33
    ds_read_b128 v[232:235], v248 offset:34816
    v_mul_f32 v87, v87, v34
    v_mul_f32 v95, v95, v35
    ds_read_b128 v[236:239], v248 offset:35840
    v_mul_f32 v103, v103, v36
    v_mul_f32 v111, v111, v37
    v_mul_f32 v119, v119, v38
    v_mul_f32 v127, v127, v39
    s_waitcnt lgkmcnt(4)
    s_barrier
    v_cvt_pk_bf16_f32 v28, v71, v79
    v_cvt_pk_bf16_f32 v29, v87, v95
    v_cvt_pk_bf16_f32 v30, v103, v111
    v_cvt_pk_bf16_f32 v31, v119, v127
    ds_write_b128 v250, v[28:31] offset:14336
    s_waitcnt lgkmcnt(0)
    s_barrier
    v_mbcnt_lo_u32_b32 v144, -1, 0
    v_mbcnt_hi_u32_b32 v144, -1, v144
    s_lshl_b32 s48, s52, 7
    v_bfe_u32 v145, v144, 1, 3
    v_lshl_add_u32 v252, v145, 14, s48
    v_bfe_u32 v146, v144, 4, 1
    v_lshl_add_u32 v252, v146, 5, v252
    v_lshrrev_b32 v146, 5, v144
    v_lshl_add_u32 v252, v146, 6, v252
    v_and_b32 v146, 1, v144
    v_lshl_add_u32 v252, v146, 4, v252
    v_add_u32 v253, 8192, v252
    s_movk_i32 s49, 4096
    s_mov_b32 vcc_lo, 0x55555555
    s_mov_b32 vcc_hi, 0x55555555
    s_mov_b32 s46, 1105920
    s_mov_b32 s47, 1110016
    buffer_load_dwordx4 v[128:131], v250, s[60:63], s46 offen offset:0 sc1
    buffer_load_dwordx4 v[132:135], v250, s[60:63], s46 offen offset:1024 sc1
    buffer_load_dwordx4 v[136:139], v250, s[60:63], s46 offen offset:2048 sc1
    buffer_load_dwordx4 v[140:143], v250, s[60:63], s46 offen offset:3072 sc1
    buffer_load_dwordx4 v[144:147], v250, s[60:63], s47 offen offset:0 sc1
    buffer_load_dwordx4 v[148:151], v250, s[60:63], s47 offen offset:1024 sc1
    buffer_load_dwordx4 v[152:155], v250, s[60:63], s47 offen offset:2048 sc1
    buffer_load_dwordx4 v[156:159], v250, s[60:63], s47 offen offset:3072 sc1
    s_mov_b32 s46, 1073152
    s_mov_b32 s47, 1077248
    s_setprio 1
    s_waitcnt vmcnt(15)
    v_mfma_f32_16x16x32_bf16 v[0:3], v[160:163], v[224:227], 0
    ds_read_b128 v[240:243], v248 offset:36864
    s_waitcnt vmcnt(14)
    v_mfma_f32_16x16x32_bf16 v[0:3], v[164:167], v[228:231], v[0:3]
    ds_read_b128 v[244:247], v248 offset:37888
    s_waitcnt vmcnt(13)
    v_mfma_f32_16x16x32_bf16 v[32:35], v[168:171], v[224:227], 0
    buffer_load_dwordx4 v[192:195], v250, s[60:63], s46 offen offset:0 sc1
    s_waitcnt vmcnt(13)
    v_mfma_f32_16x16x32_bf16 v[32:35], v[172:175], v[228:231], v[32:35]
    s_waitcnt vmcnt(9)
    v_mfma_f32_16x16x32_bf16 v[64:67], v[176:179], v[224:227], 0
    v_mfma_f32_16x16x32_bf16 v[64:67], v[180:183], v[228:231], v[64:67]
    buffer_load_dwordx4 v[196:199], v250, s[60:63], s46 offen offset:1024 sc1
    v_mfma_f32_16x16x32_bf16 v[96:99], v[184:187], v[224:227], 0
    v_mfma_f32_16x16x32_bf16 v[96:99], v[188:191], v[228:231], v[96:99]
    v_mfma_f32_16x16x32_bf16 v[100:103], v[184:187], v[232:235], 0
    ds_read_b128 v[224:227], v248 offset:38912
    v_mfma_f32_16x16x32_bf16 v[100:103], v[188:191], v[236:239], v[100:103]
    ds_read_b128 v[228:231], v248 offset:39936
    v_mfma_f32_16x16x32_bf16 v[68:71], v[176:179], v[232:235], 0
    buffer_load_dwordx4 v[200:203], v250, s[60:63], s46 offen offset:2048 sc1
    v_mfma_f32_16x16x32_bf16 v[68:71], v[180:183], v[236:239], v[68:71]
    v_mfma_f32_16x16x32_bf16 v[36:39], v[168:171], v[232:235], 0
    v_mfma_f32_16x16x32_bf16 v[36:39], v[172:175], v[236:239], v[36:39]
    buffer_load_dwordx4 v[204:207], v250, s[60:63], s46 offen offset:3072 sc1
    v_mfma_f32_16x16x32_bf16 v[4:7], v[160:163], v[232:235], 0
    v_mfma_f32_16x16x32_bf16 v[4:7], v[164:167], v[236:239], v[4:7]
    s_waitcnt lgkmcnt(2)
    v_mfma_f32_16x16x32_bf16 v[8:11], v[160:163], v[240:243], 0
    ds_read_b128 v[232:235], v248 offset:40960
    v_mfma_f32_16x16x32_bf16 v[8:11], v[164:167], v[244:247], v[8:11]
    ds_read_b128 v[236:239], v248 offset:41984
    v_mfma_f32_16x16x32_bf16 v[40:43], v[168:171], v[240:243], 0
    buffer_load_dwordx4 v[208:211], v250, s[60:63], s47 offen offset:0 sc1
    v_mfma_f32_16x16x32_bf16 v[40:43], v[172:175], v[244:247], v[40:43]
    v_mfma_f32_16x16x32_bf16 v[72:75], v[176:179], v[240:243], 0
    v_mfma_f32_16x16x32_bf16 v[72:75], v[180:183], v[244:247], v[72:75]
    buffer_load_dwordx4 v[212:215], v250, s[60:63], s47 offen offset:1024 sc1
    v_mfma_f32_16x16x32_bf16 v[104:107], v[184:187], v[240:243], 0
    v_mfma_f32_16x16x32_bf16 v[104:107], v[188:191], v[244:247], v[104:107]
    s_waitcnt lgkmcnt(2)
    v_mfma_f32_16x16x32_bf16 v[108:111], v[184:187], v[224:227], 0
    ds_read_b128 v[240:243], v248 offset:43008
    v_mfma_f32_16x16x32_bf16 v[108:111], v[188:191], v[228:231], v[108:111]
    ds_read_b128 v[244:247], v248 offset:44032
    v_mfma_f32_16x16x32_bf16 v[76:79], v[176:179], v[224:227], 0
    buffer_load_dwordx4 v[216:219], v250, s[60:63], s47 offen offset:2048 sc1
    v_mfma_f32_16x16x32_bf16 v[76:79], v[180:183], v[228:231], v[76:79]
    v_mfma_f32_16x16x32_bf16 v[44:47], v[168:171], v[224:227], 0
    v_mfma_f32_16x16x32_bf16 v[44:47], v[172:175], v[228:231], v[44:47]
    buffer_load_dwordx4 v[220:223], v250, s[60:63], s47 offen offset:3072 sc1
    v_mfma_f32_16x16x32_bf16 v[12:15], v[160:163], v[224:227], 0
    s_barrier
    v_mfma_f32_16x16x32_bf16 v[12:15], v[164:167], v[228:231], v[12:15]
    s_waitcnt lgkmcnt(2)
    v_mfma_f32_16x16x32_bf16 v[16:19], v[160:163], v[232:235], 0
    ds_read_b128 v[224:227], v248 offset:45056
    v_mfma_f32_16x16x32_bf16 v[16:19], v[164:167], v[236:239], v[16:19]
    ds_read_b128 v[228:231], v248 offset:46080
    v_mfma_f32_16x16x32_bf16 v[48:51], v[168:171], v[232:235], 0
    v_mfma_f32_16x16x32_bf16 v[48:51], v[172:175], v[236:239], v[48:51]
    v_mfma_f32_16x16x32_bf16 v[80:83], v[176:179], v[232:235], 0
    v_mfma_f32_16x16x32_bf16 v[80:83], v[180:183], v[236:239], v[80:83]
    v_mfma_f32_16x16x32_bf16 v[112:115], v[184:187], v[232:235], 0
    v_mfma_f32_16x16x32_bf16 v[112:115], v[188:191], v[236:239], v[112:115]
    s_waitcnt lgkmcnt(2)
    v_mfma_f32_16x16x32_bf16 v[116:119], v[184:187], v[240:243], 0
    ds_read_b128 v[232:235], v248 offset:47104
    v_mfma_f32_16x16x32_bf16 v[116:119], v[188:191], v[244:247], v[116:119]
    ds_read_b128 v[236:239], v248 offset:48128
    v_mfma_f32_16x16x32_bf16 v[84:87], v[176:179], v[240:243], 0
    v_mfma_f32_16x16x32_bf16 v[84:87], v[180:183], v[244:247], v[84:87]
    v_mfma_f32_16x16x32_bf16 v[52:55], v[168:171], v[240:243], 0
    v_mfma_f32_16x16x32_bf16 v[52:55], v[172:175], v[244:247], v[52:55]
    v_mfma_f32_16x16x32_bf16 v[20:23], v[160:163], v[240:243], 0
    v_mfma_f32_16x16x32_bf16 v[20:23], v[164:167], v[244:247], v[20:23]
    s_waitcnt lgkmcnt(2)
    v_mfma_f32_16x16x32_bf16 v[24:27], v[160:163], v[224:227], 0
    ds_read_b128 v[240:243], v248 offset:49152
    v_mfma_f32_16x16x32_bf16 v[24:27], v[164:167], v[228:231], v[24:27]
    ds_read_b128 v[244:247], v248 offset:50176
    v_mfma_f32_16x16x32_bf16 v[56:59], v[168:171], v[224:227], 0
    v_mfma_f32_16x16x32_bf16 v[56:59], v[172:175], v[228:231], v[56:59]
    v_mfma_f32_16x16x32_bf16 v[88:91], v[176:179], v[224:227], 0
    v_mfma_f32_16x16x32_bf16 v[88:91], v[180:183], v[228:231], v[88:91]
    v_mfma_f32_16x16x32_bf16 v[120:123], v[184:187], v[224:227], 0
    v_mfma_f32_16x16x32_bf16 v[120:123], v[188:191], v[228:231], v[120:123]
    s_waitcnt lgkmcnt(2)
    v_mfma_f32_16x16x32_bf16 v[124:127], v[184:187], v[232:235], 0
    ds_read_b128 v[224:227], v248 offset:51200
    v_mfma_f32_16x16x32_bf16 v[124:127], v[188:191], v[236:239], v[124:127]
    ds_read_b128 v[228:231], v248 offset:52224
    v_mfma_f32_16x16x32_bf16 v[92:95], v[176:179], v[232:235], 0
    v_mfma_f32_16x16x32_bf16 v[92:95], v[180:183], v[236:239], v[92:95]
    s_mov_b32 s46, 1081344
    v_mfma_f32_16x16x32_bf16 v[60:63], v[168:171], v[232:235], 0
    s_mov_b32 s47, 1085440
    v_mfma_f32_16x16x32_bf16 v[60:63], v[172:175], v[236:239], v[60:63]
    v_mfma_f32_16x16x32_bf16 v[28:31], v[160:163], v[232:235], 0
    v_mfma_f32_16x16x32_bf16 v[28:31], v[164:167], v[236:239], v[28:31]
    s_waitcnt vmcnt(4) lgkmcnt(2)
    v_mfma_f32_16x16x32_bf16 v[0:3], v[192:195], v[240:243], v[0:3]
    ds_read_b128 v[232:235], v248 offset:53248
    v_mfma_f32_16x16x32_bf16 v[0:3], v[196:199], v[244:247], v[0:3]
    ds_read_b128 v[236:239], v248 offset:54272
    v_mfma_f32_16x16x32_bf16 v[32:35], v[200:203], v[240:243], v[32:35]
    buffer_load_dwordx4 v[160:163], v250, s[60:63], s46 offen offset:0 sc1
    v_mfma_f32_16x16x32_bf16 v[32:35], v[204:207], v[244:247], v[32:35]
    s_waitcnt vmcnt(1)
    v_mfma_f32_16x16x32_bf16 v[64:67], v[208:211], v[240:243], v[64:67]
    v_mfma_f32_16x16x32_bf16 v[64:67], v[212:215], v[244:247], v[64:67]
    buffer_load_dwordx4 v[164:167], v250, s[60:63], s46 offen offset:1024 sc1
    v_mfma_f32_16x16x32_bf16 v[96:99], v[216:219], v[240:243], v[96:99]
    v_mfma_f32_16x16x32_bf16 v[96:99], v[220:223], v[244:247], v[96:99]
    s_waitcnt lgkmcnt(2)
    v_mfma_f32_16x16x32_bf16 v[100:103], v[216:219], v[224:227], v[100:103]
    ds_read_b128 v[240:243], v248 offset:55296
    v_mfma_f32_16x16x32_bf16 v[100:103], v[220:223], v[228:231], v[100:103]
    ds_read_b128 v[244:247], v248 offset:56320
    v_mfma_f32_16x16x32_bf16 v[68:71], v[208:211], v[224:227], v[68:71]
    buffer_load_dwordx4 v[168:171], v250, s[60:63], s46 offen offset:2048 sc1
    v_mfma_f32_16x16x32_bf16 v[68:71], v[212:215], v[228:231], v[68:71]
    v_mfma_f32_16x16x32_bf16 v[36:39], v[200:203], v[224:227], v[36:39]
    v_mfma_f32_16x16x32_bf16 v[36:39], v[204:207], v[228:231], v[36:39]
    buffer_load_dwordx4 v[172:175], v250, s[60:63], s46 offen offset:3072 sc1
    v_mfma_f32_16x16x32_bf16 v[4:7], v[192:195], v[224:227], v[4:7]
    v_mfma_f32_16x16x32_bf16 v[4:7], v[196:199], v[228:231], v[4:7]
    s_waitcnt lgkmcnt(2)
    v_mfma_f32_16x16x32_bf16 v[8:11], v[192:195], v[232:235], v[8:11]
    ds_read_b128 v[224:227], v248 offset:57344
    v_mfma_f32_16x16x32_bf16 v[8:11], v[196:199], v[236:239], v[8:11]
    ds_read_b128 v[228:231], v248 offset:58368
    v_mfma_f32_16x16x32_bf16 v[40:43], v[200:203], v[232:235], v[40:43]
    buffer_load_dwordx4 v[176:179], v250, s[60:63], s47 offen offset:0 sc1
    v_mfma_f32_16x16x32_bf16 v[40:43], v[204:207], v[236:239], v[40:43]
    v_mfma_f32_16x16x32_bf16 v[72:75], v[208:211], v[232:235], v[72:75]
    v_mfma_f32_16x16x32_bf16 v[72:75], v[212:215], v[236:239], v[72:75]
    buffer_load_dwordx4 v[180:183], v250, s[60:63], s47 offen offset:1024 sc1
    v_mfma_f32_16x16x32_bf16 v[104:107], v[216:219], v[232:235], v[104:107]
    v_mfma_f32_16x16x32_bf16 v[104:107], v[220:223], v[236:239], v[104:107]
    s_waitcnt lgkmcnt(2)
    v_mfma_f32_16x16x32_bf16 v[108:111], v[216:219], v[240:243], v[108:111]
    ds_read_b128 v[232:235], v248 offset:59392
    v_mfma_f32_16x16x32_bf16 v[108:111], v[220:223], v[244:247], v[108:111]
    ds_read_b128 v[236:239], v248 offset:60416
    v_mfma_f32_16x16x32_bf16 v[76:79], v[208:211], v[240:243], v[76:79]
    buffer_load_dwordx4 v[184:187], v250, s[60:63], s47 offen offset:2048 sc1
    v_mfma_f32_16x16x32_bf16 v[76:79], v[212:215], v[244:247], v[76:79]
    v_mfma_f32_16x16x32_bf16 v[44:47], v[200:203], v[240:243], v[44:47]
    v_mfma_f32_16x16x32_bf16 v[44:47], v[204:207], v[244:247], v[44:47]
    buffer_load_dwordx4 v[188:191], v250, s[60:63], s47 offen offset:3072 sc1
    v_mfma_f32_16x16x32_bf16 v[12:15], v[192:195], v[240:243], v[12:15]
    s_barrier
    v_mfma_f32_16x16x32_bf16 v[12:15], v[196:199], v[244:247], v[12:15]
    s_waitcnt lgkmcnt(2)
    v_mfma_f32_16x16x32_bf16 v[16:19], v[192:195], v[224:227], v[16:19]
    ds_read_b128 v[240:243], v248 offset:61440
    v_mfma_f32_16x16x32_bf16 v[16:19], v[196:199], v[228:231], v[16:19]
    ds_read_b128 v[244:247], v248 offset:62464
    v_mfma_f32_16x16x32_bf16 v[48:51], v[200:203], v[224:227], v[48:51]
    v_mfma_f32_16x16x32_bf16 v[48:51], v[204:207], v[228:231], v[48:51]
    v_mfma_f32_16x16x32_bf16 v[80:83], v[208:211], v[224:227], v[80:83]
    v_mfma_f32_16x16x32_bf16 v[80:83], v[212:215], v[228:231], v[80:83]
    v_mfma_f32_16x16x32_bf16 v[112:115], v[216:219], v[224:227], v[112:115]
    v_mfma_f32_16x16x32_bf16 v[112:115], v[220:223], v[228:231], v[112:115]
    s_waitcnt lgkmcnt(2)
    v_mfma_f32_16x16x32_bf16 v[116:119], v[216:219], v[232:235], v[116:119]
    ds_read_b128 v[224:227], v248 offset:63488
    v_mfma_f32_16x16x32_bf16 v[116:119], v[220:223], v[236:239], v[116:119]
    ds_read_b128 v[228:231], v248 offset:64512
    v_mfma_f32_16x16x32_bf16 v[84:87], v[208:211], v[232:235], v[84:87]
    v_mfma_f32_16x16x32_bf16 v[84:87], v[212:215], v[236:239], v[84:87]
    v_mfma_f32_16x16x32_bf16 v[52:55], v[200:203], v[232:235], v[52:55]
    v_mfma_f32_16x16x32_bf16 v[52:55], v[204:207], v[236:239], v[52:55]
    v_mfma_f32_16x16x32_bf16 v[20:23], v[192:195], v[232:235], v[20:23]
    v_mfma_f32_16x16x32_bf16 v[20:23], v[196:199], v[236:239], v[20:23]
    s_waitcnt lgkmcnt(2)
    v_mfma_f32_16x16x32_bf16 v[24:27], v[192:195], v[240:243], v[24:27]
    ds_read_b128 v[232:235], v249 offset:32768
    v_mfma_f32_16x16x32_bf16 v[24:27], v[196:199], v[244:247], v[24:27]
    ds_read_b128 v[236:239], v249 offset:33792
    v_mfma_f32_16x16x32_bf16 v[56:59], v[200:203], v[240:243], v[56:59]
    v_mfma_f32_16x16x32_bf16 v[56:59], v[204:207], v[244:247], v[56:59]
    v_mfma_f32_16x16x32_bf16 v[88:91], v[208:211], v[240:243], v[88:91]
    v_mfma_f32_16x16x32_bf16 v[88:91], v[212:215], v[244:247], v[88:91]
    v_mfma_f32_16x16x32_bf16 v[120:123], v[216:219], v[240:243], v[120:123]
    v_mfma_f32_16x16x32_bf16 v[120:123], v[220:223], v[244:247], v[120:123]
    s_waitcnt lgkmcnt(2)
    v_mfma_f32_16x16x32_bf16 v[124:127], v[216:219], v[224:227], v[124:127]
    ds_read_b128 v[240:243], v249 offset:34816
    v_mfma_f32_16x16x32_bf16 v[124:127], v[220:223], v[228:231], v[124:127]
    ds_read_b128 v[244:247], v249 offset:35840
    v_mfma_f32_16x16x32_bf16 v[92:95], v[208:211], v[224:227], v[92:95]
    v_mfma_f32_16x16x32_bf16 v[92:95], v[212:215], v[228:231], v[92:95]
    s_mov_b32 s46, 1089536
    v_mfma_f32_16x16x32_bf16 v[60:63], v[200:203], v[224:227], v[60:63]
    s_mov_b32 s47, 1093632
    v_mfma_f32_16x16x32_bf16 v[60:63], v[204:207], v[228:231], v[60:63]
    v_mfma_f32_16x16x32_bf16 v[28:31], v[192:195], v[224:227], v[28:31]
    v_mfma_f32_16x16x32_bf16 v[28:31], v[196:199], v[228:231], v[28:31]
    s_waitcnt vmcnt(4) lgkmcnt(2)
    v_mfma_f32_16x16x32_bf16 v[0:3], v[160:163], v[232:235], v[0:3]
    ds_read_b128 v[224:227], v249 offset:36864
    v_mfma_f32_16x16x32_bf16 v[0:3], v[164:167], v[236:239], v[0:3]
    ds_read_b128 v[228:231], v249 offset:37888
    v_mfma_f32_16x16x32_bf16 v[32:35], v[168:171], v[232:235], v[32:35]
    buffer_load_dwordx4 v[192:195], v250, s[60:63], s46 offen offset:0 sc1
    v_mfma_f32_16x16x32_bf16 v[32:35], v[172:175], v[236:239], v[32:35]
    s_waitcnt vmcnt(1)
    v_mfma_f32_16x16x32_bf16 v[64:67], v[176:179], v[232:235], v[64:67]
    v_mfma_f32_16x16x32_bf16 v[64:67], v[180:183], v[236:239], v[64:67]
    buffer_load_dwordx4 v[196:199], v250, s[60:63], s46 offen offset:1024 sc1
    v_mfma_f32_16x16x32_bf16 v[96:99], v[184:187], v[232:235], v[96:99]
    v_mfma_f32_16x16x32_bf16 v[96:99], v[188:191], v[236:239], v[96:99]
    s_waitcnt lgkmcnt(2)
    v_mfma_f32_16x16x32_bf16 v[100:103], v[184:187], v[240:243], v[100:103]
    ds_read_b128 v[232:235], v249 offset:38912
    v_mfma_f32_16x16x32_bf16 v[100:103], v[188:191], v[244:247], v[100:103]
    ds_read_b128 v[236:239], v249 offset:39936
    v_mfma_f32_16x16x32_bf16 v[68:71], v[176:179], v[240:243], v[68:71]
    buffer_load_dwordx4 v[200:203], v250, s[60:63], s46 offen offset:2048 sc1
    v_mfma_f32_16x16x32_bf16 v[68:71], v[180:183], v[244:247], v[68:71]
    v_mfma_f32_16x16x32_bf16 v[36:39], v[168:171], v[240:243], v[36:39]
    v_mfma_f32_16x16x32_bf16 v[36:39], v[172:175], v[244:247], v[36:39]
    buffer_load_dwordx4 v[204:207], v250, s[60:63], s46 offen offset:3072 sc1
    v_mfma_f32_16x16x32_bf16 v[4:7], v[160:163], v[240:243], v[4:7]
    v_mfma_f32_16x16x32_bf16 v[4:7], v[164:167], v[244:247], v[4:7]
    s_waitcnt lgkmcnt(2)
    v_mfma_f32_16x16x32_bf16 v[8:11], v[160:163], v[224:227], v[8:11]
    ds_read_b128 v[240:243], v249 offset:40960
    v_mfma_f32_16x16x32_bf16 v[8:11], v[164:167], v[228:231], v[8:11]
    ds_read_b128 v[244:247], v249 offset:41984
    v_mfma_f32_16x16x32_bf16 v[40:43], v[168:171], v[224:227], v[40:43]
    buffer_load_dwordx4 v[208:211], v250, s[60:63], s47 offen offset:0 sc1
    v_mfma_f32_16x16x32_bf16 v[40:43], v[172:175], v[228:231], v[40:43]
    v_mfma_f32_16x16x32_bf16 v[72:75], v[176:179], v[224:227], v[72:75]
    v_mfma_f32_16x16x32_bf16 v[72:75], v[180:183], v[228:231], v[72:75]
    buffer_load_dwordx4 v[212:215], v250, s[60:63], s47 offen offset:1024 sc1
    v_mfma_f32_16x16x32_bf16 v[104:107], v[184:187], v[224:227], v[104:107]
    v_mfma_f32_16x16x32_bf16 v[104:107], v[188:191], v[228:231], v[104:107]
    s_waitcnt lgkmcnt(2)
    v_mfma_f32_16x16x32_bf16 v[108:111], v[184:187], v[232:235], v[108:111]
    ds_read_b128 v[224:227], v249 offset:43008
    v_mfma_f32_16x16x32_bf16 v[108:111], v[188:191], v[236:239], v[108:111]
    ds_read_b128 v[228:231], v249 offset:44032
    v_mfma_f32_16x16x32_bf16 v[76:79], v[176:179], v[232:235], v[76:79]
    buffer_load_dwordx4 v[216:219], v250, s[60:63], s47 offen offset:2048 sc1
    v_mfma_f32_16x16x32_bf16 v[76:79], v[180:183], v[236:239], v[76:79]
    v_mfma_f32_16x16x32_bf16 v[44:47], v[168:171], v[232:235], v[44:47]
    v_mfma_f32_16x16x32_bf16 v[44:47], v[172:175], v[236:239], v[44:47]
    buffer_load_dwordx4 v[220:223], v250, s[60:63], s47 offen offset:3072 sc1
    v_mfma_f32_16x16x32_bf16 v[12:15], v[160:163], v[232:235], v[12:15]
    s_barrier
    v_mfma_f32_16x16x32_bf16 v[12:15], v[164:167], v[236:239], v[12:15]
    s_waitcnt lgkmcnt(2)
    v_mfma_f32_16x16x32_bf16 v[16:19], v[160:163], v[240:243], v[16:19]
    ds_read_b128 v[232:235], v249 offset:45056
    v_mfma_f32_16x16x32_bf16 v[16:19], v[164:167], v[244:247], v[16:19]
    ds_read_b128 v[236:239], v249 offset:46080
    v_mfma_f32_16x16x32_bf16 v[48:51], v[168:171], v[240:243], v[48:51]
    v_mfma_f32_16x16x32_bf16 v[48:51], v[172:175], v[244:247], v[48:51]
    v_mfma_f32_16x16x32_bf16 v[80:83], v[176:179], v[240:243], v[80:83]
    v_mfma_f32_16x16x32_bf16 v[80:83], v[180:183], v[244:247], v[80:83]
    v_mfma_f32_16x16x32_bf16 v[112:115], v[184:187], v[240:243], v[112:115]
    v_mfma_f32_16x16x32_bf16 v[112:115], v[188:191], v[244:247], v[112:115]
    s_waitcnt lgkmcnt(2)
    v_mfma_f32_16x16x32_bf16 v[116:119], v[184:187], v[224:227], v[116:119]
    ds_read_b128 v[240:243], v249 offset:47104
    v_mfma_f32_16x16x32_bf16 v[116:119], v[188:191], v[228:231], v[116:119]
    ds_read_b128 v[244:247], v249 offset:48128
    v_mfma_f32_16x16x32_bf16 v[84:87], v[176:179], v[224:227], v[84:87]
    v_mfma_f32_16x16x32_bf16 v[84:87], v[180:183], v[228:231], v[84:87]
    v_mfma_f32_16x16x32_bf16 v[52:55], v[168:171], v[224:227], v[52:55]
    v_mfma_f32_16x16x32_bf16 v[52:55], v[172:175], v[228:231], v[52:55]
    v_mfma_f32_16x16x32_bf16 v[20:23], v[160:163], v[224:227], v[20:23]
    v_mfma_f32_16x16x32_bf16 v[20:23], v[164:167], v[228:231], v[20:23]
    s_waitcnt lgkmcnt(2)
    v_mfma_f32_16x16x32_bf16 v[24:27], v[160:163], v[232:235], v[24:27]
    ds_read_b128 v[224:227], v249 offset:49152
    v_mfma_f32_16x16x32_bf16 v[24:27], v[164:167], v[236:239], v[24:27]
    ds_read_b128 v[228:231], v249 offset:50176
    v_mfma_f32_16x16x32_bf16 v[56:59], v[168:171], v[232:235], v[56:59]
    v_mfma_f32_16x16x32_bf16 v[56:59], v[172:175], v[236:239], v[56:59]
    v_mfma_f32_16x16x32_bf16 v[88:91], v[176:179], v[232:235], v[88:91]
    v_mfma_f32_16x16x32_bf16 v[88:91], v[180:183], v[236:239], v[88:91]
    v_mfma_f32_16x16x32_bf16 v[120:123], v[184:187], v[232:235], v[120:123]
    v_mfma_f32_16x16x32_bf16 v[120:123], v[188:191], v[236:239], v[120:123]
    s_waitcnt lgkmcnt(2)
    v_mfma_f32_16x16x32_bf16 v[124:127], v[184:187], v[240:243], v[124:127]
    ds_read_b128 v[232:235], v249 offset:51200
    v_mfma_f32_16x16x32_bf16 v[124:127], v[188:191], v[244:247], v[124:127]
    ds_read_b128 v[236:239], v249 offset:52224
    v_mfma_f32_16x16x32_bf16 v[92:95], v[176:179], v[240:243], v[92:95]
    v_mfma_f32_16x16x32_bf16 v[92:95], v[180:183], v[244:247], v[92:95]
    s_mov_b32 s46, 1048576
    v_mfma_f32_16x16x32_bf16 v[60:63], v[168:171], v[240:243], v[60:63]
    s_mov_b32 s47, 1052672
    v_mfma_f32_16x16x32_bf16 v[60:63], v[172:175], v[244:247], v[60:63]
    v_mfma_f32_16x16x32_bf16 v[28:31], v[160:163], v[240:243], v[28:31]
    v_mfma_f32_16x16x32_bf16 v[28:31], v[164:167], v[244:247], v[28:31]
    s_waitcnt vmcnt(4) lgkmcnt(2)
    v_mfma_f32_16x16x32_bf16 v[0:3], v[192:195], v[224:227], v[0:3]
    ds_read_b128 v[240:243], v249 offset:53248
    v_mfma_f32_16x16x32_bf16 v[0:3], v[196:199], v[228:231], v[0:3]
    ds_read_b128 v[244:247], v249 offset:54272
    v_mfma_f32_16x16x32_bf16 v[32:35], v[200:203], v[224:227], v[32:35]
    buffer_load_dwordx4 v[160:163], v250, s[60:63], s46 offen offset:0 sc1
    v_mfma_f32_16x16x32_bf16 v[32:35], v[204:207], v[228:231], v[32:35]
    s_waitcnt vmcnt(1)
    v_mfma_f32_16x16x32_bf16 v[64:67], v[208:211], v[224:227], v[64:67]
    v_mfma_f32_16x16x32_bf16 v[64:67], v[212:215], v[228:231], v[64:67]
    buffer_load_dwordx4 v[164:167], v250, s[60:63], s46 offen offset:1024 sc1
    v_mfma_f32_16x16x32_bf16 v[96:99], v[216:219], v[224:227], v[96:99]
    v_mfma_f32_16x16x32_bf16 v[96:99], v[220:223], v[228:231], v[96:99]
    s_waitcnt lgkmcnt(2)
    v_mfma_f32_16x16x32_bf16 v[100:103], v[216:219], v[232:235], v[100:103]
    ds_read_b128 v[224:227], v249 offset:55296
    v_mfma_f32_16x16x32_bf16 v[100:103], v[220:223], v[236:239], v[100:103]
    ds_read_b128 v[228:231], v249 offset:56320
    v_mfma_f32_16x16x32_bf16 v[68:71], v[208:211], v[232:235], v[68:71]
    buffer_load_dwordx4 v[168:171], v250, s[60:63], s46 offen offset:2048 sc1
    v_mfma_f32_16x16x32_bf16 v[68:71], v[212:215], v[236:239], v[68:71]
    v_mfma_f32_16x16x32_bf16 v[36:39], v[200:203], v[232:235], v[36:39]
    v_mfma_f32_16x16x32_bf16 v[36:39], v[204:207], v[236:239], v[36:39]
    buffer_load_dwordx4 v[172:175], v250, s[60:63], s46 offen offset:3072 sc1
    v_mfma_f32_16x16x32_bf16 v[4:7], v[192:195], v[232:235], v[4:7]
    v_mfma_f32_16x16x32_bf16 v[4:7], v[196:199], v[236:239], v[4:7]
    s_waitcnt lgkmcnt(2)
    v_mfma_f32_16x16x32_bf16 v[8:11], v[192:195], v[240:243], v[8:11]
    ds_read_b128 v[232:235], v249 offset:57344
    v_mfma_f32_16x16x32_bf16 v[8:11], v[196:199], v[244:247], v[8:11]
    ds_read_b128 v[236:239], v249 offset:58368
    v_mfma_f32_16x16x32_bf16 v[40:43], v[200:203], v[240:243], v[40:43]
    buffer_load_dwordx4 v[176:179], v250, s[60:63], s47 offen offset:0 sc1
    v_mfma_f32_16x16x32_bf16 v[40:43], v[204:207], v[244:247], v[40:43]
    v_mfma_f32_16x16x32_bf16 v[72:75], v[208:211], v[240:243], v[72:75]
    v_mfma_f32_16x16x32_bf16 v[72:75], v[212:215], v[244:247], v[72:75]
    buffer_load_dwordx4 v[180:183], v250, s[60:63], s47 offen offset:1024 sc1
    v_mfma_f32_16x16x32_bf16 v[104:107], v[216:219], v[240:243], v[104:107]
    v_mfma_f32_16x16x32_bf16 v[104:107], v[220:223], v[244:247], v[104:107]
    s_waitcnt lgkmcnt(2)
    v_mfma_f32_16x16x32_bf16 v[108:111], v[216:219], v[224:227], v[108:111]
    ds_read_b128 v[240:243], v249 offset:59392
    v_mfma_f32_16x16x32_bf16 v[108:111], v[220:223], v[228:231], v[108:111]
    ds_read_b128 v[244:247], v249 offset:60416
    v_mfma_f32_16x16x32_bf16 v[76:79], v[208:211], v[224:227], v[76:79]
    buffer_load_dwordx4 v[184:187], v250, s[60:63], s47 offen offset:2048 sc1
    v_mfma_f32_16x16x32_bf16 v[76:79], v[212:215], v[228:231], v[76:79]
    v_mfma_f32_16x16x32_bf16 v[44:47], v[200:203], v[224:227], v[44:47]
    v_mfma_f32_16x16x32_bf16 v[44:47], v[204:207], v[228:231], v[44:47]
    buffer_load_dwordx4 v[188:191], v250, s[60:63], s47 offen offset:3072 sc1
    v_mfma_f32_16x16x32_bf16 v[12:15], v[192:195], v[224:227], v[12:15]
    s_barrier
    v_mfma_f32_16x16x32_bf16 v[12:15], v[196:199], v[228:231], v[12:15]
    s_waitcnt lgkmcnt(2)
    v_mfma_f32_16x16x32_bf16 v[16:19], v[192:195], v[232:235], v[16:19]
    ds_read_b128 v[224:227], v249 offset:61440
    v_mfma_f32_16x16x32_bf16 v[16:19], v[196:199], v[236:239], v[16:19]
    ds_read_b128 v[228:231], v249 offset:62464
    v_mfma_f32_16x16x32_bf16 v[48:51], v[200:203], v[232:235], v[48:51]
    v_mfma_f32_16x16x32_bf16 v[48:51], v[204:207], v[236:239], v[48:51]
    v_mfma_f32_16x16x32_bf16 v[80:83], v[208:211], v[232:235], v[80:83]
    s_setprio 2
    v_mfma_f32_16x16x32_bf16 v[80:83], v[212:215], v[236:239], v[80:83]
    v_mfma_f32_16x16x32_bf16 v[112:115], v[216:219], v[232:235], v[112:115]
    v_mfma_f32_16x16x32_bf16 v[112:115], v[220:223], v[236:239], v[112:115]
    s_waitcnt lgkmcnt(2)
    v_mfma_f32_16x16x32_bf16 v[116:119], v[216:219], v[240:243], v[116:119]
    ds_read_b128 v[232:235], v249 offset:63488
    v_mfma_f32_16x16x32_bf16 v[116:119], v[220:223], v[244:247], v[116:119]
    ds_read_b128 v[236:239], v249 offset:64512
    v_mfma_f32_16x16x32_bf16 v[84:87], v[208:211], v[240:243], v[84:87]
    v_mfma_f32_16x16x32_bf16 v[84:87], v[212:215], v[244:247], v[84:87]
    v_mfma_f32_16x16x32_bf16 v[52:55], v[200:203], v[240:243], v[52:55]
    v_mfma_f32_16x16x32_bf16 v[52:55], v[204:207], v[244:247], v[52:55]
    v_mfma_f32_16x16x32_bf16 v[20:23], v[192:195], v[240:243], v[20:23]
    v_mfma_f32_16x16x32_bf16 v[20:23], v[196:199], v[244:247], v[20:23]
    s_waitcnt lgkmcnt(2)
    v_mfma_f32_16x16x32_bf16 v[24:27], v[192:195], v[224:227], v[24:27]
    ds_read_b128 v[240:243], v249 offset:0
    v_mfma_f32_16x16x32_bf16 v[24:27], v[196:199], v[228:231], v[24:27]
    ds_read_b128 v[244:247], v249 offset:1024
    v_mfma_f32_16x16x32_bf16 v[56:59], v[200:203], v[224:227], v[56:59]
    v_mfma_f32_16x16x32_bf16 v[56:59], v[204:207], v[228:231], v[56:59]
    v_mfma_f32_16x16x32_bf16 v[88:91], v[208:211], v[224:227], v[88:91]
    v_mfma_f32_16x16x32_bf16 v[88:91], v[212:215], v[228:231], v[88:91]
    v_mfma_f32_16x16x32_bf16 v[120:123], v[216:219], v[224:227], v[120:123]
    v_mfma_f32_16x16x32_bf16 v[120:123], v[220:223], v[228:231], v[120:123]
    s_waitcnt lgkmcnt(2)
    v_mfma_f32_16x16x32_bf16 v[124:127], v[216:219], v[232:235], v[124:127]
    ds_read_b128 v[224:227], v249 offset:2048
    v_mfma_f32_16x16x32_bf16 v[124:127], v[220:223], v[236:239], v[124:127]
    ds_read_b128 v[228:231], v249 offset:3072
    v_mfma_f32_16x16x32_bf16 v[92:95], v[208:211], v[232:235], v[92:95]
    v_mfma_f32_16x16x32_bf16 v[92:95], v[212:215], v[236:239], v[92:95]
    s_mov_b32 s46, 1056768
    v_mfma_f32_16x16x32_bf16 v[60:63], v[200:203], v[232:235], v[60:63]
    s_mov_b32 s47, 1060864
    v_mfma_f32_16x16x32_bf16 v[60:63], v[204:207], v[236:239], v[60:63]
    v_mfma_f32_16x16x32_bf16 v[28:31], v[192:195], v[232:235], v[28:31]
    v_mfma_f32_16x16x32_bf16 v[28:31], v[196:199], v[236:239], v[28:31]
    s_waitcnt vmcnt(4) lgkmcnt(2)
    v_mfma_f32_16x16x32_bf16 v[0:3], v[160:163], v[240:243], v[0:3]
    ds_read_b128 v[232:235], v249 offset:4096
    v_mfma_f32_16x16x32_bf16 v[0:3], v[164:167], v[244:247], v[0:3]
    ds_read_b128 v[236:239], v249 offset:5120
    v_mfma_f32_16x16x32_bf16 v[32:35], v[168:171], v[240:243], v[32:35]
    buffer_load_dwordx4 v[192:195], v250, s[60:63], s46 offen offset:0 sc1
    v_mfma_f32_16x16x32_bf16 v[32:35], v[172:175], v[244:247], v[32:35]
    s_waitcnt vmcnt(1)
    v_mfma_f32_16x16x32_bf16 v[64:67], v[176:179], v[240:243], v[64:67]
    v_mfma_f32_16x16x32_bf16 v[64:67], v[180:183], v[244:247], v[64:67]
    buffer_load_dwordx4 v[196:199], v250, s[60:63], s46 offen offset:1024 sc1
    v_mfma_f32_16x16x32_bf16 v[96:99], v[184:187], v[240:243], v[96:99]
    v_mfma_f32_16x16x32_bf16 v[96:99], v[188:191], v[244:247], v[96:99]
    s_waitcnt lgkmcnt(2)
    v_mfma_f32_16x16x32_bf16 v[100:103], v[184:187], v[224:227], v[100:103]
    ds_read_b128 v[240:243], v249 offset:6144
    v_mfma_f32_16x16x32_bf16 v[100:103], v[188:191], v[228:231], v[100:103]
    ds_read_b128 v[244:247], v249 offset:7168
    v_mfma_f32_16x16x32_bf16 v[68:71], v[176:179], v[224:227], v[68:71]
    buffer_load_dwordx4 v[200:203], v250, s[60:63], s46 offen offset:2048 sc1
    v_mfma_f32_16x16x32_bf16 v[68:71], v[180:183], v[228:231], v[68:71]
    v_mfma_f32_16x16x32_bf16 v[36:39], v[168:171], v[224:227], v[36:39]
    v_mfma_f32_16x16x32_bf16 v[36:39], v[172:175], v[228:231], v[36:39]
    buffer_load_dwordx4 v[204:207], v250, s[60:63], s46 offen offset:3072 sc1
    v_mfma_f32_16x16x32_bf16 v[4:7], v[160:163], v[224:227], v[4:7]
    v_mfma_f32_16x16x32_bf16 v[4:7], v[164:167], v[228:231], v[4:7]
    s_waitcnt lgkmcnt(2)
    v_mfma_f32_16x16x32_bf16 v[8:11], v[160:163], v[232:235], v[8:11]
    ds_read_b128 v[224:227], v249 offset:8192
    v_mfma_f32_16x16x32_bf16 v[8:11], v[164:167], v[236:239], v[8:11]
    ds_read_b128 v[228:231], v249 offset:9216
    v_mfma_f32_16x16x32_bf16 v[40:43], v[168:171], v[232:235], v[40:43]
    buffer_load_dwordx4 v[208:211], v250, s[60:63], s47 offen offset:0 sc1
    v_mfma_f32_16x16x32_bf16 v[40:43], v[172:175], v[236:239], v[40:43]
    v_mfma_f32_16x16x32_bf16 v[72:75], v[176:179], v[232:235], v[72:75]
    v_mfma_f32_16x16x32_bf16 v[72:75], v[180:183], v[236:239], v[72:75]
    buffer_load_dwordx4 v[212:215], v250, s[60:63], s47 offen offset:1024 sc1
    v_mfma_f32_16x16x32_bf16 v[104:107], v[184:187], v[232:235], v[104:107]
    v_mfma_f32_16x16x32_bf16 v[104:107], v[188:191], v[236:239], v[104:107]
    s_waitcnt lgkmcnt(2)
    v_mfma_f32_16x16x32_bf16 v[108:111], v[184:187], v[240:243], v[108:111]
    ds_read_b128 v[232:235], v249 offset:10240
    v_mfma_f32_16x16x32_bf16 v[108:111], v[188:191], v[244:247], v[108:111]
    ds_read_b128 v[236:239], v249 offset:11264
    v_mfma_f32_16x16x32_bf16 v[76:79], v[176:179], v[240:243], v[76:79]
    buffer_load_dwordx4 v[216:219], v250, s[60:63], s47 offen offset:2048 sc1
    v_mfma_f32_16x16x32_bf16 v[76:79], v[180:183], v[244:247], v[76:79]
    v_mfma_f32_16x16x32_bf16 v[44:47], v[168:171], v[240:243], v[44:47]
    v_mfma_f32_16x16x32_bf16 v[44:47], v[172:175], v[244:247], v[44:47]
    buffer_load_dwordx4 v[220:223], v250, s[60:63], s47 offen offset:3072 sc1
    v_mfma_f32_16x16x32_bf16 v[12:15], v[160:163], v[240:243], v[12:15]
    v_mfma_f32_16x16x32_bf16 v[12:15], v[164:167], v[244:247], v[12:15]
    s_waitcnt lgkmcnt(2)
    v_mfma_f32_16x16x32_bf16 v[16:19], v[160:163], v[224:227], v[16:19]
    ds_read_b128 v[240:243], v249 offset:12288
    v_mfma_f32_16x16x32_bf16 v[16:19], v[164:167], v[228:231], v[16:19]
    ds_read_b128 v[244:247], v249 offset:13312
    v_mfma_f32_16x16x32_bf16 v[48:51], v[168:171], v[224:227], v[48:51]
    v_mfma_f32_16x16x32_bf16 v[48:51], v[172:175], v[228:231], v[48:51]
    v_mfma_f32_16x16x32_bf16 v[80:83], v[176:179], v[224:227], v[80:83]
    v_mfma_f32_16x16x32_bf16 v[80:83], v[180:183], v[228:231], v[80:83]
    v_mfma_f32_16x16x32_bf16 v[112:115], v[184:187], v[224:227], v[112:115]
    v_mfma_f32_16x16x32_bf16 v[112:115], v[188:191], v[228:231], v[112:115]
    s_waitcnt lgkmcnt(2)
    v_mfma_f32_16x16x32_bf16 v[116:119], v[184:187], v[232:235], v[116:119]
    ds_read_b128 v[224:227], v249 offset:14336
    v_mfma_f32_16x16x32_bf16 v[116:119], v[188:191], v[236:239], v[116:119]
    ds_read_b128 v[228:231], v249 offset:15360
    v_mfma_f32_16x16x32_bf16 v[84:87], v[176:179], v[232:235], v[84:87]
    v_mfma_f32_16x16x32_bf16 v[84:87], v[180:183], v[236:239], v[84:87]
    v_mfma_f32_16x16x32_bf16 v[52:55], v[168:171], v[232:235], v[52:55]
    v_mfma_f32_16x16x32_bf16 v[52:55], v[172:175], v[236:239], v[52:55]
    v_mfma_f32_16x16x32_bf16 v[20:23], v[160:163], v[232:235], v[20:23]
    v_mfma_f32_16x16x32_bf16 v[20:23], v[164:167], v[236:239], v[20:23]
    s_waitcnt lgkmcnt(2)
    v_mfma_f32_16x16x32_bf16 v[24:27], v[160:163], v[240:243], v[24:27]
    ds_read_b128 v[232:235], v249 offset:16384
    v_mfma_f32_16x16x32_bf16 v[24:27], v[164:167], v[244:247], v[24:27]
    ds_read_b128 v[236:239], v249 offset:17408
    v_mfma_f32_16x16x32_bf16 v[56:59], v[168:171], v[240:243], v[56:59]
    v_mfma_f32_16x16x32_bf16 v[56:59], v[172:175], v[244:247], v[56:59]
    v_mfma_f32_16x16x32_bf16 v[88:91], v[176:179], v[240:243], v[88:91]
    v_mfma_f32_16x16x32_bf16 v[88:91], v[180:183], v[244:247], v[88:91]
    v_mfma_f32_16x16x32_bf16 v[120:123], v[184:187], v[240:243], v[120:123]
    v_mfma_f32_16x16x32_bf16 v[120:123], v[188:191], v[244:247], v[120:123]
    s_waitcnt lgkmcnt(2)
    v_mfma_f32_16x16x32_bf16 v[124:127], v[184:187], v[224:227], v[124:127]
    ds_read_b128 v[240:243], v248 offset:16384
    v_mfma_f32_16x16x32_bf16 v[124:127], v[188:191], v[228:231], v[124:127]
    ds_read_b128 v[244:247], v248 offset:17408
    v_mfma_f32_16x16x32_bf16 v[92:95], v[176:179], v[224:227], v[92:95]
    v_mfma_f32_16x16x32_bf16 v[92:95], v[180:183], v[228:231], v[92:95]
    s_mov_b32 s46, 1097728
    v_mfma_f32_16x16x32_bf16 v[60:63], v[168:171], v[224:227], v[60:63]
    s_mov_b32 s47, 1101824
    v_mfma_f32_16x16x32_bf16 v[60:63], v[172:175], v[228:231], v[60:63]
    v_mfma_f32_16x16x32_bf16 v[28:31], v[160:163], v[224:227], v[28:31]
    v_mfma_f32_16x16x32_bf16 v[28:31], v[164:167], v[228:231], v[28:31]
    s_waitcnt vmcnt(4) lgkmcnt(2)
    v_mfma_f32_16x16x32_bf16 v[0:3], v[192:195], v[232:235], v[0:3]
    ds_read_b128 v[224:227], v249 offset:18432
    v_mfma_f32_16x16x32_bf16 v[0:3], v[196:199], v[236:239], v[0:3]
    ds_read_b128 v[228:231], v249 offset:19456
    v_mfma_f32_16x16x32_bf16 v[32:35], v[200:203], v[232:235], v[32:35]
    buffer_load_dwordx4 v[160:163], v250, s[60:63], s46 offen offset:0 sc1
    v_mfma_f32_16x16x32_bf16 v[32:35], v[204:207], v[236:239], v[32:35]
    s_waitcnt vmcnt(1)
    buffer_load_dwordx4 v[164:167], v250, s[60:63], s46 offen offset:1024 sc1
    v_mfma_f32_16x16x32_bf16 v[64:67], v[208:211], v[232:235], v[64:67]
    buffer_load_dwordx4 v[168:171], v250, s[60:63], s46 offen offset:2048 sc1
    v_mfma_f32_16x16x32_bf16 v[64:67], v[212:215], v[236:239], v[64:67]
    buffer_load_dwordx4 v[172:175], v250, s[60:63], s46 offen offset:3072 sc1
    v_mfma_f32_16x16x32_bf16 v[96:99], v[216:219], v[232:235], v[96:99]
    buffer_load_dwordx4 v[176:179], v250, s[60:63], s47 offen offset:0 sc1
    v_mfma_f32_16x16x32_bf16 v[96:99], v[220:223], v[236:239], v[96:99]
    s_waitcnt lgkmcnt(2)
    v_mfma_f32_16x16x32_bf16 v[96:99], v[152:155], v[240:243], v[96:99]
    ds_read_b128 v[232:235], v248 offset:18432
    v_mfma_f32_16x16x32_bf16 v[96:99], v[156:159], v[244:247], v[96:99]
    ds_read_b128 v[236:239], v248 offset:19456
    v_mfma_f32_16x16x32_bf16 v[64:67], v[144:147], v[240:243], v[64:67]
    buffer_load_dwordx4 v[180:183], v250, s[60:63], s47 offen offset:1024 sc1
    v_mfma_f32_16x16x32_bf16 v[64:67], v[148:151], v[244:247], v[64:67]
    buffer_load_dwordx4 v[184:187], v250, s[60:63], s47 offen offset:2048 sc1
    v_mfma_f32_16x16x32_bf16 v[32:35], v[136:139], v[240:243], v[32:35]
    buffer_load_dwordx4 v[188:191], v250, s[60:63], s47 offen offset:3072 sc1
    v_mfma_f32_16x16x32_bf16 v[32:35], v[140:143], v[244:247], v[32:35]
    v_mfma_f32_16x16x32_bf16 v[0:3], v[128:131], v[240:243], v[0:3]
    v_mfma_f32_16x16x32_bf16 v[0:3], v[132:135], v[244:247], v[0:3]
    s_waitcnt lgkmcnt(2)
    v_mfma_f32_16x16x32_bf16 v[4:7], v[192:195], v[224:227], v[4:7]
    ds_read_b128 v[240:243], v249 offset:20480
    v_mfma_f32_16x16x32_bf16 v[4:7], v[196:199], v[228:231], v[4:7]
    ds_read_b128 v[244:247], v249 offset:21504
    v_mfma_f32_16x16x32_bf16 v[36:39], v[200:203], v[224:227], v[36:39]
    v_mfma_f32_16x16x32_bf16 v[36:39], v[204:207], v[228:231], v[36:39]
    v_mfma_f32_16x16x32_bf16 v[68:71], v[208:211], v[224:227], v[68:71]
    v_mfma_f32_16x16x32_bf16 v[68:71], v[212:215], v[228:231], v[68:71]
    v_mfma_f32_16x16x32_bf16 v[100:103], v[216:219], v[224:227], v[100:103]
    v_mfma_f32_16x16x32_bf16 v[100:103], v[220:223], v[228:231], v[100:103]
    s_waitcnt lgkmcnt(2)
    v_mfma_f32_16x16x32_bf16 v[100:103], v[152:155], v[232:235], v[100:103]
    ds_read_b128 v[224:227], v248 offset:20480
    v_mfma_f32_16x16x32_bf16 v[100:103], v[156:159], v[236:239], v[100:103]
    ds_read_b128 v[228:231], v248 offset:21504
    v_mfma_f32_16x16x32_bf16 v[68:71], v[144:147], v[232:235], v[68:71]
    v_mfma_f32_16x16x32_bf16 v[68:71], v[148:151], v[236:239], v[68:71]
    v_mfma_f32_16x16x32_bf16 v[36:39], v[136:139], v[232:235], v[36:39]
    v_mfma_f32_16x16x32_bf16 v[36:39], v[140:143], v[236:239], v[36:39]
    v_mfma_f32_16x16x32_bf16 v[4:7], v[128:131], v[232:235], v[4:7]
    v_mfma_f32_16x16x32_bf16 v[4:7], v[132:135], v[236:239], v[4:7]
    s_waitcnt lgkmcnt(2)
    v_mfma_f32_16x16x32_bf16 v[8:11], v[192:195], v[240:243], v[8:11]
    ds_read_b128 v[232:235], v248 offset:0
    v_mfma_f32_16x16x32_bf16 v[8:11], v[196:199], v[244:247], v[8:11]
    ds_read_b128 v[236:239], v248 offset:1024
    v_mfma_f32_16x16x32_bf16 v[40:43], v[200:203], v[240:243], v[40:43]
    v_mfma_f32_16x16x32_bf16 v[40:43], v[204:207], v[244:247], v[40:43]
    v_mfma_f32_16x16x32_bf16 v[72:75], v[208:211], v[240:243], v[72:75]
    v_mfma_f32_16x16x32_bf16 v[72:75], v[212:215], v[244:247], v[72:75]
    v_mfma_f32_16x16x32_bf16 v[104:107], v[216:219], v[240:243], v[104:107]
    v_mfma_f32_16x16x32_bf16 v[104:107], v[220:223], v[244:247], v[104:107]
    s_waitcnt lgkmcnt(2)
    v_mfma_f32_16x16x32_bf16 v[104:107], v[152:155], v[224:227], v[104:107]
    ds_read_b128 v[240:243], v248 offset:2048
    v_mfma_f32_16x16x32_bf16 v[104:107], v[156:159], v[228:231], v[104:107]
    ds_read_b128 v[244:247], v248 offset:3072
    v_mfma_f32_16x16x32_bf16 v[72:75], v[144:147], v[224:227], v[72:75]
    v_mfma_f32_16x16x32_bf16 v[72:75], v[148:151], v[228:231], v[72:75]
    v_mfma_f32_16x16x32_bf16 v[40:43], v[136:139], v[224:227], v[40:43]
    v_mfma_f32_16x16x32_bf16 v[40:43], v[140:143], v[228:231], v[40:43]
    v_mfma_f32_16x16x32_bf16 v[8:11], v[128:131], v[224:227], v[8:11]
    v_mfma_f32_16x16x32_bf16 v[8:11], v[132:135], v[228:231], v[8:11]
    s_waitcnt vmcnt(0) lgkmcnt(2)
    v_mfma_f32_16x16x32_bf16 v[0:3], v[160:163], v[232:235], v[0:3]
    ds_read_b128 v[224:227], v248 offset:4096
    v_mfma_f32_16x16x32_bf16 v[0:3], v[164:167], v[236:239], v[0:3]
    ds_read_b128 v[228:231], v248 offset:5120
    v_mfma_f32_16x16x32_bf16 v[32:35], v[168:171], v[232:235], v[32:35]
    v_mfma_f32_16x16x32_bf16 v[32:35], v[172:175], v[236:239], v[32:35]
    v_mfma_f32_16x16x32_bf16 v[64:67], v[176:179], v[232:235], v[64:67]
    v_mfma_f32_16x16x32_bf16 v[64:67], v[180:183], v[236:239], v[64:67]
    v_mfma_f32_16x16x32_bf16 v[96:99], v[184:187], v[232:235], v[96:99]
    v_mfma_f32_16x16x32_bf16 v[96:99], v[188:191], v[236:239], v[96:99]
    s_waitcnt lgkmcnt(2)
    v_mfma_f32_16x16x32_bf16 v[100:103], v[184:187], v[240:243], v[100:103]
    ds_read_b128 v[232:235], v249 offset:22528
    v_mfma_f32_16x16x32_bf16 v[100:103], v[188:191], v[244:247], v[100:103]
    ds_read_b128 v[236:239], v249 offset:23552
    v_mfma_f32_16x16x32_bf16 v[68:71], v[176:179], v[240:243], v[68:71]
    v_mfma_f32_16x16x32_bf16 v[68:71], v[180:183], v[244:247], v[68:71]
    v_mfma_f32_16x16x32_bf16 v[36:39], v[168:171], v[240:243], v[36:39]
    v_mfma_f32_16x16x32_bf16 v[36:39], v[172:175], v[244:247], v[36:39]
    v_mfma_f32_16x16x32_bf16 v[4:7], v[160:163], v[240:243], v[4:7]
    v_mfma_f32_16x16x32_bf16 v[4:7], v[164:167], v[244:247], v[4:7]
    s_waitcnt lgkmcnt(2)
    v_cvt_pk_bf16_f32 v0, v0, v1
    v_cvt_pk_bf16_f32 v1, v2, v3
    v_mfma_f32_16x16x32_bf16 v[8:11], v[160:163], v[224:227], v[8:11]
    ds_read_b128 v[240:243], v248 offset:6144
    v_cvt_pk_bf16_f32 v2, v32, v33
    v_cvt_pk_bf16_f32 v3, v34, v35
    v_mfma_f32_16x16x32_bf16 v[8:11], v[164:167], v[228:231], v[8:11]
    ds_read_b128 v[244:247], v248 offset:7168
    v_cvt_pk_bf16_f32 v32, v64, v65
    v_cvt_pk_bf16_f32 v33, v66, v67
    v_mfma_f32_16x16x32_bf16 v[40:43], v[168:171], v[224:227], v[40:43]
    v_cvt_pk_bf16_f32 v34, v96, v97
    v_cvt_pk_bf16_f32 v35, v98, v99
    v_mfma_f32_16x16x32_bf16 v[40:43], v[172:175], v[228:231], v[40:43]
    v_cndmask_b32_dpp v64, v32, v0, vcc quad_perm:[1,0,3,2] row_mask:0xf bank_mask:0xf
    v_cndmask_b32_dpp v65, v33, v1, vcc quad_perm:[1,0,3,2] row_mask:0xf bank_mask:0xf
    v_mfma_f32_16x16x32_bf16 v[72:75], v[176:179], v[224:227], v[72:75]
    v_cndmask_b32_dpp v66, v34, v2, vcc quad_perm:[1,0,3,2] row_mask:0xf bank_mask:0xf
    v_cndmask_b32_dpp v67, v35, v3, vcc quad_perm:[1,0,3,2] row_mask:0xf bank_mask:0xf
    v_mfma_f32_16x16x32_bf16 v[72:75], v[180:183], v[228:231], v[72:75]
    s_not_b64 vcc, vcc
    buffer_store_dwordx4 v[64:67], v252, s[16:19], 0 offen offset:0 nt
    v_mfma_f32_16x16x32_bf16 v[104:107], v[184:187], v[224:227], v[104:107]
    v_cndmask_b32_dpp v96, v0, v32, vcc quad_perm:[1,0,3,2] row_mask:0xf bank_mask:0xf
    v_cndmask_b32_dpp v97, v1, v33, vcc quad_perm:[1,0,3,2] row_mask:0xf bank_mask:0xf
    v_mfma_f32_16x16x32_bf16 v[104:107], v[188:191], v[228:231], v[104:107]
    s_waitcnt lgkmcnt(2)
    v_cndmask_b32_dpp v98, v2, v34, vcc quad_perm:[1,0,3,2] row_mask:0xf bank_mask:0xf
    v_cndmask_b32_dpp v99, v3, v35, vcc quad_perm:[1,0,3,2] row_mask:0xf bank_mask:0xf
    v_mfma_f32_16x16x32_bf16 v[108:111], v[216:219], v[232:235], v[108:111]
    ds_read_b128 v[224:227], v248 offset:22528
    buffer_store_dwordx4 v[96:99], v253, s[16:19], 0 offen offset:0 nt
    v_cvt_pk_bf16_f32 v4, v4, v5
    v_mfma_f32_16x16x32_bf16 v[108:111], v[220:223], v[236:239], v[108:111]
    ds_read_b128 v[228:231], v248 offset:23552
    v_cvt_pk_bf16_f32 v5, v6, v7
    v_cvt_pk_bf16_f32 v6, v36, v37
    v_mfma_f32_16x16x32_bf16 v[76:79], v[208:211], v[232:235], v[76:79]
    v_cvt_pk_bf16_f32 v7, v38, v39
    v_cvt_pk_bf16_f32 v36, v68, v69
    v_mfma_f32_16x16x32_bf16 v[76:79], v[212:215], v[236:239], v[76:79]
    v_cvt_pk_bf16_f32 v37, v70, v71
    v_cvt_pk_bf16_f32 v38, v100, v101
    v_mfma_f32_16x16x32_bf16 v[44:47], v[200:203], v[232:235], v[44:47]
    v_cvt_pk_bf16_f32 v39, v102, v103
    v_cndmask_b32_dpp v100, v4, v36, vcc quad_perm:[1,0,3,2] row_mask:0xf bank_mask:0xf
    v_mfma_f32_16x16x32_bf16 v[44:47], v[204:207], v[236:239], v[44:47]
    v_cndmask_b32_dpp v101, v5, v37, vcc quad_perm:[1,0,3,2] row_mask:0xf bank_mask:0xf
    v_cndmask_b32_dpp v102, v6, v38, vcc quad_perm:[1,0,3,2] row_mask:0xf bank_mask:0xf
    v_mfma_f32_16x16x32_bf16 v[12:15], v[192:195], v[232:235], v[12:15]
    v_cndmask_b32_dpp v103, v7, v39, vcc quad_perm:[1,0,3,2] row_mask:0xf bank_mask:0xf
    s_not_b64 vcc, vcc
    v_mfma_f32_16x16x32_bf16 v[12:15], v[196:199], v[236:239], v[12:15]
    s_waitcnt lgkmcnt(2)
    buffer_store_dwordx4 v[100:103], v253, s[16:19], 0 offen offset:1024 nt
    v_cndmask_b32_dpp v68, v36, v4, vcc quad_perm:[1,0,3,2] row_mask:0xf bank_mask:0xf
    v_mfma_f32_16x16x32_bf16 v[12:15], v[160:163], v[240:243], v[12:15]
    ds_read_b128 v[232:235], v249 offset:24576
    v_cndmask_b32_dpp v69, v37, v5, vcc quad_perm:[1,0,3,2] row_mask:0xf bank_mask:0xf
    v_cndmask_b32_dpp v70, v38, v6, vcc quad_perm:[1,0,3,2] row_mask:0xf bank_mask:0xf
    v_mfma_f32_16x16x32_bf16 v[12:15], v[164:167], v[244:247], v[12:15]
    ds_read_b128 v[236:239], v249 offset:25600
    v_cndmask_b32_dpp v71, v39, v7, vcc quad_perm:[1,0,3,2] row_mask:0xf bank_mask:0xf
    buffer_store_dwordx4 v[68:71], v252, s[16:19], 0 offen offset:1024 nt
    v_mfma_f32_16x16x32_bf16 v[44:47], v[168:171], v[240:243], v[44:47]
    v_cvt_pk_bf16_f32 v8, v8, v9
    v_cvt_pk_bf16_f32 v9, v10, v11
    v_mfma_f32_16x16x32_bf16 v[44:47], v[172:175], v[244:247], v[44:47]
    v_cvt_pk_bf16_f32 v10, v40, v41
    v_cvt_pk_bf16_f32 v11, v42, v43
    v_mfma_f32_16x16x32_bf16 v[76:79], v[176:179], v[240:243], v[76:79]
    v_cvt_pk_bf16_f32 v40, v72, v73
    v_cvt_pk_bf16_f32 v41, v74, v75
    v_mfma_f32_16x16x32_bf16 v[76:79], v[180:183], v[244:247], v[76:79]
    v_cvt_pk_bf16_f32 v42, v104, v105
    v_cvt_pk_bf16_f32 v43, v106, v107
    v_mfma_f32_16x16x32_bf16 v[108:111], v[184:187], v[240:243], v[108:111]
    v_cndmask_b32_dpp v72, v40, v8, vcc quad_perm:[1,0,3,2] row_mask:0xf bank_mask:0xf
    v_cndmask_b32_dpp v73, v41, v9, vcc quad_perm:[1,0,3,2] row_mask:0xf bank_mask:0xf
    v_mfma_f32_16x16x32_bf16 v[108:111], v[188:191], v[244:247], v[108:111]
    s_waitcnt lgkmcnt(2)
    v_cndmask_b32_dpp v74, v42, v10, vcc quad_perm:[1,0,3,2] row_mask:0xf bank_mask:0xf
    v_cndmask_b32_dpp v75, v43, v11, vcc quad_perm:[1,0,3,2] row_mask:0xf bank_mask:0xf
    v_mfma_f32_16x16x32_bf16 v[108:111], v[152:155], v[224:227], v[108:111]
    ds_read_b128 v[240:243], v248 offset:8192
    s_not_b64 vcc, vcc
    buffer_store_dwordx4 v[72:75], v252, s[16:19], 0 offen offset:2048 nt
    v_mfma_f32_16x16x32_bf16 v[108:111], v[156:159], v[228:231], v[108:111]
    ds_read_b128 v[244:247], v248 offset:9216
    v_cndmask_b32_dpp v104, v8, v40, vcc quad_perm:[1,0,3,2] row_mask:0xf bank_mask:0xf
    v_cndmask_b32_dpp v105, v9, v41, vcc quad_perm:[1,0,3,2] row_mask:0xf bank_mask:0xf
    v_mfma_f32_16x16x32_bf16 v[76:79], v[144:147], v[224:227], v[76:79]
    v_cndmask_b32_dpp v106, v10, v42, vcc quad_perm:[1,0,3,2] row_mask:0xf bank_mask:0xf
    v_cndmask_b32_dpp v107, v11, v43, vcc quad_perm:[1,0,3,2] row_mask:0xf bank_mask:0xf
    v_mfma_f32_16x16x32_bf16 v[76:79], v[148:151], v[228:231], v[76:79]
    buffer_store_dwordx4 v[104:107], v253, s[16:19], 0 offen offset:2048 nt
    v_mfma_f32_16x16x32_bf16 v[44:47], v[136:139], v[224:227], v[44:47]
    v_mfma_f32_16x16x32_bf16 v[44:47], v[140:143], v[228:231], v[44:47]
    v_mfma_f32_16x16x32_bf16 v[12:15], v[128:131], v[224:227], v[12:15]
    v_mfma_f32_16x16x32_bf16 v[12:15], v[132:135], v[228:231], v[12:15]
    s_waitcnt lgkmcnt(2)
    v_mfma_f32_16x16x32_bf16 v[16:19], v[192:195], v[232:235], v[16:19]
    ds_read_b128 v[224:227], v248 offset:24576
    v_mfma_f32_16x16x32_bf16 v[16:19], v[196:199], v[236:239], v[16:19]
    ds_read_b128 v[228:231], v248 offset:25600
    v_mfma_f32_16x16x32_bf16 v[48:51], v[200:203], v[232:235], v[48:51]
    v_mfma_f32_16x16x32_bf16 v[48:51], v[204:207], v[236:239], v[48:51]
    v_mfma_f32_16x16x32_bf16 v[80:83], v[208:211], v[232:235], v[80:83]
    v_mfma_f32_16x16x32_bf16 v[80:83], v[212:215], v[236:239], v[80:83]
    v_mfma_f32_16x16x32_bf16 v[112:115], v[216:219], v[232:235], v[112:115]
    v_mfma_f32_16x16x32_bf16 v[112:115], v[220:223], v[236:239], v[112:115]
    s_waitcnt lgkmcnt(2)
    v_cvt_pk_bf16_f32 v12, v12, v13
    v_cvt_pk_bf16_f32 v13, v14, v15
    v_mfma_f32_16x16x32_bf16 v[112:115], v[184:187], v[240:243], v[112:115]
    ds_read_b128 v[232:235], v249 offset:26624
    v_cvt_pk_bf16_f32 v14, v44, v45
    v_cvt_pk_bf16_f32 v15, v46, v47
    v_mfma_f32_16x16x32_bf16 v[112:115], v[188:191], v[244:247], v[112:115]
    ds_read_b128 v[236:239], v249 offset:27648
    v_cvt_pk_bf16_f32 v44, v76, v77
    v_cvt_pk_bf16_f32 v45, v78, v79
    v_mfma_f32_16x16x32_bf16 v[80:83], v[176:179], v[240:243], v[80:83]
    v_cvt_pk_bf16_f32 v46, v108, v109
    v_cvt_pk_bf16_f32 v47, v110, v111
    v_mfma_f32_16x16x32_bf16 v[80:83], v[180:183], v[244:247], v[80:83]
    v_cndmask_b32_dpp v108, v12, v44, vcc quad_perm:[1,0,3,2] row_mask:0xf bank_mask:0xf
    v_cndmask_b32_dpp v109, v13, v45, vcc quad_perm:[1,0,3,2] row_mask:0xf bank_mask:0xf
    v_mfma_f32_16x16x32_bf16 v[48:51], v[168:171], v[240:243], v[48:51]
    v_cndmask_b32_dpp v110, v14, v46, vcc quad_perm:[1,0,3,2] row_mask:0xf bank_mask:0xf
    v_cndmask_b32_dpp v111, v15, v47, vcc quad_perm:[1,0,3,2] row_mask:0xf bank_mask:0xf
    v_mfma_f32_16x16x32_bf16 v[48:51], v[172:175], v[244:247], v[48:51]
    s_not_b64 vcc, vcc
    buffer_store_dwordx4 v[108:111], v253, s[16:19], 0 offen offset:3072 nt
    v_mfma_f32_16x16x32_bf16 v[16:19], v[160:163], v[240:243], v[16:19]
    v_cndmask_b32_dpp v76, v44, v12, vcc quad_perm:[1,0,3,2] row_mask:0xf bank_mask:0xf
    v_cndmask_b32_dpp v77, v45, v13, vcc quad_perm:[1,0,3,2] row_mask:0xf bank_mask:0xf
    v_mfma_f32_16x16x32_bf16 v[16:19], v[164:167], v[244:247], v[16:19]
    s_waitcnt lgkmcnt(2)
    v_cndmask_b32_dpp v78, v46, v14, vcc quad_perm:[1,0,3,2] row_mask:0xf bank_mask:0xf
    v_cndmask_b32_dpp v79, v47, v15, vcc quad_perm:[1,0,3,2] row_mask:0xf bank_mask:0xf
    v_mfma_f32_16x16x32_bf16 v[16:19], v[128:131], v[224:227], v[16:19]
    ds_read_b128 v[240:243], v248 offset:10240
    buffer_store_dwordx4 v[76:79], v252, s[16:19], 0 offen offset:3072 nt
    v_mfma_f32_16x16x32_bf16 v[16:19], v[132:135], v[228:231], v[16:19]
    ds_read_b128 v[244:247], v248 offset:11264
    v_mfma_f32_16x16x32_bf16 v[48:51], v[136:139], v[224:227], v[48:51]
    v_mfma_f32_16x16x32_bf16 v[48:51], v[140:143], v[228:231], v[48:51]
    v_mfma_f32_16x16x32_bf16 v[80:83], v[144:147], v[224:227], v[80:83]
    v_mfma_f32_16x16x32_bf16 v[80:83], v[148:151], v[228:231], v[80:83]
    v_mfma_f32_16x16x32_bf16 v[112:115], v[152:155], v[224:227], v[112:115]
    v_mfma_f32_16x16x32_bf16 v[112:115], v[156:159], v[228:231], v[112:115]
    s_waitcnt lgkmcnt(2)
    v_mfma_f32_16x16x32_bf16 v[116:119], v[216:219], v[232:235], v[116:119]
    ds_read_b128 v[224:227], v248 offset:26624
    v_mfma_f32_16x16x32_bf16 v[116:119], v[220:223], v[236:239], v[116:119]
    ds_read_b128 v[228:231], v248 offset:27648
    v_mfma_f32_16x16x32_bf16 v[84:87], v[208:211], v[232:235], v[84:87]
    v_mfma_f32_16x16x32_bf16 v[84:87], v[212:215], v[236:239], v[84:87]
    v_mfma_f32_16x16x32_bf16 v[52:55], v[200:203], v[232:235], v[52:55]
    v_mfma_f32_16x16x32_bf16 v[52:55], v[204:207], v[236:239], v[52:55]
    v_mfma_f32_16x16x32_bf16 v[20:23], v[192:195], v[232:235], v[20:23]
    v_mfma_f32_16x16x32_bf16 v[20:23], v[196:199], v[236:239], v[20:23]
    s_waitcnt lgkmcnt(2)
    v_cvt_pk_bf16_f32 v16, v16, v17
    v_cvt_pk_bf16_f32 v17, v18, v19
    v_mfma_f32_16x16x32_bf16 v[20:23], v[160:163], v[240:243], v[20:23]
    ds_read_b128 v[232:235], v249 offset:28672
    v_cvt_pk_bf16_f32 v18, v48, v49
    v_cvt_pk_bf16_f32 v19, v50, v51
    v_mfma_f32_16x16x32_bf16 v[20:23], v[164:167], v[244:247], v[20:23]
    ds_read_b128 v[236:239], v249 offset:29696
    v_cvt_pk_bf16_f32 v48, v80, v81
    v_cvt_pk_bf16_f32 v49, v82, v83
    v_mfma_f32_16x16x32_bf16 v[52:55], v[168:171], v[240:243], v[52:55]
    v_cvt_pk_bf16_f32 v50, v112, v113
    v_cvt_pk_bf16_f32 v51, v114, v115
    v_mfma_f32_16x16x32_bf16 v[52:55], v[172:175], v[244:247], v[52:55]
    v_cndmask_b32_dpp v80, v48, v16, vcc quad_perm:[1,0,3,2] row_mask:0xf bank_mask:0xf
    v_cndmask_b32_dpp v81, v49, v17, vcc quad_perm:[1,0,3,2] row_mask:0xf bank_mask:0xf
    v_mfma_f32_16x16x32_bf16 v[84:87], v[176:179], v[240:243], v[84:87]
    v_cndmask_b32_dpp v82, v50, v18, vcc quad_perm:[1,0,3,2] row_mask:0xf bank_mask:0xf
    v_cndmask_b32_dpp v83, v51, v19, vcc quad_perm:[1,0,3,2] row_mask:0xf bank_mask:0xf
    v_mfma_f32_16x16x32_bf16 v[84:87], v[180:183], v[244:247], v[84:87]
    s_not_b64 vcc, vcc
    buffer_store_dwordx4 v[80:83], v252, s[16:19], s49 offen offset:0 nt
    v_mfma_f32_16x16x32_bf16 v[116:119], v[184:187], v[240:243], v[116:119]
    v_cndmask_b32_dpp v112, v16, v48, vcc quad_perm:[1,0,3,2] row_mask:0xf bank_mask:0xf
    v_cndmask_b32_dpp v113, v17, v49, vcc quad_perm:[1,0,3,2] row_mask:0xf bank_mask:0xf
    v_mfma_f32_16x16x32_bf16 v[116:119], v[188:191], v[244:247], v[116:119]
    s_waitcnt lgkmcnt(2)
    v_cndmask_b32_dpp v114, v18, v50, vcc quad_perm:[1,0,3,2] row_mask:0xf bank_mask:0xf
    v_cndmask_b32_dpp v115, v19, v51, vcc quad_perm:[1,0,3,2] row_mask:0xf bank_mask:0xf
    v_mfma_f32_16x16x32_bf16 v[116:119], v[152:155], v[224:227], v[116:119]
    ds_read_b128 v[240:243], v248 offset:12288
    buffer_store_dwordx4 v[112:115], v253, s[16:19], s49 offen offset:0 nt
    v_mfma_f32_16x16x32_bf16 v[116:119], v[156:159], v[228:231], v[116:119]
    ds_read_b128 v[244:247], v248 offset:13312
    v_mfma_f32_16x16x32_bf16 v[84:87], v[144:147], v[224:227], v[84:87]
    v_mfma_f32_16x16x32_bf16 v[84:87], v[148:151], v[228:231], v[84:87]
    v_mfma_f32_16x16x32_bf16 v[52:55], v[136:139], v[224:227], v[52:55]
    v_mfma_f32_16x16x32_bf16 v[52:55], v[140:143], v[228:231], v[52:55]
    v_mfma_f32_16x16x32_bf16 v[20:23], v[128:131], v[224:227], v[20:23]
    v_mfma_f32_16x16x32_bf16 v[20:23], v[132:135], v[228:231], v[20:23]
    s_waitcnt lgkmcnt(2)
    v_mfma_f32_16x16x32_bf16 v[24:27], v[192:195], v[232:235], v[24:27]
    ds_read_b128 v[224:227], v248 offset:28672
    v_mfma_f32_16x16x32_bf16 v[24:27], v[196:199], v[236:239], v[24:27]
    ds_read_b128 v[228:231], v248 offset:29696
    v_mfma_f32_16x16x32_bf16 v[56:59], v[200:203], v[232:235], v[56:59]
    v_mfma_f32_16x16x32_bf16 v[56:59], v[204:207], v[236:239], v[56:59]
    v_mfma_f32_16x16x32_bf16 v[88:91], v[208:211], v[232:235], v[88:91]
    v_mfma_f32_16x16x32_bf16 v[88:91], v[212:215], v[236:239], v[88:91]
    v_mfma_f32_16x16x32_bf16 v[120:123], v[216:219], v[232:235], v[120:123]
    v_mfma_f32_16x16x32_bf16 v[120:123], v[220:223], v[236:239], v[120:123]
    s_waitcnt lgkmcnt(2)
    v_cvt_pk_bf16_f32 v20, v20, v21
    v_cvt_pk_bf16_f32 v21, v22, v23
    v_mfma_f32_16x16x32_bf16 v[120:123], v[184:187], v[240:243], v[120:123]
    ds_read_b128 v[232:235], v249 offset:30720
    v_cvt_pk_bf16_f32 v22, v52, v53
    v_cvt_pk_bf16_f32 v23, v54, v55
    v_mfma_f32_16x16x32_bf16 v[120:123], v[188:191], v[244:247], v[120:123]
    ds_read_b128 v[236:239], v249 offset:31744
    v_cvt_pk_bf16_f32 v52, v84, v85
    v_cvt_pk_bf16_f32 v53, v86, v87
    v_mfma_f32_16x16x32_bf16 v[88:91], v[176:179], v[240:243], v[88:91]
    v_cvt_pk_bf16_f32 v54, v116, v117
    v_cvt_pk_bf16_f32 v55, v118, v119
    v_mfma_f32_16x16x32_bf16 v[88:91], v[180:183], v[244:247], v[88:91]
    v_cndmask_b32_dpp v116, v20, v52, vcc quad_perm:[1,0,3,2] row_mask:0xf bank_mask:0xf
    v_cndmask_b32_dpp v117, v21, v53, vcc quad_perm:[1,0,3,2] row_mask:0xf bank_mask:0xf
    v_mfma_f32_16x16x32_bf16 v[56:59], v[168:171], v[240:243], v[56:59]
    v_cndmask_b32_dpp v118, v22, v54, vcc quad_perm:[1,0,3,2] row_mask:0xf bank_mask:0xf
    v_cndmask_b32_dpp v119, v23, v55, vcc quad_perm:[1,0,3,2] row_mask:0xf bank_mask:0xf
    v_mfma_f32_16x16x32_bf16 v[56:59], v[172:175], v[244:247], v[56:59]
    s_not_b64 vcc, vcc
    buffer_store_dwordx4 v[116:119], v253, s[16:19], s49 offen offset:1024 nt
    v_mfma_f32_16x16x32_bf16 v[24:27], v[160:163], v[240:243], v[24:27]
    v_cndmask_b32_dpp v84, v52, v20, vcc quad_perm:[1,0,3,2] row_mask:0xf bank_mask:0xf
    v_cndmask_b32_dpp v85, v53, v21, vcc quad_perm:[1,0,3,2] row_mask:0xf bank_mask:0xf
    v_mfma_f32_16x16x32_bf16 v[24:27], v[164:167], v[244:247], v[24:27]
    s_waitcnt lgkmcnt(2)
    v_cndmask_b32_dpp v86, v54, v22, vcc quad_perm:[1,0,3,2] row_mask:0xf bank_mask:0xf
    v_cndmask_b32_dpp v87, v55, v23, vcc quad_perm:[1,0,3,2] row_mask:0xf bank_mask:0xf
    v_mfma_f32_16x16x32_bf16 v[24:27], v[128:131], v[224:227], v[24:27]
    ds_read_b128 v[240:243], v248 offset:14336
    buffer_store_dwordx4 v[84:87], v252, s[16:19], s49 offen offset:1024 nt
    v_mfma_f32_16x16x32_bf16 v[24:27], v[132:135], v[228:231], v[24:27]
    ds_read_b128 v[244:247], v248 offset:15360
    v_mfma_f32_16x16x32_bf16 v[56:59], v[136:139], v[224:227], v[56:59]
    v_mfma_f32_16x16x32_bf16 v[56:59], v[140:143], v[228:231], v[56:59]
    v_mfma_f32_16x16x32_bf16 v[88:91], v[144:147], v[224:227], v[88:91]
    v_mfma_f32_16x16x32_bf16 v[88:91], v[148:151], v[228:231], v[88:91]
    v_mfma_f32_16x16x32_bf16 v[120:123], v[152:155], v[224:227], v[120:123]
    v_mfma_f32_16x16x32_bf16 v[120:123], v[156:159], v[228:231], v[120:123]
    s_waitcnt lgkmcnt(2)
    v_mfma_f32_16x16x32_bf16 v[124:127], v[216:219], v[232:235], v[124:127]
    ds_read_b128 v[224:227], v248 offset:30720
    v_mfma_f32_16x16x32_bf16 v[124:127], v[220:223], v[236:239], v[124:127]
    ds_read_b128 v[228:231], v248 offset:31744
    v_mfma_f32_16x16x32_bf16 v[92:95], v[208:211], v[232:235], v[92:95]
    v_mfma_f32_16x16x32_bf16 v[92:95], v[212:215], v[236:239], v[92:95]
    v_mfma_f32_16x16x32_bf16 v[60:63], v[200:203], v[232:235], v[60:63]
    v_mfma_f32_16x16x32_bf16 v[60:63], v[204:207], v[236:239], v[60:63]
    v_mfma_f32_16x16x32_bf16 v[28:31], v[192:195], v[232:235], v[28:31]
    v_mfma_f32_16x16x32_bf16 v[28:31], v[196:199], v[236:239], v[28:31]
    s_waitcnt lgkmcnt(2)
    v_cvt_pk_bf16_f32 v24, v24, v25
    v_cvt_pk_bf16_f32 v25, v26, v27
    v_mfma_f32_16x16x32_bf16 v[28:31], v[160:163], v[240:243], v[28:31]
    v_cvt_pk_bf16_f32 v26, v56, v57
    v_cvt_pk_bf16_f32 v27, v58, v59
    v_mfma_f32_16x16x32_bf16 v[28:31], v[164:167], v[244:247], v[28:31]
    v_cvt_pk_bf16_f32 v56, v88, v89
    v_cvt_pk_bf16_f32 v57, v90, v91
    v_mfma_f32_16x16x32_bf16 v[60:63], v[168:171], v[240:243], v[60:63]
    v_cvt_pk_bf16_f32 v58, v120, v121
    v_cvt_pk_bf16_f32 v59, v122, v123
    v_mfma_f32_16x16x32_bf16 v[60:63], v[172:175], v[244:247], v[60:63]
    v_cndmask_b32_dpp v88, v56, v24, vcc quad_perm:[1,0,3,2] row_mask:0xf bank_mask:0xf
    v_cndmask_b32_dpp v89, v57, v25, vcc quad_perm:[1,0,3,2] row_mask:0xf bank_mask:0xf
    v_mfma_f32_16x16x32_bf16 v[92:95], v[176:179], v[240:243], v[92:95]
    v_cndmask_b32_dpp v90, v58, v26, vcc quad_perm:[1,0,3,2] row_mask:0xf bank_mask:0xf
    v_cndmask_b32_dpp v91, v59, v27, vcc quad_perm:[1,0,3,2] row_mask:0xf bank_mask:0xf
    v_mfma_f32_16x16x32_bf16 v[92:95], v[180:183], v[244:247], v[92:95]
    s_not_b64 vcc, vcc
    buffer_store_dwordx4 v[88:91], v252, s[16:19], s49 offen offset:2048 nt
    v_mfma_f32_16x16x32_bf16 v[124:127], v[184:187], v[240:243], v[124:127]
    v_cndmask_b32_dpp v120, v24, v56, vcc quad_perm:[1,0,3,2] row_mask:0xf bank_mask:0xf
    v_cndmask_b32_dpp v121, v25, v57, vcc quad_perm:[1,0,3,2] row_mask:0xf bank_mask:0xf
    v_mfma_f32_16x16x32_bf16 v[124:127], v[188:191], v[244:247], v[124:127]
    s_waitcnt lgkmcnt(0)
    v_cndmask_b32_dpp v122, v26, v58, vcc quad_perm:[1,0,3,2] row_mask:0xf bank_mask:0xf
    v_cndmask_b32_dpp v123, v27, v59, vcc quad_perm:[1,0,3,2] row_mask:0xf bank_mask:0xf
    v_mfma_f32_16x16x32_bf16 v[124:127], v[152:155], v[224:227], v[124:127]
    buffer_store_dwordx4 v[120:123], v253, s[16:19], s49 offen offset:2048 nt
    v_mfma_f32_16x16x32_bf16 v[124:127], v[156:159], v[228:231], v[124:127]
    v_mfma_f32_16x16x32_bf16 v[92:95], v[144:147], v[224:227], v[92:95]
    v_mfma_f32_16x16x32_bf16 v[92:95], v[148:151], v[228:231], v[92:95]
    v_mfma_f32_16x16x32_bf16 v[60:63], v[136:139], v[224:227], v[60:63]
    v_mfma_f32_16x16x32_bf16 v[60:63], v[140:143], v[228:231], v[60:63]
    v_mfma_f32_16x16x32_bf16 v[28:31], v[128:131], v[224:227], v[28:31]
    v_mfma_f32_16x16x32_bf16 v[28:31], v[132:135], v[228:231], v[28:31]
    s_nop 7
    v_cvt_pk_bf16_f32 v28, v28, v29
    v_cvt_pk_bf16_f32 v29, v30, v31
    v_cvt_pk_bf16_f32 v30, v60, v61
    v_cvt_pk_bf16_f32 v31, v62, v63
    v_cvt_pk_bf16_f32 v60, v92, v93
    v_cvt_pk_bf16_f32 v61, v94, v95
    v_cvt_pk_bf16_f32 v62, v124, v125
    v_cvt_pk_bf16_f32 v63, v126, v127
    v_cndmask_b32_dpp v124, v28, v60, vcc quad_perm:[1,0,3,2] row_mask:0xf bank_mask:0xf
    v_cndmask_b32_dpp v125, v29, v61, vcc quad_perm:[1,0,3,2] row_mask:0xf bank_mask:0xf
    v_cndmask_b32_dpp v126, v30, v62, vcc quad_perm:[1,0,3,2] row_mask:0xf bank_mask:0xf
    v_cndmask_b32_dpp v127, v31, v63, vcc quad_perm:[1,0,3,2] row_mask:0xf bank_mask:0xf
    s_not_b64 vcc, vcc
    buffer_store_dwordx4 v[124:127], v253, s[16:19], s49 offen offset:3072 nt
    v_cndmask_b32_dpp v92, v60, v28, vcc quad_perm:[1,0,3,2] row_mask:0xf bank_mask:0xf
    v_cndmask_b32_dpp v93, v61, v29, vcc quad_perm:[1,0,3,2] row_mask:0xf bank_mask:0xf
    v_cndmask_b32_dpp v94, v62, v30, vcc quad_perm:[1,0,3,2] row_mask:0xf bank_mask:0xf
    v_cndmask_b32_dpp v95, v63, v31, vcc quad_perm:[1,0,3,2] row_mask:0xf bank_mask:0xf
    buffer_store_dwordx4 v[92:95], v252, s[16:19], s49 offen offset:3072 nt
L_fin:
L_end:
    s_endpgm
L_code_end:
.section .rodata,"a"
.p2align 6
.amdhsa_kernel standalone__conformer_conv_module__speech_kernel
  .amdhsa_next_free_vgpr 256
  .amdhsa_next_free_sgpr 102
  .amdhsa_accum_offset 256
  .amdhsa_group_segment_fixed_size 0
  .amdhsa_kernarg_size 56
  .amdhsa_user_sgpr_count 2
  .amdhsa_user_sgpr_kernarg_segment_ptr 1
  .amdhsa_system_sgpr_workgroup_id_x 1
  .amdhsa_float_denorm_mode_32 3
.end_amdhsa_kernel
```
